```python
import torch

def _softmax(x, axis=-1):
    return torch.softmax(x, dim=axis)
def _gelu(x):
    return torch.nn.functional.gelu(x, approximate="tanh")
def _silu(x):
    return torch.nn.functional.silu(x)
def _sigmoid(x):
    return torch.sigmoid(x)
def _layernorm(x, axis=-1, eps=1e-5):
    m = x.mean(dim=axis, keepdim=True)
    v = x.var(dim=axis, keepdim=True, unbiased=False)
    return (x - m) / torch.sqrt(v + eps)
def _scatter_add(tgt, idx, src, axis=0):
    return tgt.clone().index_add_(axis, idx, src)
def _segment_sum(src, seg, n):
    out = torch.zeros((n,) + src.shape[1:], dtype=src.dtype)
    return out.index_add_(0, seg, src)
def _pad(x, pw):
    flat = tuple(v for pair in reversed(pw) for v in pair)
    return torch.nn.functional.pad(x, flat)

kernel_name = 'concat_heads__grouped_kv_mqa__compressed_kv_cla__prompt'

def setup_inputs():

    _w = (lambda a: (lambda t: t.to(torch.bfloat16) if t.is_floating_point() else t)(torch.as_tensor(a)))
    def _A_setup():
        B, S, D, H = 1, 2048, 1024, 32
        Dh = D // H
        return {
            "x": _w((lambda *s: torch.randn(*s, dtype=torch.bfloat16) * 0.05)(B, S, D)),
            "wq": _w((lambda *s: torch.randn(*s, dtype=torch.bfloat16) * 0.8)(D, H * Dh)),
            "wk": _w((lambda *s: torch.randn(*s, dtype=torch.bfloat16) * 0.8)(D, Dh)),
            "wv": _w((lambda *s: torch.randn(*s, dtype=torch.bfloat16) * 0.05)(D, Dh)),
            "wo": _w((lambda *s: torch.randn(*s, dtype=torch.bfloat16) * 0.05)(H * Dh, D)),
        }
    _A_in = _A_setup()

    def _B_setup():
        B, H, Sq, Sk, D, M = 1, 32, 2048, 2048, 128, 1024
        Dc = 4 * D
        return {
            "x": _w((lambda *s: torch.randn(*s, dtype=torch.bfloat16) * 1.6)(B, Sq, M)),
            "c_kv": _w((lambda *s: torch.randn(*s, dtype=torch.bfloat16) * 0.2)(B, Sk, Dc)),
            "w_q": _w((lambda *s: torch.randn(*s, dtype=torch.bfloat16) * 6.4)(M, H, D) * (M ** -0.5)),
            "w_uk": _w((lambda *s: torch.randn(*s, dtype=torch.bfloat16) * 6.4)(Dc, H, D) * (Dc ** -0.5)),
            "w_uv": _w((lambda *s: torch.randn(*s, dtype=torch.bfloat16) * 0.2)(Dc, H, D) * (Dc ** -0.5)),
            "w_o": _w((lambda *s: torch.randn(*s, dtype=torch.bfloat16) * 0.2)(H, D, M) * ((H * D) ** -0.5)),
        }
    _B_in = _B_setup()

    return {
        "A_x": _A_in["x"],
        "A_wq": _A_in["wq"],
        "A_wk": _A_in["wk"],
        "A_wv": _A_in["wv"],
        "A_wo": _A_in["wo"],
        "B_x": _B_in["x"],
        "B_c_kv": _B_in["c_kv"],
        "B_w_q": _B_in["w_q"],
        "B_w_uk": _B_in["w_uk"],
        "B_w_uv": _B_in["w_uv"],
        "B_w_o": _B_in["w_o"],
    }

def reference(A_x, A_wq, A_wk, A_wv, A_wo, B_x, B_c_kv, B_w_q, B_w_uk, B_w_uv, B_w_o):
    def _A_ref(x, wq, wk, wv, wo):
        B, S, D = x.shape
        H = 32
        Dh = D // H
        q = (lambda x, *d: x.permute(*d))((x @ wq).reshape(B, S, H, Dh), 0, 2, 1, 3)
        k = x @ wk
        v = x @ wv
        scores = torch.einsum("bhqd,bkd->bhqk", q, k) * (Dh ** -0.5)
        p = _softmax(scores, axis=-1)
        o = torch.einsum("bhqk,bkd->bhqd", p, v)
        return (lambda x, *d: x.permute(*d))(o, 0, 2, 1, 3).reshape(B, S, H * Dh) @ wo

    def _B_ref(x, c_kv, w_q, w_uk, w_uv, w_o):
        B, Sq, M = x.shape[0], x.shape[1], x.shape[2]
        Sk = c_kv.shape[1]
        H, D = w_q.shape[1], w_q.shape[2]
        q = torch.einsum("bqm,mhd->bhqd", x, w_q)
        k = torch.einsum("bkc,chd->bhkd", c_kv, w_uk)
        v = torch.einsum("bkc,chd->bhkd", c_kv, w_uv)
        scores = torch.einsum("bhqd,bhkd->bhqk", q, k) * (D ** -0.5)
        off = Sk - Sq
        qi = torch.arange(Sq)[:, None]
        kj = torch.arange(Sk)[None, :]
        cmask = kj <= (qi + off)
        scores = torch.where(cmask[None, None], scores, -1e9)
        p = _softmax(scores, axis=-1)
        ctx = torch.einsum("bhqk,bhkd->bhqd", p, v)
        return torch.einsum("bhqd,hdm->bqm", ctx, w_o)

    a = _A_ref(A_x, A_wq, A_wk, A_wv, A_wo)
    b = _B_ref(B_x, B_c_kv, B_w_q, B_w_uk, B_w_uv, B_w_o)
    return torch.concatenate([a, b], axis=-1)
```

```asm
; @launch kernel=proj_kernel grid=(256,1,1) block=(512,1,1) lds=163840
; @launch kernel=attn_kernel grid=(256,1,1) block=(512,1,1) lds=115712
; @launch kernel=outp_kernel grid=(256,1,1) block=(256,1,1) lds=163840
.amdgcn_target "amdgcn-amd-amdhsa--gfx950"
.text
.globl proj_kernel
.p2align 8
.type proj_kernel,@function
proj_kernel:
    s_cmp_ge_u32 s2, 256
    s_cbranch_scc1 L_proj_kernel_end_1
    s_load_dwordx2 s[56:57], s[0:1], 40
    s_load_dwordx2 s[58:59], s[0:1], 56
    s_load_dwordx2 s[60:61], s[0:1], 48
    s_load_dwordx2 s[62:63], s[0:1], 64
    s_load_dwordx2 s[64:65], s[0:1], 72
    s_load_dwordx2 s[66:67], s[0:1], 0
    s_load_dwordx2 s[68:69], s[0:1], 8
    s_load_dwordx2 s[70:71], s[0:1], 16
    s_load_dwordx2 s[72:73], s[0:1], 24
    s_load_dwordx2 s[74:75], s[0:1], 104
    v_and_b32 v1, 63, v0
    v_lshrrev_b32 v2, 6, v0
    s_nop 0
    v_readfirstlane_b32 s24, v2
    s_nop 3
    s_and_b32 s76, s2, 127
    s_and_b32 s77, s76, 1
    s_lshl_b32 s77, s77, 2
    s_bfe_u32 s79, s76, 0x20003
    s_add_u32 s77, s77, s79
    s_bfe_u32 s78, s76, 0x20001
    s_lshl_b32 s78, s78, 2
    s_lshr_b32 s79, s76, 5
    s_add_u32 s78, s78, s79
    s_waitcnt lgkmcnt(0)
    s_cmp_ge_u32 s2, 128
    s_cbranch_scc1 L_proj_kernel_kv_4
    s_mov_b32 s4, s56
    s_and_b32 s5, s57, 0xffff
    s_mov_b32 s6, 0x400000
    s_mov_b32 s7, 0x20000
    s_mov_b32 s8, s58
    s_and_b32 s9, s59, 0xffff
    s_mov_b32 s10, 0x800000
    s_mov_b32 s11, 0x20000
    s_mov_b32 s16, 2048
    s_mov_b32 s17, 8192
    s_mov_b32 s18, 32
    s_lshl_b32 s19, s77, 19
    s_lshl_b32 s20, s78, 9
    s_mul_i32 s25, s24, 32
    s_add_u32 s25, s25, 0
    v_lshrrev_b32 v2, 2, v1
    v_add_u32 v2, s25, v2
    v_lshrrev_b32 v3, 2, v2
    v_and_b32 v3, 3, v3
    v_and_b32 v4, 3, v1
    v_xor_b32 v3, v3, v4
    v_mul_lo_u32 v2, v2, s16
    v_lshl_add_u32 v2, v3, 4, v2
    v_add_u32 v6, s19, v2
    s_mul_i32 s25, s24, 32
    s_add_u32 s25, s25, 16
    v_lshrrev_b32 v2, 2, v1
    v_add_u32 v2, s25, v2
    v_lshrrev_b32 v3, 2, v2
    v_and_b32 v3, 3, v3
    v_and_b32 v4, 3, v1
    v_xor_b32 v3, v3, v4
    v_mul_lo_u32 v2, v2, s16
    v_lshl_add_u32 v2, v3, 4, v2
    v_add_u32 v7, s19, v2
    s_mul_i32 s25, s24, 4
    s_add_u32 s25, s25, 0
    v_lshrrev_b32 v2, 5, v1
    v_add_u32 v2, s25, v2
    v_and_b32 v3, 3, v2
    v_lshlrev_b32 v3, 2, v3
    v_and_b32 v4, 31, v1
    v_xor_b32 v3, v3, v4
    v_mul_lo_u32 v2, v2, s17
    v_lshl_add_u32 v2, v3, 4, v2
    v_add_u32 v8, s20, v2
    s_mul_i32 s25, s24, 4
    s_add_u32 s25, s25, 2
    v_lshrrev_b32 v2, 5, v1
    v_add_u32 v2, s25, v2
    v_and_b32 v3, 3, v2
    v_lshlrev_b32 v3, 2, v3
    v_and_b32 v4, 31, v1
    v_xor_b32 v3, v3, v4
    v_mul_lo_u32 v2, v2, s17
    v_lshl_add_u32 v2, v3, 4, v2
    v_add_u32 v9, s20, v2
    s_mov_b32 s27, 0
    s_mov_b32 s28, 0
    s_mov_b32 s29, 0
    s_mov_b32 s30, 0
    s_mov_b32 s31, 32768
    s_mul_i32 s33, s24, 2048
    s_mul_i32 s34, s24, 2048
    s_add_u32 s34, s34, 16384
    s_mul_i32 s35, s17, 32
    s_mov_b32 s38, s18
    s_add_u32 s36, s29, s33
    s_add_u32 m0, s36, 0
    s_nop 0
    buffer_load_dwordx4 v6, s[4:7], s27 offen lds
    s_add_u32 m0, s36, 1024
    s_nop 0
    buffer_load_dwordx4 v7, s[4:7], s27 offen lds
    s_add_u32 s37, s29, s34
    s_add_u32 m0, s37, 0
    s_nop 0
    buffer_load_dwordx4 v8, s[8:11], s28 offen lds
    s_add_u32 m0, s37, 1024
    s_nop 0
    buffer_load_dwordx4 v9, s[8:11], s28 offen lds
    s_add_u32 s27, s27, 64
    s_add_u32 s28, s28, s35
    s_add_u32 s29, s29, 32768
    s_cmp_eq_u32 s29, 131072
    s_cselect_b32 s29, 0, s29
    s_add_u32 s36, s29, s33
    s_add_u32 m0, s36, 0
    s_nop 0
    buffer_load_dwordx4 v6, s[4:7], s27 offen lds
    s_add_u32 m0, s36, 1024
    s_nop 0
    buffer_load_dwordx4 v7, s[4:7], s27 offen lds
    s_add_u32 s37, s29, s34
    s_add_u32 m0, s37, 0
    s_nop 0
    buffer_load_dwordx4 v8, s[8:11], s28 offen lds
    s_add_u32 m0, s37, 1024
    s_nop 0
    buffer_load_dwordx4 v9, s[8:11], s28 offen lds
    s_add_u32 s27, s27, 64
    s_add_u32 s28, s28, s35
    s_add_u32 s29, s29, 32768
    s_cmp_eq_u32 s29, 131072
    s_cselect_b32 s29, 0, s29
    s_add_u32 s36, s29, s33
    s_add_u32 m0, s36, 0
    s_nop 0
    buffer_load_dwordx4 v6, s[4:7], s27 offen lds
    s_add_u32 m0, s36, 1024
    s_nop 0
    buffer_load_dwordx4 v7, s[4:7], s27 offen lds
    s_add_u32 s37, s29, s34
    s_add_u32 m0, s37, 0
    s_nop 0
    buffer_load_dwordx4 v8, s[8:11], s28 offen lds
    s_add_u32 m0, s37, 1024
    s_nop 0
    buffer_load_dwordx4 v9, s[8:11], s28 offen lds
    s_add_u32 s27, s27, 64
    s_add_u32 s28, s28, s35
    s_add_u32 s29, s29, 32768
    s_cmp_eq_u32 s29, 131072
    s_cselect_b32 s29, 0, s29
    v_lshlrev_b32 v28, 4, v0
    s_mov_b32 s80, s56
    s_and_b32 s81, s57, 0xffff
    s_mov_b32 s82, 0x400000
    s_mov_b32 s83, 0x20000
    s_mul_i32 s79, s2, 16384
    buffer_load_dwordx4 v[24:27], v28, s[80:83], s79 offen
    s_add_u32 s79, s79, 8192
    buffer_load_dwordx4 v[24:27], v28, s[80:83], s79 offen
    s_add_u32 s79, s79, 8192
    s_mov_b32 s80, s58
    s_and_b32 s81, s59, 0xffff
    s_mov_b32 s82, 0x800000
    s_mov_b32 s83, 0x20000
    s_mul_i32 s79, s2, 32768
    buffer_load_dwordx4 v[24:27], v28, s[80:83], s79 offen
    s_add_u32 s79, s79, 8192
    buffer_load_dwordx4 v[24:27], v28, s[80:83], s79 offen
    s_add_u32 s79, s79, 8192
    buffer_load_dwordx4 v[24:27], v28, s[80:83], s79 offen
    s_add_u32 s79, s79, 8192
    buffer_load_dwordx4 v[24:27], v28, s[80:83], s79 offen
    s_add_u32 s79, s79, 8192
    s_mov_b32 s80, s60
    s_and_b32 s81, s61, 0xffff
    s_mov_b32 s82, 0x200000
    s_mov_b32 s83, 0x20000
    s_mul_i32 s79, s2, 8192
    buffer_load_dwordx4 v[24:27], v28, s[80:83], s79 offen
    s_add_u32 s79, s79, 8192
    s_mov_b32 s80, s62
    s_and_b32 s81, s63, 0xffff
    s_mov_b32 s82, 0x400000
    s_mov_b32 s83, 0x20000
    s_mul_i32 s79, s2, 16384
    buffer_load_dwordx4 v[24:27], v28, s[80:83], s79 offen
    s_add_u32 s79, s79, 8192
    buffer_load_dwordx4 v[24:27], v28, s[80:83], s79 offen
    s_add_u32 s79, s79, 8192
    s_mov_b32 s80, s64
    s_and_b32 s81, s65, 0xffff
    s_mov_b32 s82, 0x400000
    s_mov_b32 s83, 0x20000
    s_mul_i32 s79, s2, 16384
    buffer_load_dwordx4 v[24:27], v28, s[80:83], s79 offen
    s_add_u32 s79, s79, 8192
    buffer_load_dwordx4 v[24:27], v28, s[80:83], s79 offen
    s_add_u32 s79, s79, 8192
    s_mov_b32 s80, s66
    s_and_b32 s81, s67, 0xffff
    s_mov_b32 s82, 0x400000
    s_mov_b32 s83, 0x20000
    s_mul_i32 s79, s2, 16384
    buffer_load_dwordx4 v[24:27], v28, s[80:83], s79 offen
    s_add_u32 s79, s79, 8192
    buffer_load_dwordx4 v[24:27], v28, s[80:83], s79 offen
    s_add_u32 s79, s79, 8192
    s_mov_b32 s80, s68
    s_and_b32 s81, s69, 0xffff
    s_mov_b32 s82, 0x200000
    s_mov_b32 s83, 0x20000
    s_mul_i32 s79, s2, 8192
    buffer_load_dwordx4 v[24:27], v28, s[80:83], s79 offen
    s_add_u32 s79, s79, 8192
    s_mov_b32 s12, s74
    s_and_b32 s13, s75, 0xffff
    s_mov_b32 s14, 0x1000000
    s_mov_b32 s15, 0x20000
    s_mov_b32 s23, 0x3e0293ee
    s_mov_b32 s22, 256
    s_lshl_b32 s21, s78, 20
    s_lshl_b32 s79, s77, 16
    s_add_u32 s21, s21, s79
    s_lshr_b32 s79, s24, 2
    s_mul_i32 s79, s79, 524032
    s_add_u32 s21, s21, s79
    s_and_b32 s39, s24, 1
    s_lshr_b32 s40, s24, 1
    s_mul_i32 s25, s39, 128
    v_and_b32 v2, 31, v1
    v_add_u32 v2, s25, v2
    v_lshrrev_b32 v3, 2, v2
    v_and_b32 v3, 3, v3
    v_lshrrev_b32 v4, 5, v1
    v_xor_b32 v3, v3, v4
    v_lshlrev_b32 v2, 6, v2
    v_xor_b32 v4, 0, v3
    v_lshl_add_u32 v31, v4, 4, v2
    v_xor_b32 v4, 2, v3
    v_lshl_add_u32 v32, v4, 4, v2
    v_lshrrev_b32 v2, 5, v1
    v_lshlrev_b32 v2, 3, v2
    v_bfe_u32 v3, v1, 2, 2
    v_add_u32 v2, v2, v3
    v_and_b32 v3, 3, v2
    v_lshlrev_b32 v3, 2, v3
    v_lshlrev_b32 v2, 9, v2
    s_mul_i32 s25, s40, 8
    s_add_u32 s25, s25, 0
    v_bfe_u32 v4, v1, 4, 1
    v_lshlrev_b32 v4, 1, v4
    v_bfe_u32 v5, v1, 1, 1
    v_add3_u32 v4, v4, v5, s25
    v_xor_b32 v4, v4, v3
    v_lshl_add_u32 v4, v4, 4, v2
    v_and_b32 v5, 1, v1
    v_lshl_add_u32 v4, v5, 3, v4
    v_add_u32 v33, 16384, v4
    s_mul_i32 s25, s40, 8
    s_add_u32 s25, s25, 4
    v_bfe_u32 v4, v1, 4, 1
    v_lshlrev_b32 v4, 1, v4
    v_bfe_u32 v5, v1, 1, 1
    v_add3_u32 v4, v4, v5, s25
    v_xor_b32 v4, v4, v3
    v_lshl_add_u32 v4, v4, 4, v2
    v_and_b32 v5, 1, v1
    v_lshl_add_u32 v4, v5, 3, v4
    v_add_u32 v34, 16384, v4
    v_mov_b32 v36, 0
    v_mov_b32 v37, 0
    v_mov_b32 v38, 0
    v_mov_b32 v39, 0
    v_mov_b32 v40, 0
    v_mov_b32 v41, 0
    v_mov_b32 v42, 0
    v_mov_b32 v43, 0
    v_mov_b32 v44, 0
    v_mov_b32 v45, 0
    v_mov_b32 v46, 0
    v_mov_b32 v47, 0
    v_mov_b32 v48, 0
    v_mov_b32 v49, 0
    v_mov_b32 v50, 0
    v_mov_b32 v51, 0
    v_mov_b32 v52, 0
    v_mov_b32 v53, 0
    v_mov_b32 v54, 0
    v_mov_b32 v55, 0
    v_mov_b32 v56, 0
    v_mov_b32 v57, 0
    v_mov_b32 v58, 0
    v_mov_b32 v59, 0
    v_mov_b32 v60, 0
    v_mov_b32 v61, 0
    v_mov_b32 v62, 0
    v_mov_b32 v63, 0
    v_mov_b32 v64, 0
    v_mov_b32 v65, 0
    v_mov_b32 v66, 0
    v_mov_b32 v67, 0
    v_mov_b32 v68, 0
    v_mov_b32 v69, 0
    v_mov_b32 v70, 0
    v_mov_b32 v71, 0
    v_mov_b32 v72, 0
    v_mov_b32 v73, 0
    v_mov_b32 v74, 0
    v_mov_b32 v75, 0
    v_mov_b32 v76, 0
    v_mov_b32 v77, 0
    v_mov_b32 v78, 0
    v_mov_b32 v79, 0
    v_mov_b32 v80, 0
    v_mov_b32 v81, 0
    v_mov_b32 v82, 0
    v_mov_b32 v83, 0
    v_mov_b32 v84, 0
    v_mov_b32 v85, 0
    v_mov_b32 v86, 0
    v_mov_b32 v87, 0
    v_mov_b32 v88, 0
    v_mov_b32 v89, 0
    v_mov_b32 v90, 0
    v_mov_b32 v91, 0
    v_mov_b32 v92, 0
    v_mov_b32 v93, 0
    v_mov_b32 v94, 0
    v_mov_b32 v95, 0
    v_mov_b32 v96, 0
    v_mov_b32 v97, 0
    v_mov_b32 v98, 0
    v_mov_b32 v99, 0
    v_mov_b32 v100, 0
    v_mov_b32 v101, 0
    v_mov_b32 v102, 0
    v_mov_b32 v103, 0
    v_mov_b32 v104, 0
    v_mov_b32 v105, 0
    v_mov_b32 v106, 0
    v_mov_b32 v107, 0
    v_mov_b32 v108, 0
    v_mov_b32 v109, 0
    v_mov_b32 v110, 0
    v_mov_b32 v111, 0
    v_mov_b32 v112, 0
    v_mov_b32 v113, 0
    v_mov_b32 v114, 0
    v_mov_b32 v115, 0
    v_mov_b32 v116, 0
    v_mov_b32 v117, 0
    v_mov_b32 v118, 0
    v_mov_b32 v119, 0
    v_mov_b32 v120, 0
    v_mov_b32 v121, 0
    v_mov_b32 v122, 0
    v_mov_b32 v123, 0
    v_mov_b32 v124, 0
    v_mov_b32 v125, 0
    v_mov_b32 v126, 0
    v_mov_b32 v127, 0
    v_mov_b32 v128, 0
    v_mov_b32 v129, 0
    v_mov_b32 v130, 0
    v_mov_b32 v131, 0
    v_mov_b32 v132, 0
    v_mov_b32 v133, 0
    v_mov_b32 v134, 0
    v_mov_b32 v135, 0
    v_mov_b32 v136, 0
    v_mov_b32 v137, 0
    v_mov_b32 v138, 0
    v_mov_b32 v139, 0
    v_mov_b32 v140, 0
    v_mov_b32 v141, 0
    v_mov_b32 v142, 0
    v_mov_b32 v143, 0
    v_mov_b32 v144, 0
    v_mov_b32 v145, 0
    v_mov_b32 v146, 0
    v_mov_b32 v147, 0
    v_mov_b32 v148, 0
    v_mov_b32 v149, 0
    v_mov_b32 v150, 0
    v_mov_b32 v151, 0
    v_mov_b32 v152, 0
    v_mov_b32 v153, 0
    v_mov_b32 v154, 0
    v_mov_b32 v155, 0
    v_mov_b32 v156, 0
    v_mov_b32 v157, 0
    v_mov_b32 v158, 0
    v_mov_b32 v159, 0
    v_mov_b32 v160, 0
    v_mov_b32 v161, 0
    v_mov_b32 v162, 0
    v_mov_b32 v163, 0
    s_waitcnt vmcnt(18)
    s_barrier
    v_mov_b32 v214, v33
    v_mov_b32 v215, v34
    v_mov_b32 v212, v31
    ds_read_b128 v[164:167], v212 offset:0
    ds_read_b128 v[168:171], v212 offset:2048
    ds_read_b128 v[172:175], v212 offset:4096
    ds_read_b128 v[176:179], v212 offset:6144
    ds_read_b64_tr_b16 v[196:197], v214 offset:0
    ds_read_b64_tr_b16 v[198:199], v214 offset:2048
    ds_read_b64_tr_b16 v[200:201], v215 offset:0
    ds_read_b64_tr_b16 v[202:203], v215 offset:2048
    s_sub_u32 s32, s38, 3
L_proj_kernel_main_5:
    v_add_u32 v213, s30, v32
    v_add_u32 v214, s30, v33
    v_add_u32 v215, s30, v34
    v_add_u32 v212, s31, v31
    v_add_u32 v216, s31, v33
    v_add_u32 v217, s31, v34
    s_waitcnt lgkmcnt(0)
    v_mfma_f32_32x32x16_bf16 v[36:51], v[196:199], v[164:167], v[36:51]
    ds_read_b128 v[180:183], v213 offset:0
    ds_read_b128 v[184:187], v213 offset:2048
    v_mfma_f32_32x32x16_bf16 v[52:67], v[200:203], v[164:167], v[52:67]
    ds_read_b128 v[188:191], v213 offset:4096
    ds_read_b128 v[192:195], v213 offset:6144
    v_mfma_f32_32x32x16_bf16 v[68:83], v[196:199], v[168:171], v[68:83]
    ds_read_b64_tr_b16 v[204:205], v214 offset:8192
    ds_read_b64_tr_b16 v[206:207], v214 offset:10240
    v_mfma_f32_32x32x16_bf16 v[84:99], v[200:203], v[168:171], v[84:99]
    ds_read_b64_tr_b16 v[208:209], v215 offset:8192
    ds_read_b64_tr_b16 v[210:211], v215 offset:10240
    v_mfma_f32_32x32x16_bf16 v[100:115], v[196:199], v[172:175], v[100:115]
    v_mfma_f32_32x32x16_bf16 v[116:131], v[200:203], v[172:175], v[116:131]
    v_mfma_f32_32x32x16_bf16 v[132:147], v[196:199], v[176:179], v[132:147]
    v_mfma_f32_32x32x16_bf16 v[148:163], v[200:203], v[176:179], v[148:163]
    s_waitcnt lgkmcnt(0)
    v_mfma_f32_32x32x16_bf16 v[36:51], v[204:207], v[180:183], v[36:51]
    ds_read_b128 v[164:167], v212 offset:0
    ds_read_b128 v[168:171], v212 offset:2048
    v_mfma_f32_32x32x16_bf16 v[52:67], v[208:211], v[180:183], v[52:67]
    ds_read_b128 v[172:175], v212 offset:4096
    ds_read_b128 v[176:179], v212 offset:6144
    v_mfma_f32_32x32x16_bf16 v[68:83], v[204:207], v[184:187], v[68:83]
    ds_read_b64_tr_b16 v[196:197], v216 offset:0
    ds_read_b64_tr_b16 v[198:199], v216 offset:2048
    v_mfma_f32_32x32x16_bf16 v[84:99], v[208:211], v[184:187], v[84:99]
    ds_read_b64_tr_b16 v[200:201], v217 offset:0
    ds_read_b64_tr_b16 v[202:203], v217 offset:2048
    v_mfma_f32_32x32x16_bf16 v[100:115], v[204:207], v[188:191], v[100:115]
    s_add_u32 s36, s29, s33
    s_add_u32 m0, s36, 0
    s_nop 0
    buffer_load_dwordx4 v6, s[4:7], s27 offen lds
    s_add_u32 m0, s36, 1024
    s_nop 0
    buffer_load_dwordx4 v7, s[4:7], s27 offen lds
    v_mfma_f32_32x32x16_bf16 v[116:131], v[208:211], v[188:191], v[116:131]
    s_add_u32 s37, s29, s34
    s_add_u32 m0, s37, 0
    s_nop 0
    buffer_load_dwordx4 v8, s[8:11], s28 offen lds
    s_add_u32 m0, s37, 1024
    s_nop 0
    buffer_load_dwordx4 v9, s[8:11], s28 offen lds
    v_mfma_f32_32x32x16_bf16 v[132:147], v[204:207], v[192:195], v[132:147]
    s_add_u32 s27, s27, 64
    s_add_u32 s28, s28, s35
    s_add_u32 s29, s29, 32768
    s_cmp_eq_u32 s29, 131072
    s_cselect_b32 s29, 0, s29
    v_mfma_f32_32x32x16_bf16 v[148:163], v[208:211], v[192:195], v[148:163]
    s_mov_b32 s30, s31
    s_add_u32 s31, s31, 32768
    s_cmp_eq_u32 s31, 131072
    s_cselect_b32 s31, 0, s31
    s_waitcnt vmcnt(4)
    s_barrier
    s_sub_u32 s32, s32, 1
    s_cmp_lg_u32 s32, 0
    s_cbranch_scc1 L_proj_kernel_main_5
    s_mov_b32 s32, 3
L_proj_kernel_tail_6:
    v_add_u32 v213, s30, v32
    v_add_u32 v214, s30, v33
    v_add_u32 v215, s30, v34
    v_add_u32 v212, s31, v31
    v_add_u32 v216, s31, v33
    v_add_u32 v217, s31, v34
    s_waitcnt lgkmcnt(0)
    v_mfma_f32_32x32x16_bf16 v[36:51], v[196:199], v[164:167], v[36:51]
    ds_read_b128 v[180:183], v213 offset:0
    ds_read_b128 v[184:187], v213 offset:2048
    v_mfma_f32_32x32x16_bf16 v[52:67], v[200:203], v[164:167], v[52:67]
    ds_read_b128 v[188:191], v213 offset:4096
    ds_read_b128 v[192:195], v213 offset:6144
    v_mfma_f32_32x32x16_bf16 v[68:83], v[196:199], v[168:171], v[68:83]
    ds_read_b64_tr_b16 v[204:205], v214 offset:8192
    ds_read_b64_tr_b16 v[206:207], v214 offset:10240
    v_mfma_f32_32x32x16_bf16 v[84:99], v[200:203], v[168:171], v[84:99]
    ds_read_b64_tr_b16 v[208:209], v215 offset:8192
    ds_read_b64_tr_b16 v[210:211], v215 offset:10240
    v_mfma_f32_32x32x16_bf16 v[100:115], v[196:199], v[172:175], v[100:115]
    v_mfma_f32_32x32x16_bf16 v[116:131], v[200:203], v[172:175], v[116:131]
    v_mfma_f32_32x32x16_bf16 v[132:147], v[196:199], v[176:179], v[132:147]
    v_mfma_f32_32x32x16_bf16 v[148:163], v[200:203], v[176:179], v[148:163]
    s_waitcnt lgkmcnt(0)
    v_mfma_f32_32x32x16_bf16 v[36:51], v[204:207], v[180:183], v[36:51]
    ds_read_b128 v[164:167], v212 offset:0
    ds_read_b128 v[168:171], v212 offset:2048
    v_mfma_f32_32x32x16_bf16 v[52:67], v[208:211], v[180:183], v[52:67]
    ds_read_b128 v[172:175], v212 offset:4096
    ds_read_b128 v[176:179], v212 offset:6144
    v_mfma_f32_32x32x16_bf16 v[68:83], v[204:207], v[184:187], v[68:83]
    ds_read_b64_tr_b16 v[196:197], v216 offset:0
    ds_read_b64_tr_b16 v[198:199], v216 offset:2048
    v_mfma_f32_32x32x16_bf16 v[84:99], v[208:211], v[184:187], v[84:99]
    ds_read_b64_tr_b16 v[200:201], v217 offset:0
    ds_read_b64_tr_b16 v[202:203], v217 offset:2048
    v_mfma_f32_32x32x16_bf16 v[100:115], v[204:207], v[188:191], v[100:115]
    v_mfma_f32_32x32x16_bf16 v[116:131], v[208:211], v[188:191], v[116:131]
    v_mfma_f32_32x32x16_bf16 v[132:147], v[204:207], v[192:195], v[132:147]
    v_mfma_f32_32x32x16_bf16 v[148:163], v[208:211], v[192:195], v[148:163]
    s_mov_b32 s30, s31
    s_add_u32 s31, s31, 32768
    s_cmp_eq_u32 s31, 131072
    s_cselect_b32 s31, 0, s31
    s_waitcnt vmcnt(0)
    s_barrier
    s_sub_u32 s32, s32, 1
    s_cmp_lg_u32 s32, 0
    s_cbranch_scc1 L_proj_kernel_tail_6
    s_waitcnt lgkmcnt(0)
    s_nop 15
    s_mov_b32 s4, s66
    s_and_b32 s5, s67, 0xffff
    s_mov_b32 s6, 0x400000
    s_mov_b32 s7, 0x20000
    s_mov_b32 s8, s68
    s_and_b32 s9, s69, 0xffff
    s_mov_b32 s10, 0x200000
    s_mov_b32 s11, 0x20000
    s_mov_b32 s16, 2048
    s_mov_b32 s17, 2048
    s_mov_b32 s18, 16
    s_and_b32 s79, s2, 15
    s_lshl_b32 s19, s79, 18
    s_lshr_b32 s79, s2, 4
    s_lshl_b32 s20, s79, 8
    s_mul_i32 s25, s24, 16
    s_add_u32 s25, s25, 0
    v_lshrrev_b32 v2, 3, v1
    v_add_u32 v2, s25, v2
    v_lshrrev_b32 v3, 1, v2
    v_and_b32 v3, 7, v3
    v_and_b32 v4, 7, v1
    v_xor_b32 v3, v3, v4
    v_mul_lo_u32 v2, v2, s16
    v_lshl_add_u32 v2, v3, 4, v2
    v_add_u32 v14, s19, v2
    s_mul_i32 s25, s24, 16
    s_add_u32 s25, s25, 8
    v_lshrrev_b32 v2, 3, v1
    v_add_u32 v2, s25, v2
    v_lshrrev_b32 v3, 1, v2
    v_and_b32 v3, 7, v3
    v_and_b32 v4, 7, v1
    v_xor_b32 v3, v3, v4
    v_mul_lo_u32 v2, v2, s16
    v_lshl_add_u32 v2, v3, 4, v2
    v_add_u32 v15, s19, v2
    s_mul_i32 s25, s24, 8
    s_add_u32 s25, s25, 0
    v_lshrrev_b32 v2, 4, v1
    v_add_u32 v2, s25, v2
    v_and_b32 v3, 3, v2
    v_lshlrev_b32 v3, 2, v3
    v_and_b32 v4, 15, v1
    v_xor_b32 v3, v3, v4
    v_mul_lo_u32 v2, v2, s17
    v_lshl_add_u32 v2, v3, 4, v2
    v_add_u32 v16, s20, v2
    s_mul_i32 s25, s24, 8
    s_add_u32 s25, s25, 4
    v_lshrrev_b32 v2, 4, v1
    v_add_u32 v2, s25, v2
    v_and_b32 v3, 3, v2
    v_lshlrev_b32 v3, 2, v3
    v_and_b32 v4, 15, v1
    v_xor_b32 v3, v3, v4
    v_mul_lo_u32 v2, v2, s17
    v_lshl_add_u32 v2, v3, 4, v2
    v_add_u32 v17, s20, v2
    s_mov_b32 s41, 0
    s_mov_b32 s42, 0
    s_mov_b32 s43, 0
    s_mov_b32 s44, 0
    s_mov_b32 s45, 32768
    s_mul_i32 s47, s24, 2048
    s_mul_i32 s48, s24, 2048
    s_add_u32 s48, s48, 16384
    s_mul_i32 s49, s17, 64
    s_mov_b32 s52, s18
    s_add_u32 s50, s43, s47
    s_add_u32 m0, s50, 0
    s_nop 0
    buffer_load_dwordx4 v14, s[4:7], s41 offen lds
    s_add_u32 m0, s50, 1024
    s_nop 0
    buffer_load_dwordx4 v15, s[4:7], s41 offen lds
    s_add_u32 s51, s43, s48
    s_add_u32 m0, s51, 0
    s_nop 0
    buffer_load_dwordx4 v16, s[8:11], s42 offen lds
    s_add_u32 m0, s51, 1024
    s_nop 0
    buffer_load_dwordx4 v17, s[8:11], s42 offen lds
    s_add_u32 s41, s41, 128
    s_add_u32 s42, s42, s49
    s_add_u32 s43, s43, 32768
    s_cmp_eq_u32 s43, 131072
    s_cselect_b32 s43, 0, s43
    s_add_u32 s50, s43, s47
    s_add_u32 m0, s50, 0
    s_nop 0
    buffer_load_dwordx4 v14, s[4:7], s41 offen lds
    s_add_u32 m0, s50, 1024
    s_nop 0
    buffer_load_dwordx4 v15, s[4:7], s41 offen lds
    s_add_u32 s51, s43, s48
    s_add_u32 m0, s51, 0
    s_nop 0
    buffer_load_dwordx4 v16, s[8:11], s42 offen lds
    s_add_u32 m0, s51, 1024
    s_nop 0
    buffer_load_dwordx4 v17, s[8:11], s42 offen lds
    s_add_u32 s41, s41, 128
    s_add_u32 s42, s42, s49
    s_add_u32 s43, s43, 32768
    s_cmp_eq_u32 s43, 131072
    s_cselect_b32 s43, 0, s43
    s_add_u32 s50, s43, s47
    s_add_u32 m0, s50, 0
    s_nop 0
    buffer_load_dwordx4 v14, s[4:7], s41 offen lds
    s_add_u32 m0, s50, 1024
    s_nop 0
    buffer_load_dwordx4 v15, s[4:7], s41 offen lds
    s_add_u32 s51, s43, s48
    s_add_u32 m0, s51, 0
    s_nop 0
    buffer_load_dwordx4 v16, s[8:11], s42 offen lds
    s_add_u32 m0, s51, 1024
    s_nop 0
    buffer_load_dwordx4 v17, s[8:11], s42 offen lds
    s_add_u32 s41, s41, 128
    s_add_u32 s42, s42, s49
    s_add_u32 s43, s43, 32768
    s_cmp_eq_u32 s43, 131072
    s_cselect_b32 s43, 0, s43
    s_lshl_b32 s25, s24, 12
    s_add_u32 s25, s25, 131072
    v_and_b32 v221, 31, v1
    v_lshlrev_b32 v218, 7, v221
    v_add_u32 v218, s25, v218
    v_and_b32 v221, 7, v221
    v_lshrrev_b32 v219, 5, v1
    v_xor_b32 v221, v221, v219
    v_lshl_add_u32 v218, v221, 4, v218
    v_lshrrev_b32 v221, 3, v1
    v_xor_b32 v219, v221, v1
    v_and_b32 v219, 7, v219
    v_lshlrev_b32 v219, 4, v219
    v_lshl_add_u32 v219, v221, 7, v219
    v_add_u32 v219, s25, v219
    v_mul_lo_u32 v220, v221, s22
    v_and_b32 v221, 7, v1
    v_lshl_add_u32 v220, v221, 4, v220
    s_mul_i32 s25, s39, 128
    s_mul_i32 s25, s25, s22
    s_add_u32 s25, s25, s21
    s_mul_i32 s26, s40, 128
    s_add_u32 s25, s25, s26
    s_mul_i32 s26, s22, 8
    v_mul_f32 v36, s23, v36
    v_mul_f32 v37, s23, v37
    v_mul_f32 v38, s23, v38
    v_mul_f32 v39, s23, v39
    v_mul_f32 v40, s23, v40
    v_mul_f32 v41, s23, v41
    v_mul_f32 v42, s23, v42
    v_mul_f32 v43, s23, v43
    v_mul_f32 v44, s23, v44
    v_mul_f32 v45, s23, v45
    v_mul_f32 v46, s23, v46
    v_mul_f32 v47, s23, v47
    v_mul_f32 v48, s23, v48
    v_mul_f32 v49, s23, v49
    v_mul_f32 v50, s23, v50
    v_mul_f32 v51, s23, v51
    v_cvt_pk_bf16_f32 v36, v36, v37
    v_cvt_pk_bf16_f32 v37, v38, v39
    v_cvt_pk_bf16_f32 v38, v40, v41
    v_cvt_pk_bf16_f32 v39, v42, v43
    v_cvt_pk_bf16_f32 v40, v44, v45
    v_cvt_pk_bf16_f32 v41, v46, v47
    v_cvt_pk_bf16_f32 v42, v48, v49
    v_cvt_pk_bf16_f32 v43, v50, v51
    s_nop 1
    v_permlane32_swap_b32 v36, v38
    v_permlane32_swap_b32 v37, v39
    v_permlane32_swap_b32 v40, v42
    v_permlane32_swap_b32 v41, v43
    s_nop 0
    ds_write_b128 v218, v[36:39]
    v_xor_b32 v221, 32, v218
    ds_write_b128 v221, v[40:43]
    v_mul_f32 v52, s23, v52
    v_mul_f32 v53, s23, v53
    v_mul_f32 v54, s23, v54
    v_mul_f32 v55, s23, v55
    v_mul_f32 v56, s23, v56
    v_mul_f32 v57, s23, v57
    v_mul_f32 v58, s23, v58
    v_mul_f32 v59, s23, v59
    v_mul_f32 v60, s23, v60
    v_mul_f32 v61, s23, v61
    v_mul_f32 v62, s23, v62
    v_mul_f32 v63, s23, v63
    v_mul_f32 v64, s23, v64
    v_mul_f32 v65, s23, v65
    v_mul_f32 v66, s23, v66
    v_mul_f32 v67, s23, v67
    v_cvt_pk_bf16_f32 v52, v52, v53
    v_cvt_pk_bf16_f32 v53, v54, v55
    v_cvt_pk_bf16_f32 v54, v56, v57
    v_cvt_pk_bf16_f32 v55, v58, v59
    v_cvt_pk_bf16_f32 v56, v60, v61
    v_cvt_pk_bf16_f32 v57, v62, v63
    v_cvt_pk_bf16_f32 v58, v64, v65
    v_cvt_pk_bf16_f32 v59, v66, v67
    s_nop 1
    v_permlane32_swap_b32 v52, v54
    v_permlane32_swap_b32 v53, v55
    v_permlane32_swap_b32 v56, v58
    v_permlane32_swap_b32 v57, v59
    v_xor_b32 v221, 64, v218
    ds_write_b128 v221, v[52:55]
    v_xor_b32 v221, 96, v218
    ds_write_b128 v221, v[56:59]
    s_waitcnt lgkmcnt(0)
    ds_read_b128 v[44:47], v219 offset:0
    ds_read_b128 v[48:51], v219 offset:1024
    ds_read_b128 v[60:63], v219 offset:2048
    ds_read_b128 v[64:67], v219 offset:3072
    s_waitcnt lgkmcnt(3)
    buffer_store_dwordx4 v[44:47], v220, s[12:15], s25 offen
    s_add_u32 s25, s25, s26
    s_waitcnt lgkmcnt(2)
    buffer_store_dwordx4 v[48:51], v220, s[12:15], s25 offen
    s_add_u32 s25, s25, s26
    s_waitcnt lgkmcnt(1)
    buffer_store_dwordx4 v[60:63], v220, s[12:15], s25 offen
    s_add_u32 s25, s25, s26
    s_waitcnt lgkmcnt(0)
    buffer_store_dwordx4 v[64:67], v220, s[12:15], s25 offen
    s_add_u32 s25, s25, s26
    v_mul_f32 v68, s23, v68
    v_mul_f32 v69, s23, v69
    v_mul_f32 v70, s23, v70
    v_mul_f32 v71, s23, v71
    v_mul_f32 v72, s23, v72
    v_mul_f32 v73, s23, v73
    v_mul_f32 v74, s23, v74
    v_mul_f32 v75, s23, v75
    v_mul_f32 v76, s23, v76
    v_mul_f32 v77, s23, v77
    v_mul_f32 v78, s23, v78
    v_mul_f32 v79, s23, v79
    v_mul_f32 v80, s23, v80
    v_mul_f32 v81, s23, v81
    v_mul_f32 v82, s23, v82
    v_mul_f32 v83, s23, v83
    v_cvt_pk_bf16_f32 v68, v68, v69
    v_cvt_pk_bf16_f32 v69, v70, v71
    v_cvt_pk_bf16_f32 v70, v72, v73
    v_cvt_pk_bf16_f32 v71, v74, v75
    v_cvt_pk_bf16_f32 v72, v76, v77
    v_cvt_pk_bf16_f32 v73, v78, v79
    v_cvt_pk_bf16_f32 v74, v80, v81
    v_cvt_pk_bf16_f32 v75, v82, v83
    s_nop 1
    v_permlane32_swap_b32 v68, v70
    v_permlane32_swap_b32 v69, v71
    v_permlane32_swap_b32 v72, v74
    v_permlane32_swap_b32 v73, v75
    s_nop 0
    ds_write_b128 v218, v[68:71]
    v_xor_b32 v221, 32, v218
    ds_write_b128 v221, v[72:75]
    v_mul_f32 v84, s23, v84
    v_mul_f32 v85, s23, v85
    v_mul_f32 v86, s23, v86
    v_mul_f32 v87, s23, v87
    v_mul_f32 v88, s23, v88
    v_mul_f32 v89, s23, v89
    v_mul_f32 v90, s23, v90
    v_mul_f32 v91, s23, v91
    v_mul_f32 v92, s23, v92
    v_mul_f32 v93, s23, v93
    v_mul_f32 v94, s23, v94
    v_mul_f32 v95, s23, v95
    v_mul_f32 v96, s23, v96
    v_mul_f32 v97, s23, v97
    v_mul_f32 v98, s23, v98
    v_mul_f32 v99, s23, v99
    v_cvt_pk_bf16_f32 v84, v84, v85
    v_cvt_pk_bf16_f32 v85, v86, v87
    v_cvt_pk_bf16_f32 v86, v88, v89
    v_cvt_pk_bf16_f32 v87, v90, v91
    v_cvt_pk_bf16_f32 v88, v92, v93
    v_cvt_pk_bf16_f32 v89, v94, v95
    v_cvt_pk_bf16_f32 v90, v96, v97
    v_cvt_pk_bf16_f32 v91, v98, v99
    s_nop 1
    v_permlane32_swap_b32 v84, v86
    v_permlane32_swap_b32 v85, v87
    v_permlane32_swap_b32 v88, v90
    v_permlane32_swap_b32 v89, v91
    v_xor_b32 v221, 64, v218
    ds_write_b128 v221, v[84:87]
    v_xor_b32 v221, 96, v218
    ds_write_b128 v221, v[88:91]
    s_waitcnt lgkmcnt(0)
    ds_read_b128 v[76:79], v219 offset:0
    ds_read_b128 v[80:83], v219 offset:1024
    ds_read_b128 v[92:95], v219 offset:2048
    ds_read_b128 v[96:99], v219 offset:3072
    s_waitcnt lgkmcnt(3)
    buffer_store_dwordx4 v[76:79], v220, s[12:15], s25 offen
    s_add_u32 s25, s25, s26
    s_waitcnt lgkmcnt(2)
    buffer_store_dwordx4 v[80:83], v220, s[12:15], s25 offen
    s_add_u32 s25, s25, s26
    s_waitcnt lgkmcnt(1)
    buffer_store_dwordx4 v[92:95], v220, s[12:15], s25 offen
    s_add_u32 s25, s25, s26
    s_waitcnt lgkmcnt(0)
    buffer_store_dwordx4 v[96:99], v220, s[12:15], s25 offen
    s_add_u32 s25, s25, s26
    v_mul_f32 v100, s23, v100
    v_mul_f32 v101, s23, v101
    v_mul_f32 v102, s23, v102
    v_mul_f32 v103, s23, v103
    v_mul_f32 v104, s23, v104
    v_mul_f32 v105, s23, v105
    v_mul_f32 v106, s23, v106
    v_mul_f32 v107, s23, v107
    v_mul_f32 v108, s23, v108
    v_mul_f32 v109, s23, v109
    v_mul_f32 v110, s23, v110
    v_mul_f32 v111, s23, v111
    v_mul_f32 v112, s23, v112
    v_mul_f32 v113, s23, v113
    v_mul_f32 v114, s23, v114
    v_mul_f32 v115, s23, v115
    v_cvt_pk_bf16_f32 v100, v100, v101
    v_cvt_pk_bf16_f32 v101, v102, v103
    v_cvt_pk_bf16_f32 v102, v104, v105
    v_cvt_pk_bf16_f32 v103, v106, v107
    v_cvt_pk_bf16_f32 v104, v108, v109
    v_cvt_pk_bf16_f32 v105, v110, v111
    v_cvt_pk_bf16_f32 v106, v112, v113
    v_cvt_pk_bf16_f32 v107, v114, v115
    s_nop 1
    v_permlane32_swap_b32 v100, v102
    v_permlane32_swap_b32 v101, v103
    v_permlane32_swap_b32 v104, v106
    v_permlane32_swap_b32 v105, v107
    s_nop 0
    ds_write_b128 v218, v[100:103]
    v_xor_b32 v221, 32, v218
    ds_write_b128 v221, v[104:107]
    v_mul_f32 v116, s23, v116
    v_mul_f32 v117, s23, v117
    v_mul_f32 v118, s23, v118
    v_mul_f32 v119, s23, v119
    v_mul_f32 v120, s23, v120
    v_mul_f32 v121, s23, v121
    v_mul_f32 v122, s23, v122
    v_mul_f32 v123, s23, v123
    v_mul_f32 v124, s23, v124
    v_mul_f32 v125, s23, v125
    v_mul_f32 v126, s23, v126
    v_mul_f32 v127, s23, v127
    v_mul_f32 v128, s23, v128
    v_mul_f32 v129, s23, v129
    v_mul_f32 v130, s23, v130
    v_mul_f32 v131, s23, v131
    v_cvt_pk_bf16_f32 v116, v116, v117
    v_cvt_pk_bf16_f32 v117, v118, v119
    v_cvt_pk_bf16_f32 v118, v120, v121
    v_cvt_pk_bf16_f32 v119, v122, v123
    v_cvt_pk_bf16_f32 v120, v124, v125
    v_cvt_pk_bf16_f32 v121, v126, v127
    v_cvt_pk_bf16_f32 v122, v128, v129
    v_cvt_pk_bf16_f32 v123, v130, v131
    s_nop 1
    v_permlane32_swap_b32 v116, v118
    v_permlane32_swap_b32 v117, v119
    v_permlane32_swap_b32 v120, v122
    v_permlane32_swap_b32 v121, v123
    v_xor_b32 v221, 64, v218
    ds_write_b128 v221, v[116:119]
    v_xor_b32 v221, 96, v218
    ds_write_b128 v221, v[120:123]
    s_waitcnt lgkmcnt(0)
    ds_read_b128 v[108:111], v219 offset:0
    ds_read_b128 v[112:115], v219 offset:1024
    ds_read_b128 v[124:127], v219 offset:2048
    ds_read_b128 v[128:131], v219 offset:3072
    s_waitcnt lgkmcnt(3)
    buffer_store_dwordx4 v[108:111], v220, s[12:15], s25 offen
    s_add_u32 s25, s25, s26
    s_waitcnt lgkmcnt(2)
    buffer_store_dwordx4 v[112:115], v220, s[12:15], s25 offen
    s_add_u32 s25, s25, s26
    s_waitcnt lgkmcnt(1)
    buffer_store_dwordx4 v[124:127], v220, s[12:15], s25 offen
    s_add_u32 s25, s25, s26
    s_waitcnt lgkmcnt(0)
    buffer_store_dwordx4 v[128:131], v220, s[12:15], s25 offen
    s_add_u32 s25, s25, s26
    v_mul_f32 v132, s23, v132
    v_mul_f32 v133, s23, v133
    v_mul_f32 v134, s23, v134
    v_mul_f32 v135, s23, v135
    v_mul_f32 v136, s23, v136
    v_mul_f32 v137, s23, v137
    v_mul_f32 v138, s23, v138
    v_mul_f32 v139, s23, v139
    v_mul_f32 v140, s23, v140
    v_mul_f32 v141, s23, v141
    v_mul_f32 v142, s23, v142
    v_mul_f32 v143, s23, v143
    v_mul_f32 v144, s23, v144
    v_mul_f32 v145, s23, v145
    v_mul_f32 v146, s23, v146
    v_mul_f32 v147, s23, v147
    v_cvt_pk_bf16_f32 v132, v132, v133
    v_cvt_pk_bf16_f32 v133, v134, v135
    v_cvt_pk_bf16_f32 v134, v136, v137
    v_cvt_pk_bf16_f32 v135, v138, v139
    v_cvt_pk_bf16_f32 v136, v140, v141
    v_cvt_pk_bf16_f32 v137, v142, v143
    v_cvt_pk_bf16_f32 v138, v144, v145
    v_cvt_pk_bf16_f32 v139, v146, v147
    s_nop 1
    v_permlane32_swap_b32 v132, v134
    v_permlane32_swap_b32 v133, v135
    v_permlane32_swap_b32 v136, v138
    v_permlane32_swap_b32 v137, v139
    s_nop 0
    ds_write_b128 v218, v[132:135]
    v_xor_b32 v221, 32, v218
    ds_write_b128 v221, v[136:139]
    v_mul_f32 v148, s23, v148
    v_mul_f32 v149, s23, v149
    v_mul_f32 v150, s23, v150
    v_mul_f32 v151, s23, v151
    v_mul_f32 v152, s23, v152
    v_mul_f32 v153, s23, v153
    v_mul_f32 v154, s23, v154
    v_mul_f32 v155, s23, v155
    v_mul_f32 v156, s23, v156
    v_mul_f32 v157, s23, v157
    v_mul_f32 v158, s23, v158
    v_mul_f32 v159, s23, v159
    v_mul_f32 v160, s23, v160
    v_mul_f32 v161, s23, v161
    v_mul_f32 v162, s23, v162
    v_mul_f32 v163, s23, v163
    v_cvt_pk_bf16_f32 v148, v148, v149
    v_cvt_pk_bf16_f32 v149, v150, v151
    v_cvt_pk_bf16_f32 v150, v152, v153
    v_cvt_pk_bf16_f32 v151, v154, v155
    v_cvt_pk_bf16_f32 v152, v156, v157
    v_cvt_pk_bf16_f32 v153, v158, v159
    v_cvt_pk_bf16_f32 v154, v160, v161
    v_cvt_pk_bf16_f32 v155, v162, v163
    s_nop 1
    v_permlane32_swap_b32 v148, v150
    v_permlane32_swap_b32 v149, v151
    v_permlane32_swap_b32 v152, v154
    v_permlane32_swap_b32 v153, v155
    v_xor_b32 v221, 64, v218
    ds_write_b128 v221, v[148:151]
    v_xor_b32 v221, 96, v218
    ds_write_b128 v221, v[152:155]
    s_waitcnt lgkmcnt(0)
    ds_read_b128 v[140:143], v219 offset:0
    ds_read_b128 v[144:147], v219 offset:1024
    ds_read_b128 v[156:159], v219 offset:2048
    ds_read_b128 v[160:163], v219 offset:3072
    s_waitcnt lgkmcnt(3)
    buffer_store_dwordx4 v[140:143], v220, s[12:15], s25 offen
    s_add_u32 s25, s25, s26
    s_waitcnt lgkmcnt(2)
    buffer_store_dwordx4 v[144:147], v220, s[12:15], s25 offen
    s_add_u32 s25, s25, s26
    s_waitcnt lgkmcnt(1)
    buffer_store_dwordx4 v[156:159], v220, s[12:15], s25 offen
    s_add_u32 s25, s25, s26
    s_waitcnt lgkmcnt(0)
    buffer_store_dwordx4 v[160:163], v220, s[12:15], s25 offen
    s_add_u32 s25, s25, s26
    s_nop 1
    s_add_u32 s12, s74, 0x4000000
    s_addc_u32 s13, s75, 0
    s_and_b32 s13, s13, 0xffff
    s_mov_b32 s14, 0x400000
    s_mov_b32 s15, 0x20000
    s_mov_b32 s23, 0x3e8293ee
    s_mov_b32 s22, 2048
    s_add_u32 s21, s19, s20
    s_and_b32 s53, s24, 3
    s_lshr_b32 s54, s24, 2
    s_mul_i32 s25, s53, 32
    v_and_b32 v2, 31, v1
    v_add_u32 v2, s25, v2
    v_lshrrev_b32 v3, 1, v2
    v_and_b32 v3, 7, v3
    v_lshrrev_b32 v4, 5, v1
    v_xor_b32 v3, v3, v4
    v_lshlrev_b32 v2, 7, v2
    v_xor_b32 v4, 0, v3
    v_lshl_add_u32 v31, v4, 4, v2
    v_xor_b32 v4, 2, v3
    v_lshl_add_u32 v32, v4, 4, v2
    v_xor_b32 v4, 4, v3
    v_lshl_add_u32 v33, v4, 4, v2
    v_xor_b32 v4, 6, v3
    v_lshl_add_u32 v34, v4, 4, v2
    v_lshrrev_b32 v2, 5, v1
    v_lshlrev_b32 v2, 3, v2
    v_bfe_u32 v3, v1, 2, 2
    v_add_u32 v2, v2, v3
    v_and_b32 v3, 3, v2
    v_lshlrev_b32 v3, 2, v3
    v_lshlrev_b32 v2, 8, v2
    s_mul_i32 s25, s54, 8
    s_add_u32 s25, s25, 0
    v_bfe_u32 v4, v1, 4, 1
    v_lshlrev_b32 v4, 1, v4
    v_bfe_u32 v5, v1, 1, 1
    v_add3_u32 v4, v4, v5, s25
    v_xor_b32 v4, v4, v3
    v_lshl_add_u32 v4, v4, 4, v2
    v_and_b32 v5, 1, v1
    v_lshl_add_u32 v4, v5, 3, v4
    v_add_u32 v35, 16384, v4
    s_mul_i32 s25, s54, 8
    s_add_u32 s25, s25, 4
    v_bfe_u32 v4, v1, 4, 1
    v_lshlrev_b32 v4, 1, v4
    v_bfe_u32 v5, v1, 1, 1
    v_add3_u32 v4, v4, v5, s25
    v_xor_b32 v4, v4, v3
    v_lshl_add_u32 v4, v4, 4, v2
    v_and_b32 v5, 1, v1
    v_lshl_add_u32 v4, v5, 3, v4
    v_add_u32 v36, 16384, v4
    v_mov_b32 v40, 0
    v_mov_b32 v41, 0
    v_mov_b32 v42, 0
    v_mov_b32 v43, 0
    v_mov_b32 v44, 0
    v_mov_b32 v45, 0
    v_mov_b32 v46, 0
    v_mov_b32 v47, 0
    v_mov_b32 v48, 0
    v_mov_b32 v49, 0
    v_mov_b32 v50, 0
    v_mov_b32 v51, 0
    v_mov_b32 v52, 0
    v_mov_b32 v53, 0
    v_mov_b32 v54, 0
    v_mov_b32 v55, 0
    v_mov_b32 v56, 0
    v_mov_b32 v57, 0
    v_mov_b32 v58, 0
    v_mov_b32 v59, 0
    v_mov_b32 v60, 0
    v_mov_b32 v61, 0
    v_mov_b32 v62, 0
    v_mov_b32 v63, 0
    v_mov_b32 v64, 0
    v_mov_b32 v65, 0
    v_mov_b32 v66, 0
    v_mov_b32 v67, 0
    v_mov_b32 v68, 0
    v_mov_b32 v69, 0
    v_mov_b32 v70, 0
    v_mov_b32 v71, 0
    s_waitcnt vmcnt(20)
    s_barrier
    ds_read_b128 v[72:75], v31 offset:0
    ds_read_b64_tr_b16 v[104:105], v35 offset:0
    ds_read_b64_tr_b16 v[106:107], v35 offset:1024
    ds_read_b64_tr_b16 v[108:109], v36 offset:0
    ds_read_b64_tr_b16 v[110:111], v36 offset:1024
    ds_read_b128 v[76:79], v32 offset:0
    ds_read_b64_tr_b16 v[112:113], v35 offset:4096
    ds_read_b64_tr_b16 v[114:115], v35 offset:5120
    ds_read_b64_tr_b16 v[116:117], v36 offset:4096
    ds_read_b64_tr_b16 v[118:119], v36 offset:5120
    ds_read_b128 v[80:83], v33 offset:0
    ds_read_b64_tr_b16 v[120:121], v35 offset:8192
    ds_read_b64_tr_b16 v[122:123], v35 offset:9216
    ds_read_b64_tr_b16 v[124:125], v36 offset:8192
    ds_read_b64_tr_b16 v[126:127], v36 offset:9216
    ds_read_b128 v[84:87], v34 offset:0
    ds_read_b64_tr_b16 v[128:129], v35 offset:12288
    ds_read_b64_tr_b16 v[130:131], v35 offset:13312
    ds_read_b64_tr_b16 v[132:133], v36 offset:12288
    ds_read_b64_tr_b16 v[134:135], v36 offset:13312
    s_mov_b32 s46, 12
L_proj_kernel_main_7:
    v_add_u32 v168, s45, v31
    v_add_u32 v169, s45, v32
    v_add_u32 v170, s45, v33
    v_add_u32 v171, s45, v34
    v_add_u32 v172, s45, v35
    v_add_u32 v173, s45, v36
    s_waitcnt lgkmcnt(0)
    v_mfma_f32_32x32x16_bf16 v[40:55], v[104:107], v[72:75], v[40:55]
    ds_read_b128 v[88:91], v168 offset:0
    ds_read_b64_tr_b16 v[136:137], v172 offset:0
    ds_read_b64_tr_b16 v[138:139], v172 offset:1024
    ds_read_b64_tr_b16 v[140:141], v173 offset:0
    v_mfma_f32_32x32x16_bf16 v[56:71], v[108:111], v[72:75], v[56:71]
    s_add_u32 s50, s43, s47
    s_add_u32 m0, s50, 0
    s_nop 0
    buffer_load_dwordx4 v14, s[4:7], s41 offen lds
    ds_read_b64_tr_b16 v[142:143], v173 offset:1024
    ds_read_b128 v[92:95], v169 offset:0
    ds_read_b64_tr_b16 v[144:145], v172 offset:4096
    v_mfma_f32_32x32x16_bf16 v[40:55], v[112:115], v[76:79], v[40:55]
    ds_read_b64_tr_b16 v[146:147], v172 offset:5120
    s_add_u32 m0, s50, 1024
    s_nop 0
    buffer_load_dwordx4 v15, s[4:7], s41 offen lds
    ds_read_b64_tr_b16 v[148:149], v173 offset:4096
    ds_read_b64_tr_b16 v[150:151], v173 offset:5120
    v_mfma_f32_32x32x16_bf16 v[56:71], v[116:119], v[76:79], v[56:71]
    ds_read_b128 v[96:99], v170 offset:0
    ds_read_b64_tr_b16 v[152:153], v172 offset:8192
    s_add_u32 s51, s43, s48
    s_add_u32 m0, s51, 0
    s_nop 0
    buffer_load_dwordx4 v16, s[8:11], s42 offen lds
    ds_read_b64_tr_b16 v[154:155], v172 offset:9216
    v_mfma_f32_32x32x16_bf16 v[40:55], v[120:123], v[80:83], v[40:55]
    ds_read_b64_tr_b16 v[156:157], v173 offset:8192
    ds_read_b64_tr_b16 v[158:159], v173 offset:9216
    ds_read_b128 v[100:103], v171 offset:0
    s_add_u32 m0, s51, 1024
    s_nop 0
    buffer_load_dwordx4 v17, s[8:11], s42 offen lds
    v_mfma_f32_32x32x16_bf16 v[56:71], v[124:127], v[80:83], v[56:71]
    ds_read_b64_tr_b16 v[160:161], v172 offset:12288
    ds_read_b64_tr_b16 v[162:163], v172 offset:13312
    ds_read_b64_tr_b16 v[164:165], v173 offset:12288
    ds_read_b64_tr_b16 v[166:167], v173 offset:13312
    v_mfma_f32_32x32x16_bf16 v[40:55], v[128:131], v[84:87], v[40:55]
    s_add_u32 s41, s41, 128
    s_add_u32 s42, s42, s49
    s_add_u32 s43, s43, 32768
    s_cmp_eq_u32 s43, 131072
    s_cselect_b32 s43, 0, s43
    v_mfma_f32_32x32x16_bf16 v[56:71], v[132:135], v[84:87], v[56:71]
    s_add_u32 s45, s45, 32768
    s_cmp_eq_u32 s45, 131072
    s_cselect_b32 s45, 0, s45
    s_waitcnt vmcnt(4)
    s_barrier
    v_add_u32 v168, s45, v31
    v_add_u32 v169, s45, v32
    v_add_u32 v170, s45, v33
    v_add_u32 v171, s45, v34
    v_add_u32 v172, s45, v35
    v_add_u32 v173, s45, v36
    s_waitcnt lgkmcnt(0)
    v_mfma_f32_32x32x16_bf16 v[40:55], v[136:139], v[88:91], v[40:55]
    ds_read_b128 v[72:75], v168 offset:0
    ds_read_b64_tr_b16 v[104:105], v172 offset:0
    ds_read_b64_tr_b16 v[106:107], v172 offset:1024
    ds_read_b64_tr_b16 v[108:109], v173 offset:0
    v_mfma_f32_32x32x16_bf16 v[56:71], v[140:143], v[88:91], v[56:71]
    s_add_u32 s50, s43, s47
    s_add_u32 m0, s50, 0
    s_nop 0
    buffer_load_dwordx4 v14, s[4:7], s41 offen lds
    ds_read_b64_tr_b16 v[110:111], v173 offset:1024
    ds_read_b128 v[76:79], v169 offset:0
    ds_read_b64_tr_b16 v[112:113], v172 offset:4096
    v_mfma_f32_32x32x16_bf16 v[40:55], v[144:147], v[92:95], v[40:55]
    ds_read_b64_tr_b16 v[114:115], v172 offset:5120
    s_add_u32 m0, s50, 1024
    s_nop 0
    buffer_load_dwordx4 v15, s[4:7], s41 offen lds
    ds_read_b64_tr_b16 v[116:117], v173 offset:4096
    ds_read_b64_tr_b16 v[118:119], v173 offset:5120
    v_mfma_f32_32x32x16_bf16 v[56:71], v[148:151], v[92:95], v[56:71]
    ds_read_b128 v[80:83], v170 offset:0
    ds_read_b64_tr_b16 v[120:121], v172 offset:8192
    s_add_u32 s51, s43, s48
    s_add_u32 m0, s51, 0
    s_nop 0
    buffer_load_dwordx4 v16, s[8:11], s42 offen lds
    ds_read_b64_tr_b16 v[122:123], v172 offset:9216
    v_mfma_f32_32x32x16_bf16 v[40:55], v[152:155], v[96:99], v[40:55]
    ds_read_b64_tr_b16 v[124:125], v173 offset:8192
    ds_read_b64_tr_b16 v[126:127], v173 offset:9216
    ds_read_b128 v[84:87], v171 offset:0
    s_add_u32 m0, s51, 1024
    s_nop 0
    buffer_load_dwordx4 v17, s[8:11], s42 offen lds
    v_mfma_f32_32x32x16_bf16 v[56:71], v[156:159], v[96:99], v[56:71]
    ds_read_b64_tr_b16 v[128:129], v172 offset:12288
    ds_read_b64_tr_b16 v[130:131], v172 offset:13312
    ds_read_b64_tr_b16 v[132:133], v173 offset:12288
    ds_read_b64_tr_b16 v[134:135], v173 offset:13312
    v_mfma_f32_32x32x16_bf16 v[40:55], v[160:163], v[100:103], v[40:55]
    s_add_u32 s41, s41, 128
    s_add_u32 s42, s42, s49
    s_add_u32 s43, s43, 32768
    s_cmp_eq_u32 s43, 131072
    s_cselect_b32 s43, 0, s43
    v_mfma_f32_32x32x16_bf16 v[56:71], v[164:167], v[100:103], v[56:71]
    s_add_u32 s45, s45, 32768
    s_cmp_eq_u32 s45, 131072
    s_cselect_b32 s45, 0, s45
    s_waitcnt vmcnt(4)
    s_barrier
    s_sub_u32 s46, s46, 2
    s_cmp_lg_u32 s46, 0
    s_cbranch_scc1 L_proj_kernel_main_7
    v_add_u32 v168, s45, v31
    v_add_u32 v169, s45, v32
    v_add_u32 v170, s45, v33
    v_add_u32 v171, s45, v34
    v_add_u32 v172, s45, v35
    v_add_u32 v173, s45, v36
    s_waitcnt lgkmcnt(0)
    v_mfma_f32_32x32x16_bf16 v[40:55], v[104:107], v[72:75], v[40:55]
    ds_read_b128 v[88:91], v168 offset:0
    ds_read_b64_tr_b16 v[136:137], v172 offset:0
    ds_read_b64_tr_b16 v[138:139], v172 offset:1024
    ds_read_b64_tr_b16 v[140:141], v173 offset:0
    v_mfma_f32_32x32x16_bf16 v[56:71], v[108:111], v[72:75], v[56:71]
    s_add_u32 s50, s43, s47
    s_add_u32 m0, s50, 0
    s_nop 0
    buffer_load_dwordx4 v14, s[4:7], s41 offen lds
    ds_read_b64_tr_b16 v[142:143], v173 offset:1024
    ds_read_b128 v[92:95], v169 offset:0
    ds_read_b64_tr_b16 v[144:145], v172 offset:4096
    v_mfma_f32_32x32x16_bf16 v[40:55], v[112:115], v[76:79], v[40:55]
    ds_read_b64_tr_b16 v[146:147], v172 offset:5120
    s_add_u32 m0, s50, 1024
    s_nop 0
    buffer_load_dwordx4 v15, s[4:7], s41 offen lds
    ds_read_b64_tr_b16 v[148:149], v173 offset:4096
    ds_read_b64_tr_b16 v[150:151], v173 offset:5120
    v_mfma_f32_32x32x16_bf16 v[56:71], v[116:119], v[76:79], v[56:71]
    ds_read_b128 v[96:99], v170 offset:0
    ds_read_b64_tr_b16 v[152:153], v172 offset:8192
    s_add_u32 s51, s43, s48
    s_add_u32 m0, s51, 0
    s_nop 0
    buffer_load_dwordx4 v16, s[8:11], s42 offen lds
    ds_read_b64_tr_b16 v[154:155], v172 offset:9216
    v_mfma_f32_32x32x16_bf16 v[40:55], v[120:123], v[80:83], v[40:55]
    ds_read_b64_tr_b16 v[156:157], v173 offset:8192
    ds_read_b64_tr_b16 v[158:159], v173 offset:9216
    ds_read_b128 v[100:103], v171 offset:0
    s_add_u32 m0, s51, 1024
    s_nop 0
    buffer_load_dwordx4 v17, s[8:11], s42 offen lds
    v_mfma_f32_32x32x16_bf16 v[56:71], v[124:127], v[80:83], v[56:71]
    ds_read_b64_tr_b16 v[160:161], v172 offset:12288
    ds_read_b64_tr_b16 v[162:163], v172 offset:13312
    ds_read_b64_tr_b16 v[164:165], v173 offset:12288
    ds_read_b64_tr_b16 v[166:167], v173 offset:13312
    v_mfma_f32_32x32x16_bf16 v[40:55], v[128:131], v[84:87], v[40:55]
    s_add_u32 s41, s41, 128
    s_add_u32 s42, s42, s49
    s_add_u32 s43, s43, 32768
    s_cmp_eq_u32 s43, 131072
    s_cselect_b32 s43, 0, s43
    v_mfma_f32_32x32x16_bf16 v[56:71], v[132:135], v[84:87], v[56:71]
    s_add_u32 s45, s45, 32768
    s_cmp_eq_u32 s45, 131072
    s_cselect_b32 s45, 0, s45
    s_waitcnt vmcnt(4)
    s_barrier
    v_add_u32 v168, s45, v31
    v_add_u32 v169, s45, v32
    v_add_u32 v170, s45, v33
    v_add_u32 v171, s45, v34
    v_add_u32 v172, s45, v35
    v_add_u32 v173, s45, v36
    s_waitcnt lgkmcnt(0)
    v_mfma_f32_32x32x16_bf16 v[40:55], v[136:139], v[88:91], v[40:55]
    ds_read_b128 v[72:75], v168 offset:0
    ds_read_b64_tr_b16 v[104:105], v172 offset:0
    ds_read_b64_tr_b16 v[106:107], v172 offset:1024
    v_mfma_f32_32x32x16_bf16 v[56:71], v[140:143], v[88:91], v[56:71]
    ds_read_b64_tr_b16 v[108:109], v173 offset:0
    ds_read_b64_tr_b16 v[110:111], v173 offset:1024
    ds_read_b128 v[76:79], v169 offset:0
    v_mfma_f32_32x32x16_bf16 v[40:55], v[144:147], v[92:95], v[40:55]
    ds_read_b64_tr_b16 v[112:113], v172 offset:4096
    ds_read_b64_tr_b16 v[114:115], v172 offset:5120
    ds_read_b64_tr_b16 v[116:117], v173 offset:4096
    v_mfma_f32_32x32x16_bf16 v[56:71], v[148:151], v[92:95], v[56:71]
    ds_read_b64_tr_b16 v[118:119], v173 offset:5120
    ds_read_b128 v[80:83], v170 offset:0
    ds_read_b64_tr_b16 v[120:121], v172 offset:8192
    v_mfma_f32_32x32x16_bf16 v[40:55], v[152:155], v[96:99], v[40:55]
    ds_read_b64_tr_b16 v[122:123], v172 offset:9216
    ds_read_b64_tr_b16 v[124:125], v173 offset:8192
    ds_read_b64_tr_b16 v[126:127], v173 offset:9216
    v_mfma_f32_32x32x16_bf16 v[56:71], v[156:159], v[96:99], v[56:71]
    ds_read_b128 v[84:87], v171 offset:0
    ds_read_b64_tr_b16 v[128:129], v172 offset:12288
    ds_read_b64_tr_b16 v[130:131], v172 offset:13312
    v_mfma_f32_32x32x16_bf16 v[40:55], v[160:163], v[100:103], v[40:55]
    ds_read_b64_tr_b16 v[132:133], v173 offset:12288
    ds_read_b64_tr_b16 v[134:135], v173 offset:13312
    v_mfma_f32_32x32x16_bf16 v[56:71], v[164:167], v[100:103], v[56:71]
    s_add_u32 s45, s45, 32768
    s_cmp_eq_u32 s45, 131072
    s_cselect_b32 s45, 0, s45
    s_waitcnt vmcnt(0)
    s_barrier
    v_add_u32 v168, s45, v31
    v_add_u32 v169, s45, v32
    v_add_u32 v170, s45, v33
    v_add_u32 v171, s45, v34
    v_add_u32 v172, s45, v35
    v_add_u32 v173, s45, v36
    s_waitcnt lgkmcnt(0)
    v_mfma_f32_32x32x16_bf16 v[40:55], v[104:107], v[72:75], v[40:55]
    ds_read_b128 v[88:91], v168 offset:0
    ds_read_b64_tr_b16 v[136:137], v172 offset:0
    ds_read_b64_tr_b16 v[138:139], v172 offset:1024
    v_mfma_f32_32x32x16_bf16 v[56:71], v[108:111], v[72:75], v[56:71]
    ds_read_b64_tr_b16 v[140:141], v173 offset:0
    ds_read_b64_tr_b16 v[142:143], v173 offset:1024
    ds_read_b128 v[92:95], v169 offset:0
    v_mfma_f32_32x32x16_bf16 v[40:55], v[112:115], v[76:79], v[40:55]
    ds_read_b64_tr_b16 v[144:145], v172 offset:4096
    ds_read_b64_tr_b16 v[146:147], v172 offset:5120
    ds_read_b64_tr_b16 v[148:149], v173 offset:4096
    v_mfma_f32_32x32x16_bf16 v[56:71], v[116:119], v[76:79], v[56:71]
    ds_read_b64_tr_b16 v[150:151], v173 offset:5120
    ds_read_b128 v[96:99], v170 offset:0
    ds_read_b64_tr_b16 v[152:153], v172 offset:8192
    v_mfma_f32_32x32x16_bf16 v[40:55], v[120:123], v[80:83], v[40:55]
    ds_read_b64_tr_b16 v[154:155], v172 offset:9216
    ds_read_b64_tr_b16 v[156:157], v173 offset:8192
    ds_read_b64_tr_b16 v[158:159], v173 offset:9216
    v_mfma_f32_32x32x16_bf16 v[56:71], v[124:127], v[80:83], v[56:71]
    ds_read_b128 v[100:103], v171 offset:0
    ds_read_b64_tr_b16 v[160:161], v172 offset:12288
    ds_read_b64_tr_b16 v[162:163], v172 offset:13312
    v_mfma_f32_32x32x16_bf16 v[40:55], v[128:131], v[84:87], v[40:55]
    ds_read_b64_tr_b16 v[164:165], v173 offset:12288
    ds_read_b64_tr_b16 v[166:167], v173 offset:13312
    v_mfma_f32_32x32x16_bf16 v[56:71], v[132:135], v[84:87], v[56:71]
    s_add_u32 s45, s45, 32768
    s_cmp_eq_u32 s45, 131072
    s_cselect_b32 s45, 0, s45
    s_waitcnt vmcnt(0)
    s_barrier
    v_add_u32 v168, s45, v31
    v_add_u32 v169, s45, v32
    v_add_u32 v170, s45, v33
    v_add_u32 v171, s45, v34
    v_add_u32 v172, s45, v35
    v_add_u32 v173, s45, v36
    s_waitcnt lgkmcnt(0)
    v_mfma_f32_32x32x16_bf16 v[40:55], v[136:139], v[88:91], v[40:55]
    ds_read_b128 v[72:75], v168 offset:0
    ds_read_b64_tr_b16 v[104:105], v172 offset:0
    ds_read_b64_tr_b16 v[106:107], v172 offset:1024
    v_mfma_f32_32x32x16_bf16 v[56:71], v[140:143], v[88:91], v[56:71]
    ds_read_b64_tr_b16 v[108:109], v173 offset:0
    ds_read_b64_tr_b16 v[110:111], v173 offset:1024
    ds_read_b128 v[76:79], v169 offset:0
    v_mfma_f32_32x32x16_bf16 v[40:55], v[144:147], v[92:95], v[40:55]
    ds_read_b64_tr_b16 v[112:113], v172 offset:4096
    ds_read_b64_tr_b16 v[114:115], v172 offset:5120
    ds_read_b64_tr_b16 v[116:117], v173 offset:4096
    v_mfma_f32_32x32x16_bf16 v[56:71], v[148:151], v[92:95], v[56:71]
    ds_read_b64_tr_b16 v[118:119], v173 offset:5120
    ds_read_b128 v[80:83], v170 offset:0
    ds_read_b64_tr_b16 v[120:121], v172 offset:8192
    v_mfma_f32_32x32x16_bf16 v[40:55], v[152:155], v[96:99], v[40:55]
    ds_read_b64_tr_b16 v[122:123], v172 offset:9216
    ds_read_b64_tr_b16 v[124:125], v173 offset:8192
    ds_read_b64_tr_b16 v[126:127], v173 offset:9216
    v_mfma_f32_32x32x16_bf16 v[56:71], v[156:159], v[96:99], v[56:71]
    ds_read_b128 v[84:87], v171 offset:0
    ds_read_b64_tr_b16 v[128:129], v172 offset:12288
    ds_read_b64_tr_b16 v[130:131], v172 offset:13312
    v_mfma_f32_32x32x16_bf16 v[40:55], v[160:163], v[100:103], v[40:55]
    ds_read_b64_tr_b16 v[132:133], v173 offset:12288
    ds_read_b64_tr_b16 v[134:135], v173 offset:13312
    v_mfma_f32_32x32x16_bf16 v[56:71], v[164:167], v[100:103], v[56:71]
    s_add_u32 s45, s45, 32768
    s_cmp_eq_u32 s45, 131072
    s_cselect_b32 s45, 0, s45
    s_waitcnt vmcnt(0)
    s_barrier
    s_waitcnt lgkmcnt(0)
    s_nop 15
    s_lshl_b32 s25, s24, 12
    s_add_u32 s25, s25, 131072
    v_and_b32 v179, 31, v1
    v_lshlrev_b32 v176, 7, v179
    v_add_u32 v176, s25, v176
    v_and_b32 v179, 7, v179
    v_lshrrev_b32 v177, 5, v1
    v_xor_b32 v179, v179, v177
    v_lshl_add_u32 v176, v179, 4, v176
    v_lshrrev_b32 v179, 3, v1
    v_xor_b32 v177, v179, v1
    v_and_b32 v177, 7, v177
    v_lshlrev_b32 v177, 4, v177
    v_lshl_add_u32 v177, v179, 7, v177
    v_add_u32 v177, s25, v177
    v_mul_lo_u32 v178, v179, s22
    v_and_b32 v179, 7, v1
    v_lshl_add_u32 v178, v179, 4, v178
    s_mul_i32 s25, s53, 32
    s_mul_i32 s25, s25, s22
    s_add_u32 s25, s25, s21
    s_mul_i32 s26, s54, 128
    s_add_u32 s25, s25, s26
    s_mul_i32 s26, s22, 8
    v_mul_f32 v40, s23, v40
    v_mul_f32 v41, s23, v41
    v_mul_f32 v42, s23, v42
    v_mul_f32 v43, s23, v43
    v_mul_f32 v44, s23, v44
    v_mul_f32 v45, s23, v45
    v_mul_f32 v46, s23, v46
    v_mul_f32 v47, s23, v47
    v_mul_f32 v48, s23, v48
    v_mul_f32 v49, s23, v49
    v_mul_f32 v50, s23, v50
    v_mul_f32 v51, s23, v51
    v_mul_f32 v52, s23, v52
    v_mul_f32 v53, s23, v53
    v_mul_f32 v54, s23, v54
    v_mul_f32 v55, s23, v55
    v_cvt_pk_bf16_f32 v40, v40, v41
    v_cvt_pk_bf16_f32 v41, v42, v43
    v_cvt_pk_bf16_f32 v42, v44, v45
    v_cvt_pk_bf16_f32 v43, v46, v47
    v_cvt_pk_bf16_f32 v44, v48, v49
    v_cvt_pk_bf16_f32 v45, v50, v51
    v_cvt_pk_bf16_f32 v46, v52, v53
    v_cvt_pk_bf16_f32 v47, v54, v55
    s_nop 1
    v_permlane32_swap_b32 v40, v42
    v_permlane32_swap_b32 v41, v43
    v_permlane32_swap_b32 v44, v46
    v_permlane32_swap_b32 v45, v47
    s_nop 0
    ds_write_b128 v176, v[40:43]
    v_xor_b32 v179, 32, v176
    ds_write_b128 v179, v[44:47]
    v_mul_f32 v56, s23, v56
    v_mul_f32 v57, s23, v57
    v_mul_f32 v58, s23, v58
    v_mul_f32 v59, s23, v59
    v_mul_f32 v60, s23, v60
    v_mul_f32 v61, s23, v61
    v_mul_f32 v62, s23, v62
    v_mul_f32 v63, s23, v63
    v_mul_f32 v64, s23, v64
    v_mul_f32 v65, s23, v65
    v_mul_f32 v66, s23, v66
    v_mul_f32 v67, s23, v67
    v_mul_f32 v68, s23, v68
    v_mul_f32 v69, s23, v69
    v_mul_f32 v70, s23, v70
    v_mul_f32 v71, s23, v71
    v_cvt_pk_bf16_f32 v56, v56, v57
    v_cvt_pk_bf16_f32 v57, v58, v59
    v_cvt_pk_bf16_f32 v58, v60, v61
    v_cvt_pk_bf16_f32 v59, v62, v63
    v_cvt_pk_bf16_f32 v60, v64, v65
    v_cvt_pk_bf16_f32 v61, v66, v67
    v_cvt_pk_bf16_f32 v62, v68, v69
    v_cvt_pk_bf16_f32 v63, v70, v71
    s_nop 1
    v_permlane32_swap_b32 v56, v58
    v_permlane32_swap_b32 v57, v59
    v_permlane32_swap_b32 v60, v62
    v_permlane32_swap_b32 v61, v63
    v_xor_b32 v179, 64, v176
    ds_write_b128 v179, v[56:59]
    v_xor_b32 v179, 96, v176
    ds_write_b128 v179, v[60:63]
    s_waitcnt lgkmcnt(0)
    ds_read_b128 v[48:51], v177 offset:0
    ds_read_b128 v[52:55], v177 offset:1024
    ds_read_b128 v[64:67], v177 offset:2048
    ds_read_b128 v[68:71], v177 offset:3072
    s_waitcnt lgkmcnt(3)
    buffer_store_dwordx4 v[48:51], v178, s[12:15], s25 offen
    s_add_u32 s25, s25, s26
    s_waitcnt lgkmcnt(2)
    buffer_store_dwordx4 v[52:55], v178, s[12:15], s25 offen
    s_add_u32 s25, s25, s26
    s_waitcnt lgkmcnt(1)
    buffer_store_dwordx4 v[64:67], v178, s[12:15], s25 offen
    s_add_u32 s25, s25, s26
    s_waitcnt lgkmcnt(0)
    buffer_store_dwordx4 v[68:71], v178, s[12:15], s25 offen
    s_add_u32 s25, s25, s26
    s_nop 1
    s_branch L_proj_kernel_end_1
L_proj_kernel_kv_4:
    s_mov_b32 s4, s60
    s_and_b32 s5, s61, 0xffff
    s_mov_b32 s6, 0x200000
    s_mov_b32 s7, 0x20000
    s_mov_b32 s8, s62
    s_and_b32 s9, s63, 0xffff
    s_mov_b32 s10, 0x400000
    s_mov_b32 s11, 0x20000
    s_mov_b32 s16, 1024
    s_mov_b32 s17, 8192
    s_mov_b32 s18, 16
    s_lshl_b32 s19, s77, 18
    s_lshl_b32 s20, s78, 9
    s_mul_i32 s25, s24, 32
    s_add_u32 s25, s25, 0
    v_lshrrev_b32 v2, 2, v1
    v_add_u32 v2, s25, v2
    v_lshrrev_b32 v3, 2, v2
    v_and_b32 v3, 3, v3
    v_and_b32 v4, 3, v1
    v_xor_b32 v3, v3, v4
    v_mul_lo_u32 v2, v2, s16
    v_lshl_add_u32 v2, v3, 4, v2
    v_add_u32 v6, s19, v2
    s_mul_i32 s25, s24, 32
    s_add_u32 s25, s25, 16
    v_lshrrev_b32 v2, 2, v1
    v_add_u32 v2, s25, v2
    v_lshrrev_b32 v3, 2, v2
    v_and_b32 v3, 3, v3
    v_and_b32 v4, 3, v1
    v_xor_b32 v3, v3, v4
    v_mul_lo_u32 v2, v2, s16
    v_lshl_add_u32 v2, v3, 4, v2
    v_add_u32 v7, s19, v2
    s_mul_i32 s25, s24, 4
    s_add_u32 s25, s25, 0
    v_lshrrev_b32 v2, 5, v1
    v_add_u32 v2, s25, v2
    v_and_b32 v3, 3, v2
    v_lshlrev_b32 v3, 2, v3
    v_and_b32 v4, 31, v1
    v_xor_b32 v3, v3, v4
    v_mul_lo_u32 v2, v2, s17
    v_lshl_add_u32 v2, v3, 4, v2
    v_add_u32 v8, s20, v2
    s_mul_i32 s25, s24, 4
    s_add_u32 s25, s25, 2
    v_lshrrev_b32 v2, 5, v1
    v_add_u32 v2, s25, v2
    v_and_b32 v3, 3, v2
    v_lshlrev_b32 v3, 2, v3
    v_and_b32 v4, 31, v1
    v_xor_b32 v3, v3, v4
    v_mul_lo_u32 v2, v2, s17
    v_lshl_add_u32 v2, v3, 4, v2
    v_add_u32 v9, s20, v2
    s_mov_b32 s27, 0
    s_mov_b32 s28, 0
    s_mov_b32 s29, 0
    s_mov_b32 s30, 0
    s_mov_b32 s31, 32768
    s_mul_i32 s33, s24, 2048
    s_mul_i32 s34, s24, 2048
    s_add_u32 s34, s34, 16384
    s_mul_i32 s35, s17, 32
    s_mov_b32 s38, s18
    s_add_u32 s36, s29, s33
    s_add_u32 m0, s36, 0
    s_nop 0
    buffer_load_dwordx4 v6, s[4:7], s27 offen lds
    s_add_u32 m0, s36, 1024
    s_nop 0
    buffer_load_dwordx4 v7, s[4:7], s27 offen lds
    s_add_u32 s37, s29, s34
    s_add_u32 m0, s37, 0
    s_nop 0
    buffer_load_dwordx4 v8, s[8:11], s28 offen lds
    s_add_u32 m0, s37, 1024
    s_nop 0
    buffer_load_dwordx4 v9, s[8:11], s28 offen lds
    s_add_u32 s27, s27, 64
    s_add_u32 s28, s28, s35
    s_add_u32 s29, s29, 32768
    s_cmp_eq_u32 s29, 131072
    s_cselect_b32 s29, 0, s29
    s_add_u32 s36, s29, s33
    s_add_u32 m0, s36, 0
    s_nop 0
    buffer_load_dwordx4 v6, s[4:7], s27 offen lds
    s_add_u32 m0, s36, 1024
    s_nop 0
    buffer_load_dwordx4 v7, s[4:7], s27 offen lds
    s_add_u32 s37, s29, s34
    s_add_u32 m0, s37, 0
    s_nop 0
    buffer_load_dwordx4 v8, s[8:11], s28 offen lds
    s_add_u32 m0, s37, 1024
    s_nop 0
    buffer_load_dwordx4 v9, s[8:11], s28 offen lds
    s_add_u32 s27, s27, 64
    s_add_u32 s28, s28, s35
    s_add_u32 s29, s29, 32768
    s_cmp_eq_u32 s29, 131072
    s_cselect_b32 s29, 0, s29
    s_add_u32 s36, s29, s33
    s_add_u32 m0, s36, 0
    s_nop 0
    buffer_load_dwordx4 v6, s[4:7], s27 offen lds
    s_add_u32 m0, s36, 1024
    s_nop 0
    buffer_load_dwordx4 v7, s[4:7], s27 offen lds
    s_add_u32 s37, s29, s34
    s_add_u32 m0, s37, 0
    s_nop 0
    buffer_load_dwordx4 v8, s[8:11], s28 offen lds
    s_add_u32 m0, s37, 1024
    s_nop 0
    buffer_load_dwordx4 v9, s[8:11], s28 offen lds
    s_add_u32 s27, s27, 64
    s_add_u32 s28, s28, s35
    s_add_u32 s29, s29, 32768
    s_cmp_eq_u32 s29, 131072
    s_cselect_b32 s29, 0, s29
    v_lshlrev_b32 v28, 4, v0
    s_mov_b32 s80, s56
    s_and_b32 s81, s57, 0xffff
    s_mov_b32 s82, 0x400000
    s_mov_b32 s83, 0x20000
    s_mul_i32 s79, s2, 16384
    buffer_load_dwordx4 v[24:27], v28, s[80:83], s79 offen
    s_add_u32 s79, s79, 8192
    buffer_load_dwordx4 v[24:27], v28, s[80:83], s79 offen
    s_add_u32 s79, s79, 8192
    s_mov_b32 s80, s58
    s_and_b32 s81, s59, 0xffff
    s_mov_b32 s82, 0x800000
    s_mov_b32 s83, 0x20000
    s_mul_i32 s79, s2, 32768
    buffer_load_dwordx4 v[24:27], v28, s[80:83], s79 offen
    s_add_u32 s79, s79, 8192
    buffer_load_dwordx4 v[24:27], v28, s[80:83], s79 offen
    s_add_u32 s79, s79, 8192
    buffer_load_dwordx4 v[24:27], v28, s[80:83], s79 offen
    s_add_u32 s79, s79, 8192
    buffer_load_dwordx4 v[24:27], v28, s[80:83], s79 offen
    s_add_u32 s79, s79, 8192
    s_mov_b32 s80, s60
    s_and_b32 s81, s61, 0xffff
    s_mov_b32 s82, 0x200000
    s_mov_b32 s83, 0x20000
    s_mul_i32 s79, s2, 8192
    buffer_load_dwordx4 v[24:27], v28, s[80:83], s79 offen
    s_add_u32 s79, s79, 8192
    s_mov_b32 s80, s62
    s_and_b32 s81, s63, 0xffff
    s_mov_b32 s82, 0x400000
    s_mov_b32 s83, 0x20000
    s_mul_i32 s79, s2, 16384
    buffer_load_dwordx4 v[24:27], v28, s[80:83], s79 offen
    s_add_u32 s79, s79, 8192
    buffer_load_dwordx4 v[24:27], v28, s[80:83], s79 offen
    s_add_u32 s79, s79, 8192
    s_mov_b32 s80, s64
    s_and_b32 s81, s65, 0xffff
    s_mov_b32 s82, 0x400000
    s_mov_b32 s83, 0x20000
    s_mul_i32 s79, s2, 16384
    buffer_load_dwordx4 v[24:27], v28, s[80:83], s79 offen
    s_add_u32 s79, s79, 8192
    buffer_load_dwordx4 v[24:27], v28, s[80:83], s79 offen
    s_add_u32 s79, s79, 8192
    s_mov_b32 s80, s66
    s_and_b32 s81, s67, 0xffff
    s_mov_b32 s82, 0x400000
    s_mov_b32 s83, 0x20000
    s_mul_i32 s79, s2, 16384
    buffer_load_dwordx4 v[24:27], v28, s[80:83], s79 offen
    s_add_u32 s79, s79, 8192
    buffer_load_dwordx4 v[24:27], v28, s[80:83], s79 offen
    s_add_u32 s79, s79, 8192
    s_mov_b32 s80, s68
    s_and_b32 s81, s69, 0xffff
    s_mov_b32 s82, 0x200000
    s_mov_b32 s83, 0x20000
    s_mul_i32 s79, s2, 8192
    buffer_load_dwordx4 v[24:27], v28, s[80:83], s79 offen
    s_add_u32 s79, s79, 8192
    s_add_u32 s12, s74, 0x1000000
    s_addc_u32 s13, s75, 0
    s_and_b32 s13, s13, 0xffff
    s_mov_b32 s14, 0x1000000
    s_mov_b32 s15, 0x20000
    s_mov_b32 s23, 1.0
    s_mov_b32 s22, 256
    s_lshl_b32 s21, s78, 20
    s_lshl_b32 s79, s77, 16
    s_add_u32 s21, s21, s79
    s_lshr_b32 s79, s24, 2
    s_mul_i32 s79, s79, 524032
    s_add_u32 s21, s21, s79
    s_and_b32 s39, s24, 1
    s_lshr_b32 s40, s24, 1
    s_mul_i32 s25, s39, 128
    v_and_b32 v2, 31, v1
    v_add_u32 v2, s25, v2
    v_lshrrev_b32 v3, 2, v2
    v_and_b32 v3, 3, v3
    v_lshrrev_b32 v4, 5, v1
    v_xor_b32 v3, v3, v4
    v_lshlrev_b32 v2, 6, v2
    v_xor_b32 v4, 0, v3
    v_lshl_add_u32 v31, v4, 4, v2
    v_xor_b32 v4, 2, v3
    v_lshl_add_u32 v32, v4, 4, v2
    v_lshrrev_b32 v2, 5, v1
    v_lshlrev_b32 v2, 3, v2
    v_bfe_u32 v3, v1, 2, 2
    v_add_u32 v2, v2, v3
    v_and_b32 v3, 3, v2
    v_lshlrev_b32 v3, 2, v3
    v_lshlrev_b32 v2, 9, v2
    s_mul_i32 s25, s40, 8
    s_add_u32 s25, s25, 0
    v_bfe_u32 v4, v1, 4, 1
    v_lshlrev_b32 v4, 1, v4
    v_bfe_u32 v5, v1, 1, 1
    v_add3_u32 v4, v4, v5, s25
    v_xor_b32 v4, v4, v3
    v_lshl_add_u32 v4, v4, 4, v2
    v_and_b32 v5, 1, v1
    v_lshl_add_u32 v4, v5, 3, v4
    v_add_u32 v33, 16384, v4
    s_mul_i32 s25, s40, 8
    s_add_u32 s25, s25, 4
    v_bfe_u32 v4, v1, 4, 1
    v_lshlrev_b32 v4, 1, v4
    v_bfe_u32 v5, v1, 1, 1
    v_add3_u32 v4, v4, v5, s25
    v_xor_b32 v4, v4, v3
    v_lshl_add_u32 v4, v4, 4, v2
    v_and_b32 v5, 1, v1
    v_lshl_add_u32 v4, v5, 3, v4
    v_add_u32 v34, 16384, v4
    v_mov_b32 v36, 0
    v_mov_b32 v37, 0
    v_mov_b32 v38, 0
    v_mov_b32 v39, 0
    v_mov_b32 v40, 0
    v_mov_b32 v41, 0
    v_mov_b32 v42, 0
    v_mov_b32 v43, 0
    v_mov_b32 v44, 0
    v_mov_b32 v45, 0
    v_mov_b32 v46, 0
    v_mov_b32 v47, 0
    v_mov_b32 v48, 0
    v_mov_b32 v49, 0
    v_mov_b32 v50, 0
    v_mov_b32 v51, 0
    v_mov_b32 v52, 0
    v_mov_b32 v53, 0
    v_mov_b32 v54, 0
    v_mov_b32 v55, 0
    v_mov_b32 v56, 0
    v_mov_b32 v57, 0
    v_mov_b32 v58, 0
    v_mov_b32 v59, 0
    v_mov_b32 v60, 0
    v_mov_b32 v61, 0
    v_mov_b32 v62, 0
    v_mov_b32 v63, 0
    v_mov_b32 v64, 0
    v_mov_b32 v65, 0
    v_mov_b32 v66, 0
    v_mov_b32 v67, 0
    v_mov_b32 v68, 0
    v_mov_b32 v69, 0
    v_mov_b32 v70, 0
    v_mov_b32 v71, 0
    v_mov_b32 v72, 0
    v_mov_b32 v73, 0
    v_mov_b32 v74, 0
    v_mov_b32 v75, 0
    v_mov_b32 v76, 0
    v_mov_b32 v77, 0
    v_mov_b32 v78, 0
    v_mov_b32 v79, 0
    v_mov_b32 v80, 0
    v_mov_b32 v81, 0
    v_mov_b32 v82, 0
    v_mov_b32 v83, 0
    v_mov_b32 v84, 0
    v_mov_b32 v85, 0
    v_mov_b32 v86, 0
    v_mov_b32 v87, 0
    v_mov_b32 v88, 0
    v_mov_b32 v89, 0
    v_mov_b32 v90, 0
    v_mov_b32 v91, 0
    v_mov_b32 v92, 0
    v_mov_b32 v93, 0
    v_mov_b32 v94, 0
    v_mov_b32 v95, 0
    v_mov_b32 v96, 0
    v_mov_b32 v97, 0
    v_mov_b32 v98, 0
    v_mov_b32 v99, 0
    v_mov_b32 v100, 0
    v_mov_b32 v101, 0
    v_mov_b32 v102, 0
    v_mov_b32 v103, 0
    v_mov_b32 v104, 0
    v_mov_b32 v105, 0
    v_mov_b32 v106, 0
    v_mov_b32 v107, 0
    v_mov_b32 v108, 0
    v_mov_b32 v109, 0
    v_mov_b32 v110, 0
    v_mov_b32 v111, 0
    v_mov_b32 v112, 0
    v_mov_b32 v113, 0
    v_mov_b32 v114, 0
    v_mov_b32 v115, 0
    v_mov_b32 v116, 0
    v_mov_b32 v117, 0
    v_mov_b32 v118, 0
    v_mov_b32 v119, 0
    v_mov_b32 v120, 0
    v_mov_b32 v121, 0
    v_mov_b32 v122, 0
    v_mov_b32 v123, 0
    v_mov_b32 v124, 0
    v_mov_b32 v125, 0
    v_mov_b32 v126, 0
    v_mov_b32 v127, 0
    v_mov_b32 v128, 0
    v_mov_b32 v129, 0
    v_mov_b32 v130, 0
    v_mov_b32 v131, 0
    v_mov_b32 v132, 0
    v_mov_b32 v133, 0
    v_mov_b32 v134, 0
    v_mov_b32 v135, 0
    v_mov_b32 v136, 0
    v_mov_b32 v137, 0
    v_mov_b32 v138, 0
    v_mov_b32 v139, 0
    v_mov_b32 v140, 0
    v_mov_b32 v141, 0
    v_mov_b32 v142, 0
    v_mov_b32 v143, 0
    v_mov_b32 v144, 0
    v_mov_b32 v145, 0
    v_mov_b32 v146, 0
    v_mov_b32 v147, 0
    v_mov_b32 v148, 0
    v_mov_b32 v149, 0
    v_mov_b32 v150, 0
    v_mov_b32 v151, 0
    v_mov_b32 v152, 0
    v_mov_b32 v153, 0
    v_mov_b32 v154, 0
    v_mov_b32 v155, 0
    v_mov_b32 v156, 0
    v_mov_b32 v157, 0
    v_mov_b32 v158, 0
    v_mov_b32 v159, 0
    v_mov_b32 v160, 0
    v_mov_b32 v161, 0
    v_mov_b32 v162, 0
    v_mov_b32 v163, 0
    s_waitcnt vmcnt(18)
    s_barrier
    v_mov_b32 v214, v33
    v_mov_b32 v215, v34
    v_mov_b32 v212, v31
    ds_read_b128 v[164:167], v212 offset:0
    ds_read_b128 v[168:171], v212 offset:2048
    ds_read_b128 v[172:175], v212 offset:4096
    ds_read_b128 v[176:179], v212 offset:6144
    ds_read_b64_tr_b16 v[196:197], v214 offset:0
    ds_read_b64_tr_b16 v[198:199], v214 offset:2048
    ds_read_b64_tr_b16 v[200:201], v215 offset:0
    ds_read_b64_tr_b16 v[202:203], v215 offset:2048
    s_sub_u32 s32, s38, 3
L_proj_kernel_main_8:
    v_add_u32 v213, s30, v32
    v_add_u32 v214, s30, v33
    v_add_u32 v215, s30, v34
    v_add_u32 v212, s31, v31
    v_add_u32 v216, s31, v33
    v_add_u32 v217, s31, v34
    s_waitcnt lgkmcnt(0)
    v_mfma_f32_32x32x16_bf16 v[36:51], v[196:199], v[164:167], v[36:51]
    ds_read_b128 v[180:183], v213 offset:0
    ds_read_b128 v[184:187], v213 offset:2048
    v_mfma_f32_32x32x16_bf16 v[52:67], v[200:203], v[164:167], v[52:67]
    ds_read_b128 v[188:191], v213 offset:4096
    ds_read_b128 v[192:195], v213 offset:6144
    v_mfma_f32_32x32x16_bf16 v[68:83], v[196:199], v[168:171], v[68:83]
    ds_read_b64_tr_b16 v[204:205], v214 offset:8192
    ds_read_b64_tr_b16 v[206:207], v214 offset:10240
    v_mfma_f32_32x32x16_bf16 v[84:99], v[200:203], v[168:171], v[84:99]
    ds_read_b64_tr_b16 v[208:209], v215 offset:8192
    ds_read_b64_tr_b16 v[210:211], v215 offset:10240
    v_mfma_f32_32x32x16_bf16 v[100:115], v[196:199], v[172:175], v[100:115]
    v_mfma_f32_32x32x16_bf16 v[116:131], v[200:203], v[172:175], v[116:131]
    v_mfma_f32_32x32x16_bf16 v[132:147], v[196:199], v[176:179], v[132:147]
    v_mfma_f32_32x32x16_bf16 v[148:163], v[200:203], v[176:179], v[148:163]
    s_waitcnt lgkmcnt(0)
    v_mfma_f32_32x32x16_bf16 v[36:51], v[204:207], v[180:183], v[36:51]
    ds_read_b128 v[164:167], v212 offset:0
    ds_read_b128 v[168:171], v212 offset:2048
    v_mfma_f32_32x32x16_bf16 v[52:67], v[208:211], v[180:183], v[52:67]
    ds_read_b128 v[172:175], v212 offset:4096
    ds_read_b128 v[176:179], v212 offset:6144
    v_mfma_f32_32x32x16_bf16 v[68:83], v[204:207], v[184:187], v[68:83]
    ds_read_b64_tr_b16 v[196:197], v216 offset:0
    ds_read_b64_tr_b16 v[198:199], v216 offset:2048
    v_mfma_f32_32x32x16_bf16 v[84:99], v[208:211], v[184:187], v[84:99]
    ds_read_b64_tr_b16 v[200:201], v217 offset:0
    ds_read_b64_tr_b16 v[202:203], v217 offset:2048
    v_mfma_f32_32x32x16_bf16 v[100:115], v[204:207], v[188:191], v[100:115]
    s_add_u32 s36, s29, s33
    s_add_u32 m0, s36, 0
    s_nop 0
    buffer_load_dwordx4 v6, s[4:7], s27 offen lds
    s_add_u32 m0, s36, 1024
    s_nop 0
    buffer_load_dwordx4 v7, s[4:7], s27 offen lds
    v_mfma_f32_32x32x16_bf16 v[116:131], v[208:211], v[188:191], v[116:131]
    s_add_u32 s37, s29, s34
    s_add_u32 m0, s37, 0
    s_nop 0
    buffer_load_dwordx4 v8, s[8:11], s28 offen lds
    s_add_u32 m0, s37, 1024
    s_nop 0
    buffer_load_dwordx4 v9, s[8:11], s28 offen lds
    v_mfma_f32_32x32x16_bf16 v[132:147], v[204:207], v[192:195], v[132:147]
    s_add_u32 s27, s27, 64
    s_add_u32 s28, s28, s35
    s_add_u32 s29, s29, 32768
    s_cmp_eq_u32 s29, 131072
    s_cselect_b32 s29, 0, s29
    v_mfma_f32_32x32x16_bf16 v[148:163], v[208:211], v[192:195], v[148:163]
    s_mov_b32 s30, s31
    s_add_u32 s31, s31, 32768
    s_cmp_eq_u32 s31, 131072
    s_cselect_b32 s31, 0, s31
    s_waitcnt vmcnt(4)
    s_barrier
    s_sub_u32 s32, s32, 1
    s_cmp_lg_u32 s32, 0
    s_cbranch_scc1 L_proj_kernel_main_8
    s_mov_b32 s32, 3
L_proj_kernel_tail_9:
    v_add_u32 v213, s30, v32
    v_add_u32 v214, s30, v33
    v_add_u32 v215, s30, v34
    v_add_u32 v212, s31, v31
    v_add_u32 v216, s31, v33
    v_add_u32 v217, s31, v34
    s_waitcnt lgkmcnt(0)
    v_mfma_f32_32x32x16_bf16 v[36:51], v[196:199], v[164:167], v[36:51]
    ds_read_b128 v[180:183], v213 offset:0
    ds_read_b128 v[184:187], v213 offset:2048
    v_mfma_f32_32x32x16_bf16 v[52:67], v[200:203], v[164:167], v[52:67]
    ds_read_b128 v[188:191], v213 offset:4096
    ds_read_b128 v[192:195], v213 offset:6144
    v_mfma_f32_32x32x16_bf16 v[68:83], v[196:199], v[168:171], v[68:83]
    ds_read_b64_tr_b16 v[204:205], v214 offset:8192
    ds_read_b64_tr_b16 v[206:207], v214 offset:10240
    v_mfma_f32_32x32x16_bf16 v[84:99], v[200:203], v[168:171], v[84:99]
    ds_read_b64_tr_b16 v[208:209], v215 offset:8192
    ds_read_b64_tr_b16 v[210:211], v215 offset:10240
    v_mfma_f32_32x32x16_bf16 v[100:115], v[196:199], v[172:175], v[100:115]
    v_mfma_f32_32x32x16_bf16 v[116:131], v[200:203], v[172:175], v[116:131]
    v_mfma_f32_32x32x16_bf16 v[132:147], v[196:199], v[176:179], v[132:147]
    v_mfma_f32_32x32x16_bf16 v[148:163], v[200:203], v[176:179], v[148:163]
    s_waitcnt lgkmcnt(0)
    v_mfma_f32_32x32x16_bf16 v[36:51], v[204:207], v[180:183], v[36:51]
    ds_read_b128 v[164:167], v212 offset:0
    ds_read_b128 v[168:171], v212 offset:2048
    v_mfma_f32_32x32x16_bf16 v[52:67], v[208:211], v[180:183], v[52:67]
    ds_read_b128 v[172:175], v212 offset:4096
    ds_read_b128 v[176:179], v212 offset:6144
    v_mfma_f32_32x32x16_bf16 v[68:83], v[204:207], v[184:187], v[68:83]
    ds_read_b64_tr_b16 v[196:197], v216 offset:0
    ds_read_b64_tr_b16 v[198:199], v216 offset:2048
    v_mfma_f32_32x32x16_bf16 v[84:99], v[208:211], v[184:187], v[84:99]
    ds_read_b64_tr_b16 v[200:201], v217 offset:0
    ds_read_b64_tr_b16 v[202:203], v217 offset:2048
    v_mfma_f32_32x32x16_bf16 v[100:115], v[204:207], v[188:191], v[100:115]
    v_mfma_f32_32x32x16_bf16 v[116:131], v[208:211], v[188:191], v[116:131]
    v_mfma_f32_32x32x16_bf16 v[132:147], v[204:207], v[192:195], v[132:147]
    v_mfma_f32_32x32x16_bf16 v[148:163], v[208:211], v[192:195], v[148:163]
    s_mov_b32 s30, s31
    s_add_u32 s31, s31, 32768
    s_cmp_eq_u32 s31, 131072
    s_cselect_b32 s31, 0, s31
    s_waitcnt vmcnt(0)
    s_barrier
    s_sub_u32 s32, s32, 1
    s_cmp_lg_u32 s32, 0
    s_cbranch_scc1 L_proj_kernel_tail_9
    s_waitcnt lgkmcnt(0)
    s_nop 15
    s_mov_b32 s4, s60
    s_and_b32 s5, s61, 0xffff
    s_mov_b32 s6, 0x200000
    s_mov_b32 s7, 0x20000
    s_mov_b32 s8, s64
    s_and_b32 s9, s65, 0xffff
    s_mov_b32 s10, 0x400000
    s_mov_b32 s11, 0x20000
    s_mov_b32 s16, 1024
    s_mov_b32 s17, 8192
    s_mov_b32 s18, 16
    s_lshl_b32 s19, s77, 18
    s_lshl_b32 s20, s78, 9
    s_mul_i32 s25, s24, 32
    s_add_u32 s25, s25, 0
    v_lshrrev_b32 v2, 2, v1
    v_add_u32 v2, s25, v2
    v_lshrrev_b32 v3, 2, v2
    v_and_b32 v3, 3, v3
    v_and_b32 v4, 3, v1
    v_xor_b32 v3, v3, v4
    v_mul_lo_u32 v2, v2, s16
    v_lshl_add_u32 v2, v3, 4, v2
    v_add_u32 v14, s19, v2
    s_mul_i32 s25, s24, 32
    s_add_u32 s25, s25, 16
    v_lshrrev_b32 v2, 2, v1
    v_add_u32 v2, s25, v2
    v_lshrrev_b32 v3, 2, v2
    v_and_b32 v3, 3, v3
    v_and_b32 v4, 3, v1
    v_xor_b32 v3, v3, v4
    v_mul_lo_u32 v2, v2, s16
    v_lshl_add_u32 v2, v3, 4, v2
    v_add_u32 v15, s19, v2
    s_mul_i32 s25, s24, 4
    s_add_u32 s25, s25, 0
    v_lshrrev_b32 v2, 5, v1
    v_add_u32 v2, s25, v2
    v_and_b32 v3, 3, v2
    v_lshlrev_b32 v3, 2, v3
    v_and_b32 v4, 31, v1
    v_xor_b32 v3, v3, v4
    v_mul_lo_u32 v2, v2, s17
    v_lshl_add_u32 v2, v3, 4, v2
    v_add_u32 v16, s20, v2
    s_mul_i32 s25, s24, 4
    s_add_u32 s25, s25, 2
    v_lshrrev_b32 v2, 5, v1
    v_add_u32 v2, s25, v2
    v_and_b32 v3, 3, v2
    v_lshlrev_b32 v3, 2, v3
    v_and_b32 v4, 31, v1
    v_xor_b32 v3, v3, v4
    v_mul_lo_u32 v2, v2, s17
    v_lshl_add_u32 v2, v3, 4, v2
    v_add_u32 v17, s20, v2
    s_mov_b32 s41, 0
    s_mov_b32 s42, 0
    s_mov_b32 s43, 0
    s_mov_b32 s44, 0
    s_mov_b32 s45, 32768
    s_mul_i32 s47, s24, 2048
    s_mul_i32 s48, s24, 2048
    s_add_u32 s48, s48, 16384
    s_mul_i32 s49, s17, 32
    s_mov_b32 s52, s18
    s_add_u32 s50, s43, s47
    s_add_u32 m0, s50, 0
    s_nop 0
    buffer_load_dwordx4 v14, s[4:7], s41 offen lds
    s_add_u32 m0, s50, 1024
    s_nop 0
    buffer_load_dwordx4 v15, s[4:7], s41 offen lds
    s_add_u32 s51, s43, s48
    s_add_u32 m0, s51, 0
    s_nop 0
    buffer_load_dwordx4 v16, s[8:11], s42 offen lds
    s_add_u32 m0, s51, 1024
    s_nop 0
    buffer_load_dwordx4 v17, s[8:11], s42 offen lds
    s_add_u32 s41, s41, 64
    s_add_u32 s42, s42, s49
    s_add_u32 s43, s43, 32768
    s_cmp_eq_u32 s43, 131072
    s_cselect_b32 s43, 0, s43
    s_add_u32 s50, s43, s47
    s_add_u32 m0, s50, 0
    s_nop 0
    buffer_load_dwordx4 v14, s[4:7], s41 offen lds
    s_add_u32 m0, s50, 1024
    s_nop 0
    buffer_load_dwordx4 v15, s[4:7], s41 offen lds
    s_add_u32 s51, s43, s48
    s_add_u32 m0, s51, 0
    s_nop 0
    buffer_load_dwordx4 v16, s[8:11], s42 offen lds
    s_add_u32 m0, s51, 1024
    s_nop 0
    buffer_load_dwordx4 v17, s[8:11], s42 offen lds
    s_add_u32 s41, s41, 64
    s_add_u32 s42, s42, s49
    s_add_u32 s43, s43, 32768
    s_cmp_eq_u32 s43, 131072
    s_cselect_b32 s43, 0, s43
    s_add_u32 s50, s43, s47
    s_add_u32 m0, s50, 0
    s_nop 0
    buffer_load_dwordx4 v14, s[4:7], s41 offen lds
    s_add_u32 m0, s50, 1024
    s_nop 0
    buffer_load_dwordx4 v15, s[4:7], s41 offen lds
    s_add_u32 s51, s43, s48
    s_add_u32 m0, s51, 0
    s_nop 0
    buffer_load_dwordx4 v16, s[8:11], s42 offen lds
    s_add_u32 m0, s51, 1024
    s_nop 0
    buffer_load_dwordx4 v17, s[8:11], s42 offen lds
    s_add_u32 s41, s41, 64
    s_add_u32 s42, s42, s49
    s_add_u32 s43, s43, 32768
    s_cmp_eq_u32 s43, 131072
    s_cselect_b32 s43, 0, s43
    s_lshl_b32 s25, s24, 12
    s_add_u32 s25, s25, 131072
    v_and_b32 v221, 31, v1
    v_lshlrev_b32 v218, 7, v221
    v_add_u32 v218, s25, v218
    v_and_b32 v221, 7, v221
    v_lshrrev_b32 v219, 5, v1
    v_xor_b32 v221, v221, v219
    v_lshl_add_u32 v218, v221, 4, v218
    v_lshrrev_b32 v221, 3, v1
    v_xor_b32 v219, v221, v1
    v_and_b32 v219, 7, v219
    v_lshlrev_b32 v219, 4, v219
    v_lshl_add_u32 v219, v221, 7, v219
    v_add_u32 v219, s25, v219
    v_mul_lo_u32 v220, v221, s22
    v_and_b32 v221, 7, v1
    v_lshl_add_u32 v220, v221, 4, v220
    s_mul_i32 s25, s39, 128
    s_mul_i32 s25, s25, s22
    s_add_u32 s25, s25, s21
    s_mul_i32 s26, s40, 128
    s_add_u32 s25, s25, s26
    s_mul_i32 s26, s22, 8
    v_cvt_pk_bf16_f32 v36, v36, v37
    v_cvt_pk_bf16_f32 v37, v38, v39
    v_cvt_pk_bf16_f32 v38, v40, v41
    v_cvt_pk_bf16_f32 v39, v42, v43
    v_cvt_pk_bf16_f32 v40, v44, v45
    v_cvt_pk_bf16_f32 v41, v46, v47
    v_cvt_pk_bf16_f32 v42, v48, v49
    v_cvt_pk_bf16_f32 v43, v50, v51
    s_nop 1
    v_permlane32_swap_b32 v36, v38
    v_permlane32_swap_b32 v37, v39
    v_permlane32_swap_b32 v40, v42
    v_permlane32_swap_b32 v41, v43
    s_nop 0
    ds_write_b128 v218, v[36:39]
    v_xor_b32 v221, 32, v218
    ds_write_b128 v221, v[40:43]
    v_cvt_pk_bf16_f32 v52, v52, v53
    v_cvt_pk_bf16_f32 v53, v54, v55
    v_cvt_pk_bf16_f32 v54, v56, v57
    v_cvt_pk_bf16_f32 v55, v58, v59
    v_cvt_pk_bf16_f32 v56, v60, v61
    v_cvt_pk_bf16_f32 v57, v62, v63
    v_cvt_pk_bf16_f32 v58, v64, v65
    v_cvt_pk_bf16_f32 v59, v66, v67
    s_nop 1
    v_permlane32_swap_b32 v52, v54
    v_permlane32_swap_b32 v53, v55
    v_permlane32_swap_b32 v56, v58
    v_permlane32_swap_b32 v57, v59
    v_xor_b32 v221, 64, v218
    ds_write_b128 v221, v[52:55]
    v_xor_b32 v221, 96, v218
    ds_write_b128 v221, v[56:59]
    s_waitcnt lgkmcnt(0)
    ds_read_b128 v[44:47], v219 offset:0
    ds_read_b128 v[48:51], v219 offset:1024
    ds_read_b128 v[60:63], v219 offset:2048
    ds_read_b128 v[64:67], v219 offset:3072
    s_waitcnt lgkmcnt(3)
    buffer_store_dwordx4 v[44:47], v220, s[12:15], s25 offen
    s_add_u32 s25, s25, s26
    s_waitcnt lgkmcnt(2)
    buffer_store_dwordx4 v[48:51], v220, s[12:15], s25 offen
    s_add_u32 s25, s25, s26
    s_waitcnt lgkmcnt(1)
    buffer_store_dwordx4 v[60:63], v220, s[12:15], s25 offen
    s_add_u32 s25, s25, s26
    s_waitcnt lgkmcnt(0)
    buffer_store_dwordx4 v[64:67], v220, s[12:15], s25 offen
    s_add_u32 s25, s25, s26
    v_cvt_pk_bf16_f32 v68, v68, v69
    v_cvt_pk_bf16_f32 v69, v70, v71
    v_cvt_pk_bf16_f32 v70, v72, v73
    v_cvt_pk_bf16_f32 v71, v74, v75
    v_cvt_pk_bf16_f32 v72, v76, v77
    v_cvt_pk_bf16_f32 v73, v78, v79
    v_cvt_pk_bf16_f32 v74, v80, v81
    v_cvt_pk_bf16_f32 v75, v82, v83
    s_nop 1
    v_permlane32_swap_b32 v68, v70
    v_permlane32_swap_b32 v69, v71
    v_permlane32_swap_b32 v72, v74
    v_permlane32_swap_b32 v73, v75
    s_nop 0
    ds_write_b128 v218, v[68:71]
    v_xor_b32 v221, 32, v218
    ds_write_b128 v221, v[72:75]
    v_cvt_pk_bf16_f32 v84, v84, v85
    v_cvt_pk_bf16_f32 v85, v86, v87
    v_cvt_pk_bf16_f32 v86, v88, v89
    v_cvt_pk_bf16_f32 v87, v90, v91
    v_cvt_pk_bf16_f32 v88, v92, v93
    v_cvt_pk_bf16_f32 v89, v94, v95
    v_cvt_pk_bf16_f32 v90, v96, v97
    v_cvt_pk_bf16_f32 v91, v98, v99
    s_nop 1
    v_permlane32_swap_b32 v84, v86
    v_permlane32_swap_b32 v85, v87
    v_permlane32_swap_b32 v88, v90
    v_permlane32_swap_b32 v89, v91
    v_xor_b32 v221, 64, v218
    ds_write_b128 v221, v[84:87]
    v_xor_b32 v221, 96, v218
    ds_write_b128 v221, v[88:91]
    s_waitcnt lgkmcnt(0)
    ds_read_b128 v[76:79], v219 offset:0
    ds_read_b128 v[80:83], v219 offset:1024
    ds_read_b128 v[92:95], v219 offset:2048
    ds_read_b128 v[96:99], v219 offset:3072
    s_waitcnt lgkmcnt(3)
    buffer_store_dwordx4 v[76:79], v220, s[12:15], s25 offen
    s_add_u32 s25, s25, s26
    s_waitcnt lgkmcnt(2)
    buffer_store_dwordx4 v[80:83], v220, s[12:15], s25 offen
    s_add_u32 s25, s25, s26
    s_waitcnt lgkmcnt(1)
    buffer_store_dwordx4 v[92:95], v220, s[12:15], s25 offen
    s_add_u32 s25, s25, s26
    s_waitcnt lgkmcnt(0)
    buffer_store_dwordx4 v[96:99], v220, s[12:15], s25 offen
    s_add_u32 s25, s25, s26
    v_cvt_pk_bf16_f32 v100, v100, v101
    v_cvt_pk_bf16_f32 v101, v102, v103
    v_cvt_pk_bf16_f32 v102, v104, v105
    v_cvt_pk_bf16_f32 v103, v106, v107
    v_cvt_pk_bf16_f32 v104, v108, v109
    v_cvt_pk_bf16_f32 v105, v110, v111
    v_cvt_pk_bf16_f32 v106, v112, v113
    v_cvt_pk_bf16_f32 v107, v114, v115
    s_nop 1
    v_permlane32_swap_b32 v100, v102
    v_permlane32_swap_b32 v101, v103
    v_permlane32_swap_b32 v104, v106
    v_permlane32_swap_b32 v105, v107
    s_nop 0
    ds_write_b128 v218, v[100:103]
    v_xor_b32 v221, 32, v218
    ds_write_b128 v221, v[104:107]
    v_cvt_pk_bf16_f32 v116, v116, v117
    v_cvt_pk_bf16_f32 v117, v118, v119
    v_cvt_pk_bf16_f32 v118, v120, v121
    v_cvt_pk_bf16_f32 v119, v122, v123
    v_cvt_pk_bf16_f32 v120, v124, v125
    v_cvt_pk_bf16_f32 v121, v126, v127
    v_cvt_pk_bf16_f32 v122, v128, v129
    v_cvt_pk_bf16_f32 v123, v130, v131
    s_nop 1
    v_permlane32_swap_b32 v116, v118
    v_permlane32_swap_b32 v117, v119
    v_permlane32_swap_b32 v120, v122
    v_permlane32_swap_b32 v121, v123
    v_xor_b32 v221, 64, v218
    ds_write_b128 v221, v[116:119]
    v_xor_b32 v221, 96, v218
    ds_write_b128 v221, v[120:123]
    s_waitcnt lgkmcnt(0)
    ds_read_b128 v[108:111], v219 offset:0
    ds_read_b128 v[112:115], v219 offset:1024
    ds_read_b128 v[124:127], v219 offset:2048
    ds_read_b128 v[128:131], v219 offset:3072
    s_waitcnt lgkmcnt(3)
    buffer_store_dwordx4 v[108:111], v220, s[12:15], s25 offen
    s_add_u32 s25, s25, s26
    s_waitcnt lgkmcnt(2)
    buffer_store_dwordx4 v[112:115], v220, s[12:15], s25 offen
    s_add_u32 s25, s25, s26
    s_waitcnt lgkmcnt(1)
    buffer_store_dwordx4 v[124:127], v220, s[12:15], s25 offen
    s_add_u32 s25, s25, s26
    s_waitcnt lgkmcnt(0)
    buffer_store_dwordx4 v[128:131], v220, s[12:15], s25 offen
    s_add_u32 s25, s25, s26
    v_cvt_pk_bf16_f32 v132, v132, v133
    v_cvt_pk_bf16_f32 v133, v134, v135
    v_cvt_pk_bf16_f32 v134, v136, v137
    v_cvt_pk_bf16_f32 v135, v138, v139
    v_cvt_pk_bf16_f32 v136, v140, v141
    v_cvt_pk_bf16_f32 v137, v142, v143
    v_cvt_pk_bf16_f32 v138, v144, v145
    v_cvt_pk_bf16_f32 v139, v146, v147
    s_nop 1
    v_permlane32_swap_b32 v132, v134
    v_permlane32_swap_b32 v133, v135
    v_permlane32_swap_b32 v136, v138
    v_permlane32_swap_b32 v137, v139
    s_nop 0
    ds_write_b128 v218, v[132:135]
    v_xor_b32 v221, 32, v218
    ds_write_b128 v221, v[136:139]
    v_cvt_pk_bf16_f32 v148, v148, v149
    v_cvt_pk_bf16_f32 v149, v150, v151
    v_cvt_pk_bf16_f32 v150, v152, v153
    v_cvt_pk_bf16_f32 v151, v154, v155
    v_cvt_pk_bf16_f32 v152, v156, v157
    v_cvt_pk_bf16_f32 v153, v158, v159
    v_cvt_pk_bf16_f32 v154, v160, v161
    v_cvt_pk_bf16_f32 v155, v162, v163
    s_nop 1
    v_permlane32_swap_b32 v148, v150
    v_permlane32_swap_b32 v149, v151
    v_permlane32_swap_b32 v152, v154
    v_permlane32_swap_b32 v153, v155
    v_xor_b32 v221, 64, v218
    ds_write_b128 v221, v[148:151]
    v_xor_b32 v221, 96, v218
    ds_write_b128 v221, v[152:155]
    s_waitcnt lgkmcnt(0)
    ds_read_b128 v[140:143], v219 offset:0
    ds_read_b128 v[144:147], v219 offset:1024
    ds_read_b128 v[156:159], v219 offset:2048
    ds_read_b128 v[160:163], v219 offset:3072
    s_waitcnt lgkmcnt(3)
    buffer_store_dwordx4 v[140:143], v220, s[12:15], s25 offen
    s_add_u32 s25, s25, s26
    s_waitcnt lgkmcnt(2)
    buffer_store_dwordx4 v[144:147], v220, s[12:15], s25 offen
    s_add_u32 s25, s25, s26
    s_waitcnt lgkmcnt(1)
    buffer_store_dwordx4 v[156:159], v220, s[12:15], s25 offen
    s_add_u32 s25, s25, s26
    s_waitcnt lgkmcnt(0)
    buffer_store_dwordx4 v[160:163], v220, s[12:15], s25 offen
    s_add_u32 s25, s25, s26
    s_nop 1
    s_add_u32 s12, s74, 0x2000000
    s_addc_u32 s13, s75, 0
    s_and_b32 s13, s13, 0xffff
    s_mov_b32 s14, 0x1000000
    s_mov_b32 s15, 0x20000
    s_lshl_b32 s21, s78, 20
    s_lshl_b32 s79, s77, 16
    s_add_u32 s21, s21, s79
    s_lshr_b32 s79, s24, 2
    s_mul_i32 s79, s79, 507904
    s_add_u32 s21, s21, s79
    s_and_b32 s53, s24, 1
    s_lshr_b32 s54, s24, 1
    s_mul_i32 s25, s53, 128
    v_and_b32 v2, 31, v1
    v_add_u32 v2, s25, v2
    v_lshrrev_b32 v3, 2, v2
    v_and_b32 v3, 3, v3
    v_lshrrev_b32 v4, 5, v1
    v_xor_b32 v3, v3, v4
    v_lshlrev_b32 v2, 6, v2
    v_xor_b32 v4, 0, v3
    v_lshl_add_u32 v31, v4, 4, v2
    v_xor_b32 v4, 2, v3
    v_lshl_add_u32 v32, v4, 4, v2
    v_lshrrev_b32 v2, 5, v1
    v_lshlrev_b32 v2, 3, v2
    v_bfe_u32 v3, v1, 2, 2
    v_add_u32 v2, v2, v3
    v_and_b32 v3, 3, v2
    v_lshlrev_b32 v3, 2, v3
    v_lshlrev_b32 v2, 9, v2
    s_mul_i32 s25, s54, 8
    s_add_u32 s25, s25, 0
    v_bfe_u32 v4, v1, 4, 1
    v_lshlrev_b32 v4, 1, v4
    v_bfe_u32 v5, v1, 1, 1
    v_add3_u32 v4, v4, v5, s25
    v_xor_b32 v4, v4, v3
    v_lshl_add_u32 v4, v4, 4, v2
    v_and_b32 v5, 1, v1
    v_lshl_add_u32 v4, v5, 3, v4
    v_add_u32 v33, 16384, v4
    s_mul_i32 s25, s54, 8
    s_add_u32 s25, s25, 4
    v_bfe_u32 v4, v1, 4, 1
    v_lshlrev_b32 v4, 1, v4
    v_bfe_u32 v5, v1, 1, 1
    v_add3_u32 v4, v4, v5, s25
    v_xor_b32 v4, v4, v3
    v_lshl_add_u32 v4, v4, 4, v2
    v_and_b32 v5, 1, v1
    v_lshl_add_u32 v4, v5, 3, v4
    v_add_u32 v34, 16384, v4
    v_mov_b32 v36, 0
    v_mov_b32 v37, 0
    v_mov_b32 v38, 0
    v_mov_b32 v39, 0
    v_mov_b32 v40, 0
    v_mov_b32 v41, 0
    v_mov_b32 v42, 0
    v_mov_b32 v43, 0
    v_mov_b32 v44, 0
    v_mov_b32 v45, 0
    v_mov_b32 v46, 0
    v_mov_b32 v47, 0
    v_mov_b32 v48, 0
    v_mov_b32 v49, 0
    v_mov_b32 v50, 0
    v_mov_b32 v51, 0
    v_mov_b32 v52, 0
    v_mov_b32 v53, 0
    v_mov_b32 v54, 0
    v_mov_b32 v55, 0
    v_mov_b32 v56, 0
    v_mov_b32 v57, 0
    v_mov_b32 v58, 0
    v_mov_b32 v59, 0
    v_mov_b32 v60, 0
    v_mov_b32 v61, 0
    v_mov_b32 v62, 0
    v_mov_b32 v63, 0
    v_mov_b32 v64, 0
    v_mov_b32 v65, 0
    v_mov_b32 v66, 0
    v_mov_b32 v67, 0
    v_mov_b32 v68, 0
    v_mov_b32 v69, 0
    v_mov_b32 v70, 0
    v_mov_b32 v71, 0
    v_mov_b32 v72, 0
    v_mov_b32 v73, 0
    v_mov_b32 v74, 0
    v_mov_b32 v75, 0
    v_mov_b32 v76, 0
    v_mov_b32 v77, 0
    v_mov_b32 v78, 0
    v_mov_b32 v79, 0
    v_mov_b32 v80, 0
    v_mov_b32 v81, 0
    v_mov_b32 v82, 0
    v_mov_b32 v83, 0
    v_mov_b32 v84, 0
    v_mov_b32 v85, 0
    v_mov_b32 v86, 0
    v_mov_b32 v87, 0
    v_mov_b32 v88, 0
    v_mov_b32 v89, 0
    v_mov_b32 v90, 0
    v_mov_b32 v91, 0
    v_mov_b32 v92, 0
    v_mov_b32 v93, 0
    v_mov_b32 v94, 0
    v_mov_b32 v95, 0
    v_mov_b32 v96, 0
    v_mov_b32 v97, 0
    v_mov_b32 v98, 0
    v_mov_b32 v99, 0
    v_mov_b32 v100, 0
    v_mov_b32 v101, 0
    v_mov_b32 v102, 0
    v_mov_b32 v103, 0
    v_mov_b32 v104, 0
    v_mov_b32 v105, 0
    v_mov_b32 v106, 0
    v_mov_b32 v107, 0
    v_mov_b32 v108, 0
    v_mov_b32 v109, 0
    v_mov_b32 v110, 0
    v_mov_b32 v111, 0
    v_mov_b32 v112, 0
    v_mov_b32 v113, 0
    v_mov_b32 v114, 0
    v_mov_b32 v115, 0
    v_mov_b32 v116, 0
    v_mov_b32 v117, 0
    v_mov_b32 v118, 0
    v_mov_b32 v119, 0
    v_mov_b32 v120, 0
    v_mov_b32 v121, 0
    v_mov_b32 v122, 0
    v_mov_b32 v123, 0
    v_mov_b32 v124, 0
    v_mov_b32 v125, 0
    v_mov_b32 v126, 0
    v_mov_b32 v127, 0
    v_mov_b32 v128, 0
    v_mov_b32 v129, 0
    v_mov_b32 v130, 0
    v_mov_b32 v131, 0
    v_mov_b32 v132, 0
    v_mov_b32 v133, 0
    v_mov_b32 v134, 0
    v_mov_b32 v135, 0
    v_mov_b32 v136, 0
    v_mov_b32 v137, 0
    v_mov_b32 v138, 0
    v_mov_b32 v139, 0
    v_mov_b32 v140, 0
    v_mov_b32 v141, 0
    v_mov_b32 v142, 0
    v_mov_b32 v143, 0
    v_mov_b32 v144, 0
    v_mov_b32 v145, 0
    v_mov_b32 v146, 0
    v_mov_b32 v147, 0
    v_mov_b32 v148, 0
    v_mov_b32 v149, 0
    v_mov_b32 v150, 0
    v_mov_b32 v151, 0
    v_mov_b32 v152, 0
    v_mov_b32 v153, 0
    v_mov_b32 v154, 0
    v_mov_b32 v155, 0
    v_mov_b32 v156, 0
    v_mov_b32 v157, 0
    v_mov_b32 v158, 0
    v_mov_b32 v159, 0
    v_mov_b32 v160, 0
    v_mov_b32 v161, 0
    v_mov_b32 v162, 0
    v_mov_b32 v163, 0
    s_waitcnt vmcnt(20)
    s_barrier
    v_mov_b32 v214, v33
    v_mov_b32 v215, v34
    v_mov_b32 v212, v31
    ds_read_b128 v[164:167], v212 offset:0
    ds_read_b128 v[168:171], v212 offset:2048
    ds_read_b128 v[172:175], v212 offset:4096
    ds_read_b128 v[176:179], v212 offset:6144
    ds_read_b64_tr_b16 v[196:197], v214 offset:0
    ds_read_b64_tr_b16 v[198:199], v214 offset:2048
    ds_read_b64_tr_b16 v[200:201], v215 offset:0
    ds_read_b64_tr_b16 v[202:203], v215 offset:2048
    s_sub_u32 s46, s52, 3
L_proj_kernel_main_10:
    v_add_u32 v213, s44, v32
    v_add_u32 v214, s44, v33
    v_add_u32 v215, s44, v34
    v_add_u32 v212, s45, v31
    v_add_u32 v216, s45, v33
    v_add_u32 v217, s45, v34
    s_waitcnt lgkmcnt(0)
    v_mfma_f32_32x32x16_bf16 v[36:51], v[164:167], v[196:199], v[36:51]
    ds_read_b128 v[180:183], v213 offset:0
    ds_read_b128 v[184:187], v213 offset:2048
    v_mfma_f32_32x32x16_bf16 v[52:67], v[164:167], v[200:203], v[52:67]
    ds_read_b128 v[188:191], v213 offset:4096
    ds_read_b128 v[192:195], v213 offset:6144
    v_mfma_f32_32x32x16_bf16 v[68:83], v[168:171], v[196:199], v[68:83]
    ds_read_b64_tr_b16 v[204:205], v214 offset:8192
    ds_read_b64_tr_b16 v[206:207], v214 offset:10240
    v_mfma_f32_32x32x16_bf16 v[84:99], v[168:171], v[200:203], v[84:99]
    ds_read_b64_tr_b16 v[208:209], v215 offset:8192
    ds_read_b64_tr_b16 v[210:211], v215 offset:10240
    v_mfma_f32_32x32x16_bf16 v[100:115], v[172:175], v[196:199], v[100:115]
    v_mfma_f32_32x32x16_bf16 v[116:131], v[172:175], v[200:203], v[116:131]
    v_mfma_f32_32x32x16_bf16 v[132:147], v[176:179], v[196:199], v[132:147]
    v_mfma_f32_32x32x16_bf16 v[148:163], v[176:179], v[200:203], v[148:163]
    s_waitcnt lgkmcnt(0)
    v_mfma_f32_32x32x16_bf16 v[36:51], v[180:183], v[204:207], v[36:51]
    ds_read_b128 v[164:167], v212 offset:0
    ds_read_b128 v[168:171], v212 offset:2048
    v_mfma_f32_32x32x16_bf16 v[52:67], v[180:183], v[208:211], v[52:67]
    ds_read_b128 v[172:175], v212 offset:4096
    ds_read_b128 v[176:179], v212 offset:6144
    v_mfma_f32_32x32x16_bf16 v[68:83], v[184:187], v[204:207], v[68:83]
    ds_read_b64_tr_b16 v[196:197], v216 offset:0
    ds_read_b64_tr_b16 v[198:199], v216 offset:2048
    v_mfma_f32_32x32x16_bf16 v[84:99], v[184:187], v[208:211], v[84:99]
    ds_read_b64_tr_b16 v[200:201], v217 offset:0
    ds_read_b64_tr_b16 v[202:203], v217 offset:2048
    v_mfma_f32_32x32x16_bf16 v[100:115], v[188:191], v[204:207], v[100:115]
    s_add_u32 s50, s43, s47
    s_add_u32 m0, s50, 0
    s_nop 0
    buffer_load_dwordx4 v14, s[4:7], s41 offen lds
    s_add_u32 m0, s50, 1024
    s_nop 0
    buffer_load_dwordx4 v15, s[4:7], s41 offen lds
    v_mfma_f32_32x32x16_bf16 v[116:131], v[188:191], v[208:211], v[116:131]
    s_add_u32 s51, s43, s48
    s_add_u32 m0, s51, 0
    s_nop 0
    buffer_load_dwordx4 v16, s[8:11], s42 offen lds
    s_add_u32 m0, s51, 1024
    s_nop 0
    buffer_load_dwordx4 v17, s[8:11], s42 offen lds
    v_mfma_f32_32x32x16_bf16 v[132:147], v[192:195], v[204:207], v[132:147]
    s_add_u32 s41, s41, 64
    s_add_u32 s42, s42, s49
    s_add_u32 s43, s43, 32768
    s_cmp_eq_u32 s43, 131072
    s_cselect_b32 s43, 0, s43
    v_mfma_f32_32x32x16_bf16 v[148:163], v[192:195], v[208:211], v[148:163]
    s_mov_b32 s44, s45
    s_add_u32 s45, s45, 32768
    s_cmp_eq_u32 s45, 131072
    s_cselect_b32 s45, 0, s45
    s_waitcnt vmcnt(4)
    s_barrier
    s_sub_u32 s46, s46, 1
    s_cmp_lg_u32 s46, 0
    s_cbranch_scc1 L_proj_kernel_main_10
    s_mov_b32 s46, 3
L_proj_kernel_tail_11:
    v_add_u32 v213, s44, v32
    v_add_u32 v214, s44, v33
    v_add_u32 v215, s44, v34
    v_add_u32 v212, s45, v31
    v_add_u32 v216, s45, v33
    v_add_u32 v217, s45, v34
    s_waitcnt lgkmcnt(0)
    v_mfma_f32_32x32x16_bf16 v[36:51], v[164:167], v[196:199], v[36:51]
    ds_read_b128 v[180:183], v213 offset:0
    ds_read_b128 v[184:187], v213 offset:2048
    v_mfma_f32_32x32x16_bf16 v[52:67], v[164:167], v[200:203], v[52:67]
    ds_read_b128 v[188:191], v213 offset:4096
    ds_read_b128 v[192:195], v213 offset:6144
    v_mfma_f32_32x32x16_bf16 v[68:83], v[168:171], v[196:199], v[68:83]
    ds_read_b64_tr_b16 v[204:205], v214 offset:8192
    ds_read_b64_tr_b16 v[206:207], v214 offset:10240
    v_mfma_f32_32x32x16_bf16 v[84:99], v[168:171], v[200:203], v[84:99]
    ds_read_b64_tr_b16 v[208:209], v215 offset:8192
    ds_read_b64_tr_b16 v[210:211], v215 offset:10240
    v_mfma_f32_32x32x16_bf16 v[100:115], v[172:175], v[196:199], v[100:115]
    v_mfma_f32_32x32x16_bf16 v[116:131], v[172:175], v[200:203], v[116:131]
    v_mfma_f32_32x32x16_bf16 v[132:147], v[176:179], v[196:199], v[132:147]
    v_mfma_f32_32x32x16_bf16 v[148:163], v[176:179], v[200:203], v[148:163]
    s_waitcnt lgkmcnt(0)
    v_mfma_f32_32x32x16_bf16 v[36:51], v[180:183], v[204:207], v[36:51]
    ds_read_b128 v[164:167], v212 offset:0
    ds_read_b128 v[168:171], v212 offset:2048
    v_mfma_f32_32x32x16_bf16 v[52:67], v[180:183], v[208:211], v[52:67]
    ds_read_b128 v[172:175], v212 offset:4096
    ds_read_b128 v[176:179], v212 offset:6144
    v_mfma_f32_32x32x16_bf16 v[68:83], v[184:187], v[204:207], v[68:83]
    ds_read_b64_tr_b16 v[196:197], v216 offset:0
    ds_read_b64_tr_b16 v[198:199], v216 offset:2048
    v_mfma_f32_32x32x16_bf16 v[84:99], v[184:187], v[208:211], v[84:99]
    ds_read_b64_tr_b16 v[200:201], v217 offset:0
    ds_read_b64_tr_b16 v[202:203], v217 offset:2048
    v_mfma_f32_32x32x16_bf16 v[100:115], v[188:191], v[204:207], v[100:115]
    v_mfma_f32_32x32x16_bf16 v[116:131], v[188:191], v[208:211], v[116:131]
    v_mfma_f32_32x32x16_bf16 v[132:147], v[192:195], v[204:207], v[132:147]
    v_mfma_f32_32x32x16_bf16 v[148:163], v[192:195], v[208:211], v[148:163]
    s_mov_b32 s44, s45
    s_add_u32 s45, s45, 32768
    s_cmp_eq_u32 s45, 131072
    s_cselect_b32 s45, 0, s45
    s_waitcnt vmcnt(0)
    s_barrier
    s_sub_u32 s46, s46, 1
    s_cmp_lg_u32 s46, 0
    s_cbranch_scc1 L_proj_kernel_tail_11
    s_waitcnt lgkmcnt(0)
    s_nop 15
    s_lshl_b32 s25, s24, 12
    s_add_u32 s25, s25, 131072
    v_and_b32 v221, 31, v1
    v_lshlrev_b32 v218, 7, v221
    v_add_u32 v218, s25, v218
    v_and_b32 v221, 7, v221
    v_lshrrev_b32 v219, 5, v1
    v_xor_b32 v221, v221, v219
    v_lshl_add_u32 v218, v221, 4, v218
    v_lshrrev_b32 v221, 3, v1
    v_xor_b32 v219, v221, v1
    v_and_b32 v219, 7, v219
    v_lshlrev_b32 v219, 4, v219
    v_lshl_add_u32 v219, v221, 7, v219
    v_add_u32 v219, s25, v219
    v_lshlrev_b32 v220, 7, v221
    v_and_b32 v221, 7, v1
    v_lshl_add_u32 v220, v221, 4, v220
    s_mul_i32 s25, s53, 32768
    s_add_u32 s25, s25, s21
    s_mul_i32 s26, s54, 8192
    s_add_u32 s25, s25, s26
    v_cvt_pk_bf16_f32 v36, v36, v37
    v_cvt_pk_bf16_f32 v37, v38, v39
    v_cvt_pk_bf16_f32 v38, v40, v41
    v_cvt_pk_bf16_f32 v39, v42, v43
    v_cvt_pk_bf16_f32 v40, v44, v45
    v_cvt_pk_bf16_f32 v41, v46, v47
    v_cvt_pk_bf16_f32 v42, v48, v49
    v_cvt_pk_bf16_f32 v43, v50, v51
    s_nop 0
    ds_write_b128 v218, v[36:39]
    v_xor_b32 v221, 32, v218
    ds_write_b128 v221, v[40:43]
    v_cvt_pk_bf16_f32 v68, v68, v69
    v_cvt_pk_bf16_f32 v69, v70, v71
    v_cvt_pk_bf16_f32 v70, v72, v73
    v_cvt_pk_bf16_f32 v71, v74, v75
    v_cvt_pk_bf16_f32 v72, v76, v77
    v_cvt_pk_bf16_f32 v73, v78, v79
    v_cvt_pk_bf16_f32 v74, v80, v81
    v_cvt_pk_bf16_f32 v75, v82, v83
    v_xor_b32 v221, 64, v218
    ds_write_b128 v221, v[68:71]
    v_xor_b32 v221, 96, v218
    ds_write_b128 v221, v[72:75]
    s_waitcnt lgkmcnt(0)
    ds_read_b128 v[44:47], v219 offset:0
    ds_read_b128 v[48:51], v219 offset:1024
    ds_read_b128 v[76:79], v219 offset:2048
    ds_read_b128 v[80:83], v219 offset:3072
    s_add_u32 s26, s25, 0
    s_waitcnt lgkmcnt(3)
    buffer_store_dwordx4 v[44:47], v220, s[12:15], s26 offen
    s_add_u32 s26, s25, 1024
    s_waitcnt lgkmcnt(2)
    buffer_store_dwordx4 v[48:51], v220, s[12:15], s26 offen
    s_add_u32 s26, s25, 2048
    s_waitcnt lgkmcnt(1)
    buffer_store_dwordx4 v[76:79], v220, s[12:15], s26 offen
    s_add_u32 s26, s25, 3072
    s_waitcnt lgkmcnt(0)
    buffer_store_dwordx4 v[80:83], v220, s[12:15], s26 offen
    v_cvt_pk_bf16_f32 v100, v100, v101
    v_cvt_pk_bf16_f32 v101, v102, v103
    v_cvt_pk_bf16_f32 v102, v104, v105
    v_cvt_pk_bf16_f32 v103, v106, v107
    v_cvt_pk_bf16_f32 v104, v108, v109
    v_cvt_pk_bf16_f32 v105, v110, v111
    v_cvt_pk_bf16_f32 v106, v112, v113
    v_cvt_pk_bf16_f32 v107, v114, v115
    s_nop 0
    ds_write_b128 v218, v[100:103]
    v_xor_b32 v221, 32, v218
    ds_write_b128 v221, v[104:107]
    v_cvt_pk_bf16_f32 v132, v132, v133
    v_cvt_pk_bf16_f32 v133, v134, v135
    v_cvt_pk_bf16_f32 v134, v136, v137
    v_cvt_pk_bf16_f32 v135, v138, v139
    v_cvt_pk_bf16_f32 v136, v140, v141
    v_cvt_pk_bf16_f32 v137, v142, v143
    v_cvt_pk_bf16_f32 v138, v144, v145
    v_cvt_pk_bf16_f32 v139, v146, v147
    v_xor_b32 v221, 64, v218
    ds_write_b128 v221, v[132:135]
    v_xor_b32 v221, 96, v218
    ds_write_b128 v221, v[136:139]
    s_waitcnt lgkmcnt(0)
    ds_read_b128 v[108:111], v219 offset:0
    ds_read_b128 v[112:115], v219 offset:1024
    ds_read_b128 v[140:143], v219 offset:2048
    ds_read_b128 v[144:147], v219 offset:3072
    s_add_u32 s26, s25, 16384
    s_waitcnt lgkmcnt(3)
    buffer_store_dwordx4 v[108:111], v220, s[12:15], s26 offen
    s_add_u32 s26, s25, 17408
    s_waitcnt lgkmcnt(2)
    buffer_store_dwordx4 v[112:115], v220, s[12:15], s26 offen
    s_add_u32 s26, s25, 18432
    s_waitcnt lgkmcnt(1)
    buffer_store_dwordx4 v[140:143], v220, s[12:15], s26 offen
    s_add_u32 s26, s25, 19456
    s_waitcnt lgkmcnt(0)
    buffer_store_dwordx4 v[144:147], v220, s[12:15], s26 offen
    v_cvt_pk_bf16_f32 v52, v52, v53
    v_cvt_pk_bf16_f32 v53, v54, v55
    v_cvt_pk_bf16_f32 v54, v56, v57
    v_cvt_pk_bf16_f32 v55, v58, v59
    v_cvt_pk_bf16_f32 v56, v60, v61
    v_cvt_pk_bf16_f32 v57, v62, v63
    v_cvt_pk_bf16_f32 v58, v64, v65
    v_cvt_pk_bf16_f32 v59, v66, v67
    s_nop 0
    ds_write_b128 v218, v[52:55]
    v_xor_b32 v221, 32, v218
    ds_write_b128 v221, v[56:59]
    v_cvt_pk_bf16_f32 v84, v84, v85
    v_cvt_pk_bf16_f32 v85, v86, v87
    v_cvt_pk_bf16_f32 v86, v88, v89
    v_cvt_pk_bf16_f32 v87, v90, v91
    v_cvt_pk_bf16_f32 v88, v92, v93
    v_cvt_pk_bf16_f32 v89, v94, v95
    v_cvt_pk_bf16_f32 v90, v96, v97
    v_cvt_pk_bf16_f32 v91, v98, v99
    v_xor_b32 v221, 64, v218
    ds_write_b128 v221, v[84:87]
    v_xor_b32 v221, 96, v218
    ds_write_b128 v221, v[88:91]
    s_waitcnt lgkmcnt(0)
    ds_read_b128 v[60:63], v219 offset:0
    ds_read_b128 v[64:67], v219 offset:1024
    ds_read_b128 v[92:95], v219 offset:2048
    ds_read_b128 v[96:99], v219 offset:3072
    s_add_u32 s26, s25, 4096
    s_waitcnt lgkmcnt(3)
    buffer_store_dwordx4 v[60:63], v220, s[12:15], s26 offen
    s_add_u32 s26, s25, 5120
    s_waitcnt lgkmcnt(2)
    buffer_store_dwordx4 v[64:67], v220, s[12:15], s26 offen
    s_add_u32 s26, s25, 6144
    s_waitcnt lgkmcnt(1)
    buffer_store_dwordx4 v[92:95], v220, s[12:15], s26 offen
    s_add_u32 s26, s25, 7168
    s_waitcnt lgkmcnt(0)
    buffer_store_dwordx4 v[96:99], v220, s[12:15], s26 offen
    v_cvt_pk_bf16_f32 v116, v116, v117
    v_cvt_pk_bf16_f32 v117, v118, v119
    v_cvt_pk_bf16_f32 v118, v120, v121
    v_cvt_pk_bf16_f32 v119, v122, v123
    v_cvt_pk_bf16_f32 v120, v124, v125
    v_cvt_pk_bf16_f32 v121, v126, v127
    v_cvt_pk_bf16_f32 v122, v128, v129
    v_cvt_pk_bf16_f32 v123, v130, v131
    s_nop 0
    ds_write_b128 v218, v[116:119]
    v_xor_b32 v221, 32, v218
    ds_write_b128 v221, v[120:123]
    v_cvt_pk_bf16_f32 v148, v148, v149
    v_cvt_pk_bf16_f32 v149, v150, v151
    v_cvt_pk_bf16_f32 v150, v152, v153
    v_cvt_pk_bf16_f32 v151, v154, v155
    v_cvt_pk_bf16_f32 v152, v156, v157
    v_cvt_pk_bf16_f32 v153, v158, v159
    v_cvt_pk_bf16_f32 v154, v160, v161
    v_cvt_pk_bf16_f32 v155, v162, v163
    v_xor_b32 v221, 64, v218
    ds_write_b128 v221, v[148:151]
    v_xor_b32 v221, 96, v218
    ds_write_b128 v221, v[152:155]
    s_waitcnt lgkmcnt(0)
    ds_read_b128 v[124:127], v219 offset:0
    ds_read_b128 v[128:131], v219 offset:1024
    ds_read_b128 v[156:159], v219 offset:2048
    ds_read_b128 v[160:163], v219 offset:3072
    s_add_u32 s26, s25, 20480
    s_waitcnt lgkmcnt(3)
    buffer_store_dwordx4 v[124:127], v220, s[12:15], s26 offen
    s_add_u32 s26, s25, 21504
    s_waitcnt lgkmcnt(2)
    buffer_store_dwordx4 v[128:131], v220, s[12:15], s26 offen
    s_add_u32 s26, s25, 22528
    s_waitcnt lgkmcnt(1)
    buffer_store_dwordx4 v[156:159], v220, s[12:15], s26 offen
    s_add_u32 s26, s25, 23552
    s_waitcnt lgkmcnt(0)
    buffer_store_dwordx4 v[160:163], v220, s[12:15], s26 offen
    s_nop 1
    s_branch L_proj_kernel_kva_3
L_proj_kernel_kva_3:
    s_cmp_ge_u32 s2, 160
    s_cbranch_scc1 L_proj_kernel_end_1
    s_cmp_ge_u32 s24, 4
    s_cbranch_scc1 L_proj_kernel_idle_12
    s_cmp_ge_u32 s2, 144
    s_cbranch_scc1 L_proj_kernel_va_13
    s_mov_b32 s4, s66
    s_and_b32 s5, s67, 0xffff
    s_mov_b32 s6, 0x400000
    s_mov_b32 s7, 0x20000
    s_mov_b32 s8, s70
    s_and_b32 s9, s71, 0xffff
    s_mov_b32 s10, 0x10000
    s_mov_b32 s11, 0x20000
    s_mov_b32 s16, 2048
    s_mov_b32 s17, 64
    s_mov_b32 s18, 16
    s_and_b32 s79, s2, 15
    s_lshl_b32 s19, s79, 18
    s_mov_b32 s20, 0
    s_mul_i32 s25, s24, 32
    s_add_u32 s25, s25, 0
    v_lshrrev_b32 v2, 3, v1
    v_add_u32 v2, s25, v2
    v_lshrrev_b32 v3, 1, v2
    v_and_b32 v3, 7, v3
    v_and_b32 v4, 7, v1
    v_xor_b32 v3, v3, v4
    v_mul_lo_u32 v2, v2, s16
    v_lshl_add_u32 v2, v3, 4, v2
    v_add_u32 v6, s19, v2
    s_mul_i32 s25, s24, 32
    s_add_u32 s25, s25, 8
    v_lshrrev_b32 v2, 3, v1
    v_add_u32 v2, s25, v2
    v_lshrrev_b32 v3, 1, v2
    v_and_b32 v3, 7, v3
    v_and_b32 v4, 7, v1
    v_xor_b32 v3, v3, v4
    v_mul_lo_u32 v2, v2, s16
    v_lshl_add_u32 v2, v3, 4, v2
    v_add_u32 v7, s19, v2
    s_mul_i32 s25, s24, 32
    s_add_u32 s25, s25, 16
    v_lshrrev_b32 v2, 3, v1
    v_add_u32 v2, s25, v2
    v_lshrrev_b32 v3, 1, v2
    v_and_b32 v3, 7, v3
    v_and_b32 v4, 7, v1
    v_xor_b32 v3, v3, v4
    v_mul_lo_u32 v2, v2, s16
    v_lshl_add_u32 v2, v3, 4, v2
    v_add_u32 v8, s19, v2
    s_mul_i32 s25, s24, 32
    s_add_u32 s25, s25, 24
    v_lshrrev_b32 v2, 3, v1
    v_add_u32 v2, s25, v2
    v_lshrrev_b32 v3, 1, v2
    v_and_b32 v3, 7, v3
    v_and_b32 v4, 7, v1
    v_xor_b32 v3, v3, v4
    v_mul_lo_u32 v2, v2, s16
    v_lshl_add_u32 v2, v3, 4, v2
    v_add_u32 v9, s19, v2
    s_mul_i32 s25, s24, 16
    s_add_u32 s25, s25, 0
    v_lshrrev_b32 v2, 2, v1
    v_add_u32 v2, s25, v2
    v_mov_b32 v3, 0
    v_lshlrev_b32 v3, 2, v3
    v_and_b32 v4, 3, v1
    v_xor_b32 v3, v3, v4
    v_mul_lo_u32 v2, v2, s17
    v_lshl_add_u32 v2, v3, 4, v2
    v_add_u32 v10, s20, v2
    s_mov_b32 s27, 0
    s_mov_b32 s28, 0
    s_mov_b32 s29, 0
    s_mov_b32 s30, 0
    s_mov_b32 s31, 20480
    s_mul_i32 s33, s24, 4096
    s_mul_i32 s34, s24, 1024
    s_add_u32 s34, s34, 16384
    s_mul_i32 s35, s17, 64
    s_mov_b32 s38, s18
    s_add_u32 s36, s29, s33
    s_add_u32 m0, s36, 0
    s_nop 0
    buffer_load_dwordx4 v6, s[4:7], s27 offen lds
    s_add_u32 m0, s36, 1024
    s_nop 0
    buffer_load_dwordx4 v7, s[4:7], s27 offen lds
    s_add_u32 m0, s36, 2048
    s_nop 0
    buffer_load_dwordx4 v8, s[4:7], s27 offen lds
    s_add_u32 m0, s36, 3072
    s_nop 0
    buffer_load_dwordx4 v9, s[4:7], s27 offen lds
    s_add_u32 s37, s29, s34
    s_add_u32 m0, s37, 0
    s_nop 0
    buffer_load_dwordx4 v10, s[8:11], s28 offen lds
    s_add_u32 s27, s27, 128
    s_add_u32 s28, s28, s35
    s_add_u32 s29, s29, 20480
    s_cmp_eq_u32 s29, 102400
    s_cselect_b32 s29, 0, s29
    s_add_u32 s36, s29, s33
    s_add_u32 m0, s36, 0
    s_nop 0
    buffer_load_dwordx4 v6, s[4:7], s27 offen lds
    s_add_u32 m0, s36, 1024
    s_nop 0
    buffer_load_dwordx4 v7, s[4:7], s27 offen lds
    s_add_u32 m0, s36, 2048
    s_nop 0
    buffer_load_dwordx4 v8, s[4:7], s27 offen lds
    s_add_u32 m0, s36, 3072
    s_nop 0
    buffer_load_dwordx4 v9, s[4:7], s27 offen lds
    s_add_u32 s37, s29, s34
    s_add_u32 m0, s37, 0
    s_nop 0
    buffer_load_dwordx4 v10, s[8:11], s28 offen lds
    s_add_u32 s27, s27, 128
    s_add_u32 s28, s28, s35
    s_add_u32 s29, s29, 20480
    s_cmp_eq_u32 s29, 102400
    s_cselect_b32 s29, 0, s29
    s_add_u32 s36, s29, s33
    s_add_u32 m0, s36, 0
    s_nop 0
    buffer_load_dwordx4 v6, s[4:7], s27 offen lds
    s_add_u32 m0, s36, 1024
    s_nop 0
    buffer_load_dwordx4 v7, s[4:7], s27 offen lds
    s_add_u32 m0, s36, 2048
    s_nop 0
    buffer_load_dwordx4 v8, s[4:7], s27 offen lds
    s_add_u32 m0, s36, 3072
    s_nop 0
    buffer_load_dwordx4 v9, s[4:7], s27 offen lds
    s_add_u32 s37, s29, s34
    s_add_u32 m0, s37, 0
    s_nop 0
    buffer_load_dwordx4 v10, s[8:11], s28 offen lds
    s_add_u32 s27, s27, 128
    s_add_u32 s28, s28, s35
    s_add_u32 s29, s29, 20480
    s_cmp_eq_u32 s29, 102400
    s_cselect_b32 s29, 0, s29
    s_add_u32 s36, s29, s33
    s_add_u32 m0, s36, 0
    s_nop 0
    buffer_load_dwordx4 v6, s[4:7], s27 offen lds
    s_add_u32 m0, s36, 1024
    s_nop 0
    buffer_load_dwordx4 v7, s[4:7], s27 offen lds
    s_add_u32 m0, s36, 2048
    s_nop 0
    buffer_load_dwordx4 v8, s[4:7], s27 offen lds
    s_add_u32 m0, s36, 3072
    s_nop 0
    buffer_load_dwordx4 v9, s[4:7], s27 offen lds
    s_add_u32 s37, s29, s34
    s_add_u32 m0, s37, 0
    s_nop 0
    buffer_load_dwordx4 v10, s[8:11], s28 offen lds
    s_add_u32 s27, s27, 128
    s_add_u32 s28, s28, s35
    s_add_u32 s29, s29, 20480
    s_cmp_eq_u32 s29, 102400
    s_cselect_b32 s29, 0, s29
    s_add_u32 s12, s74, 0x4800000
    s_addc_u32 s13, s75, 0
    s_and_b32 s13, s13, 0xffff
    s_mov_b32 s14, 0x20000
    s_mov_b32 s15, 0x20000
    s_mov_b32 s23, 1.0
    s_mov_b32 s22, 64
    s_and_b32 s79, s2, 15
    s_lshl_b32 s21, s79, 13
    s_and_b32 s39, s24, 3
    s_lshr_b32 s40, s24, 2
    s_mul_i32 s25, s39, 32
    v_and_b32 v2, 31, v1
    v_add_u32 v2, s25, v2
    v_lshrrev_b32 v3, 1, v2
    v_and_b32 v3, 7, v3
    v_lshrrev_b32 v4, 5, v1
    v_xor_b32 v3, v3, v4
    v_lshlrev_b32 v2, 7, v2
    v_xor_b32 v4, 0, v3
    v_lshl_add_u32 v31, v4, 4, v2
    v_xor_b32 v4, 2, v3
    v_lshl_add_u32 v32, v4, 4, v2
    v_xor_b32 v4, 4, v3
    v_lshl_add_u32 v33, v4, 4, v2
    v_xor_b32 v4, 6, v3
    v_lshl_add_u32 v34, v4, 4, v2
    v_lshrrev_b32 v2, 5, v1
    v_lshlrev_b32 v2, 3, v2
    v_bfe_u32 v3, v1, 2, 2
    v_add_u32 v2, v2, v3
    v_mov_b32 v3, 0
    v_lshlrev_b32 v3, 2, v3
    v_lshlrev_b32 v2, 6, v2
    s_mul_i32 s25, s40, 4
    s_add_u32 s25, s25, 0
    v_bfe_u32 v4, v1, 4, 1
    v_lshlrev_b32 v4, 1, v4
    v_bfe_u32 v5, v1, 1, 1
    v_add3_u32 v4, v4, v5, s25
    v_xor_b32 v4, v4, v3
    v_lshl_add_u32 v4, v4, 4, v2
    v_and_b32 v5, 1, v1
    v_lshl_add_u32 v4, v5, 3, v4
    v_add_u32 v35, 16384, v4
    v_mov_b32 v36, 0
    v_mov_b32 v37, 0
    v_mov_b32 v38, 0
    v_mov_b32 v39, 0
    v_mov_b32 v40, 0
    v_mov_b32 v41, 0
    v_mov_b32 v42, 0
    v_mov_b32 v43, 0
    v_mov_b32 v44, 0
    v_mov_b32 v45, 0
    v_mov_b32 v46, 0
    v_mov_b32 v47, 0
    v_mov_b32 v48, 0
    v_mov_b32 v49, 0
    v_mov_b32 v50, 0
    v_mov_b32 v51, 0
    s_waitcnt vmcnt(10)
    s_barrier
    ds_read_b128 v[52:55], v31 offset:0
    ds_read_b64_tr_b16 v[84:85], v35 offset:0
    ds_read_b64_tr_b16 v[86:87], v35 offset:256
    ds_read_b128 v[56:59], v32 offset:0
    ds_read_b64_tr_b16 v[88:89], v35 offset:1024
    ds_read_b64_tr_b16 v[90:91], v35 offset:1280
    ds_read_b128 v[60:63], v33 offset:0
    ds_read_b64_tr_b16 v[92:93], v35 offset:2048
    ds_read_b64_tr_b16 v[94:95], v35 offset:2304
    ds_read_b128 v[64:67], v34 offset:0
    ds_read_b64_tr_b16 v[96:97], v35 offset:3072
    ds_read_b64_tr_b16 v[98:99], v35 offset:3328
    s_sub_u32 s32, s38, 4
L_proj_kernel_main_14:
    v_add_u32 v116, s31, v31
    v_add_u32 v117, s31, v32
    v_add_u32 v118, s31, v33
    v_add_u32 v119, s31, v34
    v_add_u32 v120, s31, v35
    s_waitcnt lgkmcnt(0)
    v_mfma_f32_32x32x16_bf16 v[36:51], v[84:87], v[52:55], v[36:51]
    ds_read_b128 v[68:71], v116 offset:0
    ds_read_b64_tr_b16 v[100:101], v120 offset:0
    s_add_u32 s36, s29, s33
    s_add_u32 m0, s36, 0
    s_nop 0
    buffer_load_dwordx4 v6, s[4:7], s27 offen lds
    ds_read_b64_tr_b16 v[102:103], v120 offset:256
    ds_read_b128 v[72:75], v117 offset:0
    v_mfma_f32_32x32x16_bf16 v[36:51], v[88:91], v[56:59], v[36:51]
    s_add_u32 m0, s36, 1024
    s_nop 0
    buffer_load_dwordx4 v7, s[4:7], s27 offen lds
    ds_read_b64_tr_b16 v[104:105], v120 offset:1024
    ds_read_b64_tr_b16 v[106:107], v120 offset:1280
    s_add_u32 m0, s36, 2048
    s_nop 0
    buffer_load_dwordx4 v8, s[4:7], s27 offen lds
    ds_read_b128 v[76:79], v118 offset:0
    v_mfma_f32_32x32x16_bf16 v[36:51], v[92:95], v[60:63], v[36:51]
    ds_read_b64_tr_b16 v[108:109], v120 offset:2048
    s_add_u32 m0, s36, 3072
    s_nop 0
    buffer_load_dwordx4 v9, s[4:7], s27 offen lds
    ds_read_b64_tr_b16 v[110:111], v120 offset:2304
    ds_read_b128 v[80:83], v119 offset:0
    s_add_u32 s37, s29, s34
    s_add_u32 m0, s37, 0
    s_nop 0
    buffer_load_dwordx4 v10, s[8:11], s28 offen lds
    v_mfma_f32_32x32x16_bf16 v[36:51], v[96:99], v[64:67], v[36:51]
    ds_read_b64_tr_b16 v[112:113], v120 offset:3072
    ds_read_b64_tr_b16 v[114:115], v120 offset:3328
    s_add_u32 s27, s27, 128
    s_add_u32 s28, s28, s35
    s_add_u32 s29, s29, 20480
    s_cmp_eq_u32 s29, 102400
    s_cselect_b32 s29, 0, s29
    s_add_u32 s31, s31, 20480
    s_cmp_eq_u32 s31, 102400
    s_cselect_b32 s31, 0, s31
    s_waitcnt vmcnt(10)
    s_barrier
    v_add_u32 v116, s31, v31
    v_add_u32 v117, s31, v32
    v_add_u32 v118, s31, v33
    v_add_u32 v119, s31, v34
    v_add_u32 v120, s31, v35
    s_waitcnt lgkmcnt(0)
    v_mfma_f32_32x32x16_bf16 v[36:51], v[100:103], v[68:71], v[36:51]
    ds_read_b128 v[52:55], v116 offset:0
    ds_read_b64_tr_b16 v[84:85], v120 offset:0
    s_add_u32 s36, s29, s33
    s_add_u32 m0, s36, 0
    s_nop 0
    buffer_load_dwordx4 v6, s[4:7], s27 offen lds
    ds_read_b64_tr_b16 v[86:87], v120 offset:256
    ds_read_b128 v[56:59], v117 offset:0
    v_mfma_f32_32x32x16_bf16 v[36:51], v[104:107], v[72:75], v[36:51]
    s_add_u32 m0, s36, 1024
    s_nop 0
    buffer_load_dwordx4 v7, s[4:7], s27 offen lds
    ds_read_b64_tr_b16 v[88:89], v120 offset:1024
    ds_read_b64_tr_b16 v[90:91], v120 offset:1280
    s_add_u32 m0, s36, 2048
    s_nop 0
    buffer_load_dwordx4 v8, s[4:7], s27 offen lds
    ds_read_b128 v[60:63], v118 offset:0
    v_mfma_f32_32x32x16_bf16 v[36:51], v[108:111], v[76:79], v[36:51]
    ds_read_b64_tr_b16 v[92:93], v120 offset:2048
    s_add_u32 m0, s36, 3072
    s_nop 0
    buffer_load_dwordx4 v9, s[4:7], s27 offen lds
    ds_read_b64_tr_b16 v[94:95], v120 offset:2304
    ds_read_b128 v[64:67], v119 offset:0
    s_add_u32 s37, s29, s34
    s_add_u32 m0, s37, 0
    s_nop 0
    buffer_load_dwordx4 v10, s[8:11], s28 offen lds
    v_mfma_f32_32x32x16_bf16 v[36:51], v[112:115], v[80:83], v[36:51]
    ds_read_b64_tr_b16 v[96:97], v120 offset:3072
    ds_read_b64_tr_b16 v[98:99], v120 offset:3328
    s_add_u32 s27, s27, 128
    s_add_u32 s28, s28, s35
    s_add_u32 s29, s29, 20480
    s_cmp_eq_u32 s29, 102400
    s_cselect_b32 s29, 0, s29
    s_add_u32 s31, s31, 20480
    s_cmp_eq_u32 s31, 102400
    s_cselect_b32 s31, 0, s31
    s_waitcnt vmcnt(10)
    s_barrier
    s_sub_u32 s32, s32, 2
    s_cmp_lg_u32 s32, 0
    s_cbranch_scc1 L_proj_kernel_main_14
    s_mov_b32 s32, 4
L_proj_kernel_tail_15:
    v_add_u32 v116, s31, v31
    v_add_u32 v117, s31, v32
    v_add_u32 v118, s31, v33
    v_add_u32 v119, s31, v34
    v_add_u32 v120, s31, v35
    s_waitcnt lgkmcnt(0)
    v_mfma_f32_32x32x16_bf16 v[36:51], v[84:87], v[52:55], v[36:51]
    ds_read_b128 v[68:71], v116 offset:0
    ds_read_b64_tr_b16 v[100:101], v120 offset:0
    ds_read_b64_tr_b16 v[102:103], v120 offset:256
    v_mfma_f32_32x32x16_bf16 v[36:51], v[88:91], v[56:59], v[36:51]
    ds_read_b128 v[72:75], v117 offset:0
    ds_read_b64_tr_b16 v[104:105], v120 offset:1024
    ds_read_b64_tr_b16 v[106:107], v120 offset:1280
    v_mfma_f32_32x32x16_bf16 v[36:51], v[92:95], v[60:63], v[36:51]
    ds_read_b128 v[76:79], v118 offset:0
    ds_read_b64_tr_b16 v[108:109], v120 offset:2048
    ds_read_b64_tr_b16 v[110:111], v120 offset:2304
    v_mfma_f32_32x32x16_bf16 v[36:51], v[96:99], v[64:67], v[36:51]
    ds_read_b128 v[80:83], v119 offset:0
    ds_read_b64_tr_b16 v[112:113], v120 offset:3072
    ds_read_b64_tr_b16 v[114:115], v120 offset:3328
    s_add_u32 s31, s31, 20480
    s_cmp_eq_u32 s31, 102400
    s_cselect_b32 s31, 0, s31
    s_waitcnt vmcnt(0)
    s_barrier
    v_add_u32 v116, s31, v31
    v_add_u32 v117, s31, v32
    v_add_u32 v118, s31, v33
    v_add_u32 v119, s31, v34
    v_add_u32 v120, s31, v35
    s_waitcnt lgkmcnt(0)
    v_mfma_f32_32x32x16_bf16 v[36:51], v[100:103], v[68:71], v[36:51]
    ds_read_b128 v[52:55], v116 offset:0
    ds_read_b64_tr_b16 v[84:85], v120 offset:0
    ds_read_b64_tr_b16 v[86:87], v120 offset:256
    v_mfma_f32_32x32x16_bf16 v[36:51], v[104:107], v[72:75], v[36:51]
    ds_read_b128 v[56:59], v117 offset:0
    ds_read_b64_tr_b16 v[88:89], v120 offset:1024
    ds_read_b64_tr_b16 v[90:91], v120 offset:1280
    v_mfma_f32_32x32x16_bf16 v[36:51], v[108:111], v[76:79], v[36:51]
    ds_read_b128 v[60:63], v118 offset:0
    ds_read_b64_tr_b16 v[92:93], v120 offset:2048
    ds_read_b64_tr_b16 v[94:95], v120 offset:2304
    v_mfma_f32_32x32x16_bf16 v[36:51], v[112:115], v[80:83], v[36:51]
    ds_read_b128 v[64:67], v119 offset:0
    ds_read_b64_tr_b16 v[96:97], v120 offset:3072
    ds_read_b64_tr_b16 v[98:99], v120 offset:3328
    s_add_u32 s31, s31, 20480
    s_cmp_eq_u32 s31, 102400
    s_cselect_b32 s31, 0, s31
    s_waitcnt vmcnt(0)
    s_barrier
    s_sub_u32 s32, s32, 2
    s_cmp_lg_u32 s32, 0
    s_cbranch_scc1 L_proj_kernel_tail_15
    s_waitcnt lgkmcnt(0)
    s_nop 15
    s_lshl_b32 s25, s24, 12
    s_add_u32 s25, s25, 131072
    v_and_b32 v125, 31, v1
    v_lshlrev_b32 v122, 6, v125
    v_add_u32 v122, s25, v122
    v_and_b32 v125, 3, v125
    v_lshrrev_b32 v123, 5, v1
    v_xor_b32 v125, v125, v123
    v_lshl_add_u32 v122, v125, 4, v122
    v_lshrrev_b32 v125, 2, v1
    v_xor_b32 v123, v125, v1
    v_and_b32 v123, 3, v123
    v_lshlrev_b32 v123, 4, v123
    v_lshl_add_u32 v123, v125, 6, v123
    v_add_u32 v123, s25, v123
    v_mul_lo_u32 v124, v125, s22
    v_and_b32 v125, 3, v1
    v_lshl_add_u32 v124, v125, 4, v124
    s_mul_i32 s25, s39, 32
    s_mul_i32 s25, s25, s22
    s_add_u32 s25, s25, s21
    s_mul_i32 s26, s40, 64
    s_add_u32 s25, s25, s26
    s_mul_i32 s26, s22, 16
    v_cvt_pk_bf16_f32 v36, v36, v37
    v_cvt_pk_bf16_f32 v37, v38, v39
    v_cvt_pk_bf16_f32 v38, v40, v41
    v_cvt_pk_bf16_f32 v39, v42, v43
    v_cvt_pk_bf16_f32 v40, v44, v45
    v_cvt_pk_bf16_f32 v41, v46, v47
    v_cvt_pk_bf16_f32 v42, v48, v49
    v_cvt_pk_bf16_f32 v43, v50, v51
    s_nop 1
    v_permlane32_swap_b32 v36, v38
    v_permlane32_swap_b32 v37, v39
    v_permlane32_swap_b32 v40, v42
    v_permlane32_swap_b32 v41, v43
    s_nop 0
    ds_write_b128 v122, v[36:39]
    v_xor_b32 v125, 32, v122
    ds_write_b128 v125, v[40:43]
    s_waitcnt lgkmcnt(0)
    ds_read_b128 v[44:47], v123 offset:0
    ds_read_b128 v[48:51], v123 offset:1024
    s_waitcnt lgkmcnt(1)
    buffer_store_dwordx4 v[44:47], v124, s[12:15], s25 offen
    s_add_u32 s25, s25, s26
    s_waitcnt lgkmcnt(0)
    buffer_store_dwordx4 v[48:51], v124, s[12:15], s25 offen
    s_add_u32 s25, s25, s26
    s_nop 1
    s_branch L_proj_kernel_end_1
L_proj_kernel_va_13:
    s_mov_b32 s4, s66
    s_and_b32 s5, s67, 0xffff
    s_mov_b32 s6, 0x400000
    s_mov_b32 s7, 0x20000
    s_mov_b32 s8, s72
    s_and_b32 s9, s73, 0xffff
    s_mov_b32 s10, 0x10000
    s_mov_b32 s11, 0x20000
    s_mov_b32 s16, 2048
    s_mov_b32 s17, 64
    s_mov_b32 s18, 16
    s_and_b32 s79, s2, 15
    s_lshl_b32 s19, s79, 18
    s_mov_b32 s20, 0
    s_mul_i32 s25, s24, 32
    s_add_u32 s25, s25, 0
    v_lshrrev_b32 v2, 3, v1
    v_add_u32 v2, s25, v2
    v_lshrrev_b32 v3, 1, v2
    v_and_b32 v3, 7, v3
    v_and_b32 v4, 7, v1
    v_xor_b32 v3, v3, v4
    v_mul_lo_u32 v2, v2, s16
    v_lshl_add_u32 v2, v3, 4, v2
    v_add_u32 v14, s19, v2
    s_mul_i32 s25, s24, 32
    s_add_u32 s25, s25, 8
    v_lshrrev_b32 v2, 3, v1
    v_add_u32 v2, s25, v2
    v_lshrrev_b32 v3, 1, v2
    v_and_b32 v3, 7, v3
    v_and_b32 v4, 7, v1
    v_xor_b32 v3, v3, v4
    v_mul_lo_u32 v2, v2, s16
    v_lshl_add_u32 v2, v3, 4, v2
    v_add_u32 v15, s19, v2
    s_mul_i32 s25, s24, 32
    s_add_u32 s25, s25, 16
    v_lshrrev_b32 v2, 3, v1
    v_add_u32 v2, s25, v2
    v_lshrrev_b32 v3, 1, v2
    v_and_b32 v3, 7, v3
    v_and_b32 v4, 7, v1
    v_xor_b32 v3, v3, v4
    v_mul_lo_u32 v2, v2, s16
    v_lshl_add_u32 v2, v3, 4, v2
    v_add_u32 v16, s19, v2
    s_mul_i32 s25, s24, 32
    s_add_u32 s25, s25, 24
    v_lshrrev_b32 v2, 3, v1
    v_add_u32 v2, s25, v2
    v_lshrrev_b32 v3, 1, v2
    v_and_b32 v3, 7, v3
    v_and_b32 v4, 7, v1
    v_xor_b32 v3, v3, v4
    v_mul_lo_u32 v2, v2, s16
    v_lshl_add_u32 v2, v3, 4, v2
    v_add_u32 v17, s19, v2
    s_mul_i32 s25, s24, 16
    s_add_u32 s25, s25, 0
    v_lshrrev_b32 v2, 2, v1
    v_add_u32 v2, s25, v2
    v_mov_b32 v3, 0
    v_lshlrev_b32 v3, 2, v3
    v_and_b32 v4, 3, v1
    v_xor_b32 v3, v3, v4
    v_mul_lo_u32 v2, v2, s17
    v_lshl_add_u32 v2, v3, 4, v2
    v_add_u32 v18, s20, v2
    s_mov_b32 s41, 0
    s_mov_b32 s42, 0
    s_mov_b32 s43, 0
    s_mov_b32 s44, 0
    s_mov_b32 s45, 20480
    s_mul_i32 s47, s24, 4096
    s_mul_i32 s48, s24, 1024
    s_add_u32 s48, s48, 16384
    s_mul_i32 s49, s17, 64
    s_mov_b32 s52, s18
    s_add_u32 s50, s43, s47
    s_add_u32 m0, s50, 0
    s_nop 0
    buffer_load_dwordx4 v14, s[4:7], s41 offen lds
    s_add_u32 m0, s50, 1024
    s_nop 0
    buffer_load_dwordx4 v15, s[4:7], s41 offen lds
    s_add_u32 m0, s50, 2048
    s_nop 0
    buffer_load_dwordx4 v16, s[4:7], s41 offen lds
    s_add_u32 m0, s50, 3072
    s_nop 0
    buffer_load_dwordx4 v17, s[4:7], s41 offen lds
    s_add_u32 s51, s43, s48
    s_add_u32 m0, s51, 0
    s_nop 0
    buffer_load_dwordx4 v18, s[8:11], s42 offen lds
    s_add_u32 s41, s41, 128
    s_add_u32 s42, s42, s49
    s_add_u32 s43, s43, 20480
    s_cmp_eq_u32 s43, 102400
    s_cselect_b32 s43, 0, s43
    s_add_u32 s50, s43, s47
    s_add_u32 m0, s50, 0
    s_nop 0
    buffer_load_dwordx4 v14, s[4:7], s41 offen lds
    s_add_u32 m0, s50, 1024
    s_nop 0
    buffer_load_dwordx4 v15, s[4:7], s41 offen lds
    s_add_u32 m0, s50, 2048
    s_nop 0
    buffer_load_dwordx4 v16, s[4:7], s41 offen lds
    s_add_u32 m0, s50, 3072
    s_nop 0
    buffer_load_dwordx4 v17, s[4:7], s41 offen lds
    s_add_u32 s51, s43, s48
    s_add_u32 m0, s51, 0
    s_nop 0
    buffer_load_dwordx4 v18, s[8:11], s42 offen lds
    s_add_u32 s41, s41, 128
    s_add_u32 s42, s42, s49
    s_add_u32 s43, s43, 20480
    s_cmp_eq_u32 s43, 102400
    s_cselect_b32 s43, 0, s43
    s_add_u32 s50, s43, s47
    s_add_u32 m0, s50, 0
    s_nop 0
    buffer_load_dwordx4 v14, s[4:7], s41 offen lds
    s_add_u32 m0, s50, 1024
    s_nop 0
    buffer_load_dwordx4 v15, s[4:7], s41 offen lds
    s_add_u32 m0, s50, 2048
    s_nop 0
    buffer_load_dwordx4 v16, s[4:7], s41 offen lds
    s_add_u32 m0, s50, 3072
    s_nop 0
    buffer_load_dwordx4 v17, s[4:7], s41 offen lds
    s_add_u32 s51, s43, s48
    s_add_u32 m0, s51, 0
    s_nop 0
    buffer_load_dwordx4 v18, s[8:11], s42 offen lds
    s_add_u32 s41, s41, 128
    s_add_u32 s42, s42, s49
    s_add_u32 s43, s43, 20480
    s_cmp_eq_u32 s43, 102400
    s_cselect_b32 s43, 0, s43
    s_add_u32 s50, s43, s47
    s_add_u32 m0, s50, 0
    s_nop 0
    buffer_load_dwordx4 v14, s[4:7], s41 offen lds
    s_add_u32 m0, s50, 1024
    s_nop 0
    buffer_load_dwordx4 v15, s[4:7], s41 offen lds
    s_add_u32 m0, s50, 2048
    s_nop 0
    buffer_load_dwordx4 v16, s[4:7], s41 offen lds
    s_add_u32 m0, s50, 3072
    s_nop 0
    buffer_load_dwordx4 v17, s[4:7], s41 offen lds
    s_add_u32 s51, s43, s48
    s_add_u32 m0, s51, 0
    s_nop 0
    buffer_load_dwordx4 v18, s[8:11], s42 offen lds
    s_add_u32 s41, s41, 128
    s_add_u32 s42, s42, s49
    s_add_u32 s43, s43, 20480
    s_cmp_eq_u32 s43, 102400
    s_cselect_b32 s43, 0, s43
    s_add_u32 s12, s74, 0x4900000
    s_addc_u32 s13, s75, 0
    s_and_b32 s13, s13, 0xffff
    s_mov_b32 s14, 0x20000
    s_mov_b32 s15, 0x20000
    s_mov_b32 s23, 1.0
    s_mov_b32 s22, 64
    s_and_b32 s79, s2, 15
    s_lshl_b32 s21, s79, 13
    s_and_b32 s53, s24, 3
    s_lshr_b32 s54, s24, 2
    s_mul_i32 s25, s53, 32
    v_and_b32 v2, 31, v1
    v_add_u32 v2, s25, v2
    v_lshrrev_b32 v3, 1, v2
    v_and_b32 v3, 7, v3
    v_lshrrev_b32 v4, 5, v1
    v_xor_b32 v3, v3, v4
    v_lshlrev_b32 v2, 7, v2
    v_xor_b32 v4, 0, v3
    v_lshl_add_u32 v31, v4, 4, v2
    v_xor_b32 v4, 2, v3
    v_lshl_add_u32 v32, v4, 4, v2
    v_xor_b32 v4, 4, v3
    v_lshl_add_u32 v33, v4, 4, v2
    v_xor_b32 v4, 6, v3
    v_lshl_add_u32 v34, v4, 4, v2
    v_lshrrev_b32 v2, 5, v1
    v_lshlrev_b32 v2, 3, v2
    v_bfe_u32 v3, v1, 2, 2
    v_add_u32 v2, v2, v3
    v_mov_b32 v3, 0
    v_lshlrev_b32 v3, 2, v3
    v_lshlrev_b32 v2, 6, v2
    s_mul_i32 s25, s54, 4
    s_add_u32 s25, s25, 0
    v_bfe_u32 v4, v1, 4, 1
    v_lshlrev_b32 v4, 1, v4
    v_bfe_u32 v5, v1, 1, 1
    v_add3_u32 v4, v4, v5, s25
    v_xor_b32 v4, v4, v3
    v_lshl_add_u32 v4, v4, 4, v2
    v_and_b32 v5, 1, v1
    v_lshl_add_u32 v4, v5, 3, v4
    v_add_u32 v35, 16384, v4
    v_mov_b32 v36, 0
    v_mov_b32 v37, 0
    v_mov_b32 v38, 0
    v_mov_b32 v39, 0
    v_mov_b32 v40, 0
    v_mov_b32 v41, 0
    v_mov_b32 v42, 0
    v_mov_b32 v43, 0
    v_mov_b32 v44, 0
    v_mov_b32 v45, 0
    v_mov_b32 v46, 0
    v_mov_b32 v47, 0
    v_mov_b32 v48, 0
    v_mov_b32 v49, 0
    v_mov_b32 v50, 0
    v_mov_b32 v51, 0
    s_waitcnt vmcnt(10)
    s_barrier
    ds_read_b128 v[52:55], v31 offset:0
    ds_read_b64_tr_b16 v[84:85], v35 offset:0
    ds_read_b64_tr_b16 v[86:87], v35 offset:256
    ds_read_b128 v[56:59], v32 offset:0
    ds_read_b64_tr_b16 v[88:89], v35 offset:1024
    ds_read_b64_tr_b16 v[90:91], v35 offset:1280
    ds_read_b128 v[60:63], v33 offset:0
    ds_read_b64_tr_b16 v[92:93], v35 offset:2048
    ds_read_b64_tr_b16 v[94:95], v35 offset:2304
    ds_read_b128 v[64:67], v34 offset:0
    ds_read_b64_tr_b16 v[96:97], v35 offset:3072
    ds_read_b64_tr_b16 v[98:99], v35 offset:3328
    s_sub_u32 s46, s52, 4
L_proj_kernel_main_16:
    v_add_u32 v116, s45, v31
    v_add_u32 v117, s45, v32
    v_add_u32 v118, s45, v33
    v_add_u32 v119, s45, v34
    v_add_u32 v120, s45, v35
    s_waitcnt lgkmcnt(0)
    v_mfma_f32_32x32x16_bf16 v[36:51], v[52:55], v[84:87], v[36:51]
    ds_read_b128 v[68:71], v116 offset:0
    ds_read_b64_tr_b16 v[100:101], v120 offset:0
    s_add_u32 s50, s43, s47
    s_add_u32 m0, s50, 0
    s_nop 0
    buffer_load_dwordx4 v14, s[4:7], s41 offen lds
    ds_read_b64_tr_b16 v[102:103], v120 offset:256
    ds_read_b128 v[72:75], v117 offset:0
    v_mfma_f32_32x32x16_bf16 v[36:51], v[56:59], v[88:91], v[36:51]
    s_add_u32 m0, s50, 1024
    s_nop 0
    buffer_load_dwordx4 v15, s[4:7], s41 offen lds
    ds_read_b64_tr_b16 v[104:105], v120 offset:1024
    ds_read_b64_tr_b16 v[106:107], v120 offset:1280
    s_add_u32 m0, s50, 2048
    s_nop 0
    buffer_load_dwordx4 v16, s[4:7], s41 offen lds
    ds_read_b128 v[76:79], v118 offset:0
    v_mfma_f32_32x32x16_bf16 v[36:51], v[60:63], v[92:95], v[36:51]
    ds_read_b64_tr_b16 v[108:109], v120 offset:2048
    s_add_u32 m0, s50, 3072
    s_nop 0
    buffer_load_dwordx4 v17, s[4:7], s41 offen lds
    ds_read_b64_tr_b16 v[110:111], v120 offset:2304
    ds_read_b128 v[80:83], v119 offset:0
    s_add_u32 s51, s43, s48
    s_add_u32 m0, s51, 0
    s_nop 0
    buffer_load_dwordx4 v18, s[8:11], s42 offen lds
    v_mfma_f32_32x32x16_bf16 v[36:51], v[64:67], v[96:99], v[36:51]
    ds_read_b64_tr_b16 v[112:113], v120 offset:3072
    ds_read_b64_tr_b16 v[114:115], v120 offset:3328
    s_add_u32 s41, s41, 128
    s_add_u32 s42, s42, s49
    s_add_u32 s43, s43, 20480
    s_cmp_eq_u32 s43, 102400
    s_cselect_b32 s43, 0, s43
    s_add_u32 s45, s45, 20480
    s_cmp_eq_u32 s45, 102400
    s_cselect_b32 s45, 0, s45
    s_waitcnt vmcnt(10)
    s_barrier
    v_add_u32 v116, s45, v31
    v_add_u32 v117, s45, v32
    v_add_u32 v118, s45, v33
    v_add_u32 v119, s45, v34
    v_add_u32 v120, s45, v35
    s_waitcnt lgkmcnt(0)
    v_mfma_f32_32x32x16_bf16 v[36:51], v[68:71], v[100:103], v[36:51]
    ds_read_b128 v[52:55], v116 offset:0
    ds_read_b64_tr_b16 v[84:85], v120 offset:0
    s_add_u32 s50, s43, s47
    s_add_u32 m0, s50, 0
    s_nop 0
    buffer_load_dwordx4 v14, s[4:7], s41 offen lds
    ds_read_b64_tr_b16 v[86:87], v120 offset:256
    ds_read_b128 v[56:59], v117 offset:0
    v_mfma_f32_32x32x16_bf16 v[36:51], v[72:75], v[104:107], v[36:51]
    s_add_u32 m0, s50, 1024
    s_nop 0
    buffer_load_dwordx4 v15, s[4:7], s41 offen lds
    ds_read_b64_tr_b16 v[88:89], v120 offset:1024
    ds_read_b64_tr_b16 v[90:91], v120 offset:1280
    s_add_u32 m0, s50, 2048
    s_nop 0
    buffer_load_dwordx4 v16, s[4:7], s41 offen lds
    ds_read_b128 v[60:63], v118 offset:0
    v_mfma_f32_32x32x16_bf16 v[36:51], v[76:79], v[108:111], v[36:51]
    ds_read_b64_tr_b16 v[92:93], v120 offset:2048
    s_add_u32 m0, s50, 3072
    s_nop 0
    buffer_load_dwordx4 v17, s[4:7], s41 offen lds
    ds_read_b64_tr_b16 v[94:95], v120 offset:2304
    ds_read_b128 v[64:67], v119 offset:0
    s_add_u32 s51, s43, s48
    s_add_u32 m0, s51, 0
    s_nop 0
    buffer_load_dwordx4 v18, s[8:11], s42 offen lds
    v_mfma_f32_32x32x16_bf16 v[36:51], v[80:83], v[112:115], v[36:51]
    ds_read_b64_tr_b16 v[96:97], v120 offset:3072
    ds_read_b64_tr_b16 v[98:99], v120 offset:3328
    s_add_u32 s41, s41, 128
    s_add_u32 s42, s42, s49
    s_add_u32 s43, s43, 20480
    s_cmp_eq_u32 s43, 102400
    s_cselect_b32 s43, 0, s43
    s_add_u32 s45, s45, 20480
    s_cmp_eq_u32 s45, 102400
    s_cselect_b32 s45, 0, s45
    s_waitcnt vmcnt(10)
    s_barrier
    s_sub_u32 s46, s46, 2
    s_cmp_lg_u32 s46, 0
    s_cbranch_scc1 L_proj_kernel_main_16
    s_mov_b32 s46, 4
L_proj_kernel_tail_17:
    v_add_u32 v116, s45, v31
    v_add_u32 v117, s45, v32
    v_add_u32 v118, s45, v33
    v_add_u32 v119, s45, v34
    v_add_u32 v120, s45, v35
    s_waitcnt lgkmcnt(0)
    v_mfma_f32_32x32x16_bf16 v[36:51], v[52:55], v[84:87], v[36:51]
    ds_read_b128 v[68:71], v116 offset:0
    ds_read_b64_tr_b16 v[100:101], v120 offset:0
    ds_read_b64_tr_b16 v[102:103], v120 offset:256
    v_mfma_f32_32x32x16_bf16 v[36:51], v[56:59], v[88:91], v[36:51]
    ds_read_b128 v[72:75], v117 offset:0
    ds_read_b64_tr_b16 v[104:105], v120 offset:1024
    ds_read_b64_tr_b16 v[106:107], v120 offset:1280
    v_mfma_f32_32x32x16_bf16 v[36:51], v[60:63], v[92:95], v[36:51]
    ds_read_b128 v[76:79], v118 offset:0
    ds_read_b64_tr_b16 v[108:109], v120 offset:2048
    ds_read_b64_tr_b16 v[110:111], v120 offset:2304
    v_mfma_f32_32x32x16_bf16 v[36:51], v[64:67], v[96:99], v[36:51]
    ds_read_b128 v[80:83], v119 offset:0
    ds_read_b64_tr_b16 v[112:113], v120 offset:3072
    ds_read_b64_tr_b16 v[114:115], v120 offset:3328
    s_add_u32 s45, s45, 20480
    s_cmp_eq_u32 s45, 102400
    s_cselect_b32 s45, 0, s45
    s_waitcnt vmcnt(0)
    s_barrier
    v_add_u32 v116, s45, v31
    v_add_u32 v117, s45, v32
    v_add_u32 v118, s45, v33
    v_add_u32 v119, s45, v34
    v_add_u32 v120, s45, v35
    s_waitcnt lgkmcnt(0)
    v_mfma_f32_32x32x16_bf16 v[36:51], v[68:71], v[100:103], v[36:51]
    ds_read_b128 v[52:55], v116 offset:0
    ds_read_b64_tr_b16 v[84:85], v120 offset:0
    ds_read_b64_tr_b16 v[86:87], v120 offset:256
    v_mfma_f32_32x32x16_bf16 v[36:51], v[72:75], v[104:107], v[36:51]
    ds_read_b128 v[56:59], v117 offset:0
    ds_read_b64_tr_b16 v[88:89], v120 offset:1024
    ds_read_b64_tr_b16 v[90:91], v120 offset:1280
    v_mfma_f32_32x32x16_bf16 v[36:51], v[76:79], v[108:111], v[36:51]
    ds_read_b128 v[60:63], v118 offset:0
    ds_read_b64_tr_b16 v[92:93], v120 offset:2048
    ds_read_b64_tr_b16 v[94:95], v120 offset:2304
    v_mfma_f32_32x32x16_bf16 v[36:51], v[80:83], v[112:115], v[36:51]
    ds_read_b128 v[64:67], v119 offset:0
    ds_read_b64_tr_b16 v[96:97], v120 offset:3072
    ds_read_b64_tr_b16 v[98:99], v120 offset:3328
    s_add_u32 s45, s45, 20480
    s_cmp_eq_u32 s45, 102400
    s_cselect_b32 s45, 0, s45
    s_waitcnt vmcnt(0)
    s_barrier
    s_sub_u32 s46, s46, 2
    s_cmp_lg_u32 s46, 0
    s_cbranch_scc1 L_proj_kernel_tail_17
    s_waitcnt lgkmcnt(0)
    s_nop 15
    s_lshl_b32 s25, s24, 12
    s_add_u32 s25, s25, 131072
    v_and_b32 v125, 31, v1
    v_lshlrev_b32 v122, 6, v125
    v_add_u32 v122, s25, v122
    v_and_b32 v125, 3, v125
    v_lshrrev_b32 v123, 5, v1
    v_xor_b32 v125, v125, v123
    v_lshl_add_u32 v122, v125, 4, v122
    v_lshrrev_b32 v125, 2, v1
    v_xor_b32 v123, v125, v1
    v_and_b32 v123, 3, v123
    v_lshlrev_b32 v123, 4, v123
    v_lshl_add_u32 v123, v125, 6, v123
    v_add_u32 v123, s25, v123
    v_lshlrev_b32 v124, 6, v125
    v_and_b32 v125, 3, v1
    v_lshl_add_u32 v124, v125, 4, v124
    s_mul_i32 s25, s53, 2048
    s_add_u32 s25, s25, s21
    s_mul_i32 s26, s54, 2048
    s_add_u32 s25, s25, s26
    v_cvt_pk_bf16_f32 v36, v36, v37
    v_cvt_pk_bf16_f32 v37, v38, v39
    v_cvt_pk_bf16_f32 v38, v40, v41
    v_cvt_pk_bf16_f32 v39, v42, v43
    v_cvt_pk_bf16_f32 v40, v44, v45
    v_cvt_pk_bf16_f32 v41, v46, v47
    v_cvt_pk_bf16_f32 v42, v48, v49
    v_cvt_pk_bf16_f32 v43, v50, v51
    s_nop 0
    ds_write_b128 v122, v[36:39]
    v_xor_b32 v125, 32, v122
    ds_write_b128 v125, v[40:43]
    s_waitcnt lgkmcnt(0)
    ds_read_b128 v[44:47], v123 offset:0
    ds_read_b128 v[48:51], v123 offset:1024
    s_add_u32 s26, s25, 0
    s_waitcnt lgkmcnt(1)
    buffer_store_dwordx4 v[44:47], v124, s[12:15], s26 offen
    s_add_u32 s26, s25, 1024
    s_waitcnt lgkmcnt(0)
    buffer_store_dwordx4 v[48:51], v124, s[12:15], s26 offen
    s_nop 1
    s_branch L_proj_kernel_end_1
L_proj_kernel_idle_12:
    s_mov_b32 s79, 17
L_proj_kernel_idlel_18:
    s_barrier
    s_sub_u32 s79, s79, 1
    s_cmp_lg_u32 s79, 0
    s_cbranch_scc1 L_proj_kernel_idlel_18
L_proj_kernel_end_1:
    s_endpgm
.globl attn_kernel
.p2align 8
.type attn_kernel,@function
attn_kernel:
    s_cmp_ge_u32 s2, 256
    s_cbranch_scc1 L_attn_kernel_end_1
    s_load_dwordx2 s[4:5], s[0:1], 104
    s_load_dwordx2 s[6:7], s[0:1], 80
    s_load_dwordx2 s[8:9], s[0:1], 32
    v_and_b32 v1, 63, v0
    v_lshrrev_b32 v2, 6, v0
    s_nop 0
    v_readfirstlane_b32 s32, v2
    s_mov_b32 s33, 0
    s_waitcnt lgkmcnt(0)
    s_mov_b32 s31, 0
    s_cmp_ge_u32 s32, 4
    s_cbranch_scc1 L_attn_kernel_attnA_3
    s_mov_b32 s28, s32
    s_mov_b32 s12, s4
    s_and_b32 s13, s5, 0xffff
    s_mov_b32 s14, 0x1000000
    s_mov_b32 s15, 0x20000
    s_add_u32 s16, s4, 0x1000000
    s_addc_u32 s17, s5, 0
    s_and_b32 s17, s17, 0xffff
    s_mov_b32 s18, 0x1000000
    s_mov_b32 s19, 0x20000
    s_add_u32 s20, s4, 0x2000000
    s_addc_u32 s21, s5, 0
    s_and_b32 s21, s21, 0xffff
    s_mov_b32 s22, 0x1000000
    s_mov_b32 s23, 0x20000
    s_add_u32 s24, s4, 0x3000000
    s_addc_u32 s25, s5, 0
    s_and_b32 s25, s25, 0xffff
    s_mov_b32 s26, 0x1000000
    s_mov_b32 s27, 0x20000
    s_and_b32 s34, s2, 31
    s_lshr_b32 s35, s2, 5
    s_sub_u32 s35, 15, s35
    v_lshrrev_b32 v4, 5, v1
    v_lshlrev_b32 v235, 2, v4
    v_lshrrev_b32 v2, 4, v1
    v_lshlrev_b32 v2, 12, v2
    v_and_b32 v3, 15, v1
    v_lshl_add_u32 v2, v3, 4, v2
    s_lshl_b32 s29, s28, 10
    v_add_u32 v237, s29, v2
    v_lshrrev_b32 v2, 4, v1
    v_lshlrev_b32 v2, 4, v2
    v_bfe_u32 v3, v1, 3, 1
    v_lshl_add_u32 v2, v3, 6, v2
    s_lshl_b32 s29, s28, 2
    v_lshlrev_b32 v3, 3, v3
    v_add_u32 v3, s29, v3
    v_and_b32 v3, 15, v3
    v_add_u32 v2, v2, v3
    v_lshlrev_b32 v2, 7, v2
    v_and_b32 v3, 7, v1
    v_lshl_add_u32 v238, v3, 4, v2
    v_and_b32 v2, 15, v1
    v_mul_u32_u24 v3, 1040, v2
    v_bfe_u32 v4, v1, 4, 1
    v_lshlrev_b32 v4, 8, v4
    v_lshl_add_u32 v4, v235, 2, v4
    v_add_u32 v239, v3, v4
    v_add_u32 v2, 8, v2
    v_and_b32 v2, 15, v2
    v_mul_u32_u24 v3, 1040, v2
    v_add_u32 v3, 33408, v3
    v_add_u32 v240, v3, v4
    s_mul_i32 s41, s28, 4160
    s_lshl_b32 s36, s35, 7
    s_lshl_b32 s29, s28, 5
    s_add_u32 s36, s36, s29
    s_lshl_b32 s39, s34, 19
    s_mov_b32 s40, s39
    v_and_b32 v2, 31, v1
    v_add_u32 v2, s36, v2
    v_lshlrev_b32 v3, 8, v2
    v_lshl_add_u32 v3, v235, 2, v3
    buffer_load_dwordx4 v[8:11], v3, s[12:15], s39 offen offset:0
    buffer_load_dwordx4 v[12:15], v3, s[12:15], s39 offen offset:32
    buffer_load_dwordx4 v[16:19], v3, s[12:15], s39 offen offset:64
    buffer_load_dwordx4 v[20:23], v3, s[12:15], s39 offen offset:96
    buffer_load_dwordx4 v[24:27], v3, s[12:15], s39 offen offset:128
    buffer_load_dwordx4 v[28:31], v3, s[12:15], s39 offen offset:160
    buffer_load_dwordx4 v[32:35], v3, s[12:15], s39 offen offset:192
    buffer_load_dwordx4 v[36:39], v3, s[12:15], s39 offen offset:224
    s_add_u32 m0, s41, 0
    s_nop 0
    buffer_load_dwordx4 v237, s[16:19], s39 offen offset:0 lds
    s_add_u32 m0, s41, 784
    s_nop 0
    buffer_load_dwordx4 v237, s[16:19], s39 offen offset:256 lds
    s_add_u32 m0, s41, 1568
    s_nop 0
    buffer_load_dwordx4 v237, s[16:19], s39 offen offset:512 lds
    s_add_u32 m0, s41, 2352
    s_nop 0
    buffer_load_dwordx4 v237, s[16:19], s39 offen offset:768 lds
    s_add_u32 s39, s39, 16384
    s_add_u32 m0, s41, 16640
    s_nop 0
    buffer_load_dwordx4 v237, s[16:19], s39 offen offset:0 lds
    s_add_u32 m0, s41, 17424
    s_nop 0
    buffer_load_dwordx4 v237, s[16:19], s39 offen offset:256 lds
    s_add_u32 m0, s41, 18208
    s_nop 0
    buffer_load_dwordx4 v237, s[16:19], s39 offen offset:512 lds
    s_add_u32 m0, s41, 18992
    s_nop 0
    buffer_load_dwordx4 v237, s[16:19], s39 offen offset:768 lds
    s_add_u32 s39, s39, 16384
    s_add_u32 m0, s41, 33280
    s_nop 0
    buffer_load_dwordx4 v238, s[20:23], s40 offen offset:0 lds
    s_add_u32 m0, s41, 34192
    s_nop 0
    buffer_load_dwordx4 v238, s[20:23], s40 offen offset:128 lds
    s_add_u32 m0, s41, 35104
    s_nop 0
    buffer_load_dwordx4 v238, s[20:23], s40 offen offset:256 lds
    s_add_u32 m0, s41, 36016
    s_nop 0
    buffer_load_dwordx4 v238, s[20:23], s40 offen offset:384 lds
    s_add_u32 s40, s40, 16384
L_attn_kernel_btop_4:
    v_and_b32 v2, 31, v1
    v_add_u32 v234, s36, v2
    s_lshl_b32 s37, s35, 1
    s_add_u32 s37, s37, 2
    v_mov_b32 v40, 0
    v_mov_b32 v41, 0
    v_mov_b32 v42, 0
    v_mov_b32 v43, 0
    v_mov_b32 v44, 0
    v_mov_b32 v45, 0
    v_mov_b32 v46, 0
    v_mov_b32 v47, 0
    v_mov_b32 v48, 0
    v_mov_b32 v49, 0
    v_mov_b32 v50, 0
    v_mov_b32 v51, 0
    v_mov_b32 v52, 0
    v_mov_b32 v53, 0
    v_mov_b32 v54, 0
    v_mov_b32 v55, 0
    v_mov_b32 v56, 0
    v_mov_b32 v57, 0
    v_mov_b32 v58, 0
    v_mov_b32 v59, 0
    v_mov_b32 v60, 0
    v_mov_b32 v61, 0
    v_mov_b32 v62, 0
    v_mov_b32 v63, 0
    v_mov_b32 v64, 0
    v_mov_b32 v65, 0
    v_mov_b32 v66, 0
    v_mov_b32 v67, 0
    v_mov_b32 v68, 0
    v_mov_b32 v69, 0
    v_mov_b32 v70, 0
    v_mov_b32 v71, 0
    v_mov_b32 v72, 0
    v_mov_b32 v73, 0
    v_mov_b32 v74, 0
    v_mov_b32 v75, 0
    v_mov_b32 v76, 0
    v_mov_b32 v77, 0
    v_mov_b32 v78, 0
    v_mov_b32 v79, 0
    v_mov_b32 v80, 0
    v_mov_b32 v81, 0
    v_mov_b32 v82, 0
    v_mov_b32 v83, 0
    v_mov_b32 v84, 0
    v_mov_b32 v85, 0
    v_mov_b32 v86, 0
    v_mov_b32 v87, 0
    v_mov_b32 v88, 0
    v_mov_b32 v89, 0
    v_mov_b32 v90, 0
    v_mov_b32 v91, 0
    v_mov_b32 v92, 0
    v_mov_b32 v93, 0
    v_mov_b32 v94, 0
    v_mov_b32 v95, 0
    v_mov_b32 v96, 0
    v_mov_b32 v97, 0
    v_mov_b32 v98, 0
    v_mov_b32 v99, 0
    v_mov_b32 v100, 0
    v_mov_b32 v101, 0
    v_mov_b32 v102, 0
    v_mov_b32 v103, 0
    v_mov_b32 v232, 0
    v_mov_b32 v233, 0
    s_mov_b32 s38, 0
    s_waitcnt vmcnt(0)
    s_barrier
    ds_read_b128 v[200:203], v239 offset:0
    ds_read_b128 v[204:207], v239 offset:32
    ds_read_b128 v[208:211], v239 offset:64
    ds_read_b128 v[212:215], v239 offset:96
    ds_read_b128 v[216:219], v239 offset:128
    ds_read_b128 v[220:223], v239 offset:160
    ds_read_b128 v[224:227], v239 offset:192
    ds_read_b128 v[228:231], v239 offset:224
    s_waitcnt lgkmcnt(4)
    v_mfma_f32_32x32x16_bf16 v[104:119], v[200:203], v[8:11], 0
    v_mfma_f32_32x32x16_bf16 v[104:119], v[204:207], v[12:15], v[104:119]
    v_mfma_f32_32x32x16_bf16 v[104:119], v[208:211], v[16:19], v[104:119]
    v_mfma_f32_32x32x16_bf16 v[104:119], v[212:215], v[20:23], v[104:119]
    ds_read_b128 v[200:203], v239 offset:512
    ds_read_b128 v[204:207], v239 offset:544
    ds_read_b128 v[208:211], v239 offset:576
    ds_read_b128 v[212:215], v239 offset:608
    s_waitcnt lgkmcnt(4)
    v_mfma_f32_32x32x16_bf16 v[104:119], v[216:219], v[24:27], v[104:119]
    v_mfma_f32_32x32x16_bf16 v[104:119], v[220:223], v[28:31], v[104:119]
    v_mfma_f32_32x32x16_bf16 v[104:119], v[224:227], v[32:35], v[104:119]
    v_mfma_f32_32x32x16_bf16 v[104:119], v[228:231], v[36:39], v[104:119]
    ds_read_b128 v[216:219], v239 offset:640
    ds_read_b128 v[220:223], v239 offset:672
    ds_read_b128 v[224:227], v239 offset:704
    ds_read_b128 v[228:231], v239 offset:736
    s_waitcnt lgkmcnt(4)
    v_mfma_f32_32x32x16_bf16 v[120:135], v[200:203], v[8:11], 0
    v_mfma_f32_32x32x16_bf16 v[120:135], v[204:207], v[12:15], v[120:135]
    v_mfma_f32_32x32x16_bf16 v[120:135], v[208:211], v[16:19], v[120:135]
    v_mfma_f32_32x32x16_bf16 v[120:135], v[212:215], v[20:23], v[120:135]
    s_waitcnt lgkmcnt(0)
    v_mfma_f32_32x32x16_bf16 v[120:135], v[216:219], v[24:27], v[120:135]
    v_mfma_f32_32x32x16_bf16 v[120:135], v[220:223], v[28:31], v[120:135]
    v_mfma_f32_32x32x16_bf16 v[120:135], v[224:227], v[32:35], v[120:135]
    v_mfma_f32_32x32x16_bf16 v[120:135], v[228:231], v[36:39], v[120:135]
    s_nop 15
    s_cmp_lg_u32 s37, 2
    s_cbranch_scc1 L_attn_kernel_nm0_5
    s_mov_b32 s30, 0
    v_subrev_u32 v236, s30, v234
    v_sub_u32 v236, v236, v235
    v_mov_b32 v4, 0xff800000
    v_cmp_gt_i32 s[42:43], 0, v236
    v_cmp_gt_i32 s[44:45], 1, v236
    v_cmp_gt_i32 s[46:47], 2, v236
    v_cmp_gt_i32 s[48:49], 3, v236
    v_cndmask_b32 v104, v104, v4, s[42:43]
    v_cndmask_b32 v105, v105, v4, s[44:45]
    v_cndmask_b32 v106, v106, v4, s[46:47]
    v_cndmask_b32 v107, v107, v4, s[48:49]
    v_cmp_gt_i32 s[42:43], 8, v236
    v_cmp_gt_i32 s[44:45], 9, v236
    v_cmp_gt_i32 s[46:47], 10, v236
    v_cmp_gt_i32 s[48:49], 11, v236
    v_cndmask_b32 v108, v108, v4, s[42:43]
    v_cndmask_b32 v109, v109, v4, s[44:45]
    v_cndmask_b32 v110, v110, v4, s[46:47]
    v_cndmask_b32 v111, v111, v4, s[48:49]
    v_cmp_gt_i32 s[42:43], 16, v236
    v_cmp_gt_i32 s[44:45], 17, v236
    v_cmp_gt_i32 s[46:47], 18, v236
    v_cmp_gt_i32 s[48:49], 19, v236
    v_cndmask_b32 v112, v112, v4, s[42:43]
    v_cndmask_b32 v113, v113, v4, s[44:45]
    v_cndmask_b32 v114, v114, v4, s[46:47]
    v_cndmask_b32 v115, v115, v4, s[48:49]
    v_cmp_gt_i32 s[42:43], 24, v236
    v_cmp_gt_i32 s[44:45], 25, v236
    v_cmp_gt_i32 s[46:47], 26, v236
    v_cmp_gt_i32 s[48:49], 27, v236
    v_cndmask_b32 v116, v116, v4, s[42:43]
    v_cndmask_b32 v117, v117, v4, s[44:45]
    v_cndmask_b32 v118, v118, v4, s[46:47]
    v_cndmask_b32 v119, v119, v4, s[48:49]
    v_cmp_gt_i32 s[42:43], 32, v236
    v_cmp_gt_i32 s[44:45], 33, v236
    v_cmp_gt_i32 s[46:47], 34, v236
    v_cmp_gt_i32 s[48:49], 35, v236
    v_cndmask_b32 v120, v120, v4, s[42:43]
    v_cndmask_b32 v121, v121, v4, s[44:45]
    v_cndmask_b32 v122, v122, v4, s[46:47]
    v_cndmask_b32 v123, v123, v4, s[48:49]
    v_cmp_gt_i32 s[42:43], 40, v236
    v_cmp_gt_i32 s[44:45], 41, v236
    v_cmp_gt_i32 s[46:47], 42, v236
    v_cmp_gt_i32 s[48:49], 43, v236
    v_cndmask_b32 v124, v124, v4, s[42:43]
    v_cndmask_b32 v125, v125, v4, s[44:45]
    v_cndmask_b32 v126, v126, v4, s[46:47]
    v_cndmask_b32 v127, v127, v4, s[48:49]
    v_cmp_gt_i32 s[42:43], 48, v236
    v_cmp_gt_i32 s[44:45], 49, v236
    v_cmp_gt_i32 s[46:47], 50, v236
    v_cmp_gt_i32 s[48:49], 51, v236
    v_cndmask_b32 v128, v128, v4, s[42:43]
    v_cndmask_b32 v129, v129, v4, s[44:45]
    v_cndmask_b32 v130, v130, v4, s[46:47]
    v_cndmask_b32 v131, v131, v4, s[48:49]
    v_cmp_gt_i32 s[42:43], 56, v236
    v_cmp_gt_i32 s[44:45], 57, v236
    v_cmp_gt_i32 s[46:47], 58, v236
    v_cmp_gt_i32 s[48:49], 59, v236
    v_cndmask_b32 v132, v132, v4, s[42:43]
    v_cndmask_b32 v133, v133, v4, s[44:45]
    v_cndmask_b32 v134, v134, v4, s[46:47]
    v_cndmask_b32 v135, v135, v4, s[48:49]
L_attn_kernel_nm0_5:
    v_max3_f32 v2, v104, v105, v106
    v_max3_f32 v2, v2, v107, v108
    v_max3_f32 v2, v2, v109, v110
    v_max3_f32 v2, v2, v111, v112
    v_max3_f32 v2, v2, v113, v114
    v_max3_f32 v2, v2, v115, v116
    v_max3_f32 v2, v2, v117, v118
    v_max3_f32 v2, v2, v119, v120
    v_max3_f32 v2, v2, v121, v122
    v_max3_f32 v2, v2, v123, v124
    v_max3_f32 v2, v2, v125, v126
    v_max3_f32 v2, v2, v127, v128
    v_max3_f32 v2, v2, v129, v130
    v_max3_f32 v2, v2, v131, v132
    v_max3_f32 v2, v2, v133, v134
    v_max_f32 v2, v2, v135
    v_mov_b32 v3, v2
    s_nop 1
    v_permlane32_swap_b32 v2, v3
    s_nop 1
    v_max_f32 v2, v2, v3
    v_sub_f32 v104, v104, v2
    v_sub_f32 v105, v105, v2
    v_sub_f32 v106, v106, v2
    v_sub_f32 v107, v107, v2
    v_sub_f32 v108, v108, v2
    v_sub_f32 v109, v109, v2
    v_sub_f32 v110, v110, v2
    v_sub_f32 v111, v111, v2
    v_sub_f32 v112, v112, v2
    v_sub_f32 v113, v113, v2
    v_sub_f32 v114, v114, v2
    v_sub_f32 v115, v115, v2
    v_sub_f32 v116, v116, v2
    v_sub_f32 v117, v117, v2
    v_sub_f32 v118, v118, v2
    v_sub_f32 v119, v119, v2
    v_sub_f32 v120, v120, v2
    v_sub_f32 v121, v121, v2
    v_sub_f32 v122, v122, v2
    v_sub_f32 v123, v123, v2
    v_sub_f32 v124, v124, v2
    v_sub_f32 v125, v125, v2
    v_sub_f32 v126, v126, v2
    v_sub_f32 v127, v127, v2
    v_sub_f32 v128, v128, v2
    v_sub_f32 v129, v129, v2
    v_sub_f32 v130, v130, v2
    v_sub_f32 v131, v131, v2
    v_sub_f32 v132, v132, v2
    v_sub_f32 v133, v133, v2
    v_sub_f32 v134, v134, v2
    v_sub_f32 v135, v135, v2
    v_sub_f32 v3, 0, v2
    v_mov_b32 v184, v3
    v_mov_b32 v185, v3
    v_mov_b32 v186, v3
    v_mov_b32 v187, v3
    v_mov_b32 v188, v3
    v_mov_b32 v189, v3
    v_mov_b32 v190, v3
    v_mov_b32 v191, v3
    v_mov_b32 v192, v3
    v_mov_b32 v193, v3
    v_mov_b32 v194, v3
    v_mov_b32 v195, v3
    v_mov_b32 v196, v3
    v_mov_b32 v197, v3
    v_mov_b32 v198, v3
    v_mov_b32 v199, v3
    s_barrier
    s_cmp_eq_u32 s37, 2
    s_cbranch_scc1 L_attn_kernel_blast_7
L_attn_kernel_bloop_6:
    ds_read_b128 v[200:203], v239 offset:16640
    ds_read_b128 v[204:207], v239 offset:16672
    ds_read_b128 v[208:211], v239 offset:16704
    ds_read_b128 v[212:215], v239 offset:16736
    ds_read_b128 v[216:219], v239 offset:16768
    ds_read_b128 v[220:223], v239 offset:16800
    ds_read_b128 v[224:227], v239 offset:16832
    ds_read_b128 v[228:231], v239 offset:16864
    s_waitcnt lgkmcnt(4)
    v_mfma_f32_32x32x16_bf16 v[136:151], v[200:203], v[8:11], v[184:199]
    s_add_u32 m0, s41, 0
    s_nop 0
    buffer_load_dwordx4 v237, s[16:19], s39 offen offset:0 lds
    v_exp_f32 v104, v104
    v_exp_f32 v105, v105
    v_mfma_f32_32x32x16_bf16 v[136:151], v[204:207], v[12:15], v[136:151]
    s_add_u32 m0, s41, 784
    s_nop 0
    buffer_load_dwordx4 v237, s[16:19], s39 offen offset:256 lds
    v_exp_f32 v106, v106
    v_exp_f32 v107, v107
    v_cvt_pk_bf16_f32 v168, v104, v105
    v_mfma_f32_32x32x16_bf16 v[136:151], v[208:211], v[16:19], v[136:151]
    s_add_u32 m0, s41, 1568
    s_nop 0
    buffer_load_dwordx4 v237, s[16:19], s39 offen offset:512 lds
    v_exp_f32 v108, v108
    v_exp_f32 v109, v109
    v_cvt_pk_bf16_f32 v169, v106, v107
    v_mfma_f32_32x32x16_bf16 v[136:151], v[212:215], v[20:23], v[136:151]
    ds_read_b128 v[200:203], v239 offset:17152
    ds_read_b128 v[204:207], v239 offset:17184
    ds_read_b128 v[208:211], v239 offset:17216
    ds_read_b128 v[212:215], v239 offset:17248
    v_exp_f32 v110, v110
    v_exp_f32 v111, v111
    v_cvt_pk_bf16_f32 v170, v108, v109
    s_waitcnt lgkmcnt(4)
    v_mfma_f32_32x32x16_bf16 v[136:151], v[216:219], v[24:27], v[136:151]
    s_add_u32 m0, s41, 2352
    s_nop 0
    buffer_load_dwordx4 v237, s[16:19], s39 offen offset:768 lds
    s_add_u32 s39, s39, 16384
    v_exp_f32 v112, v112
    v_exp_f32 v113, v113
    v_cvt_pk_bf16_f32 v171, v110, v111
    v_mfma_f32_32x32x16_bf16 v[136:151], v[220:223], v[28:31], v[136:151]
    s_add_u32 m0, s41, 49920
    s_nop 0
    buffer_load_dwordx4 v238, s[20:23], s40 offen offset:0 lds
    v_exp_f32 v114, v114
    v_exp_f32 v115, v115
    v_cvt_pk_bf16_f32 v172, v112, v113
    v_mfma_f32_32x32x16_bf16 v[136:151], v[224:227], v[32:35], v[136:151]
    s_add_u32 m0, s41, 50832
    s_nop 0
    buffer_load_dwordx4 v238, s[20:23], s40 offen offset:128 lds
    v_exp_f32 v116, v116
    v_exp_f32 v117, v117
    v_cvt_pk_bf16_f32 v173, v114, v115
    v_mfma_f32_32x32x16_bf16 v[136:151], v[228:231], v[36:39], v[136:151]
    ds_read_b128 v[216:219], v239 offset:17280
    ds_read_b128 v[220:223], v239 offset:17312
    ds_read_b128 v[224:227], v239 offset:17344
    ds_read_b128 v[228:231], v239 offset:17376
    v_exp_f32 v118, v118
    v_exp_f32 v119, v119
    v_cvt_pk_bf16_f32 v174, v116, v117
    s_waitcnt lgkmcnt(4)
    v_mfma_f32_32x32x16_bf16 v[152:167], v[200:203], v[8:11], v[184:199]
    s_add_u32 m0, s41, 51744
    s_nop 0
    buffer_load_dwordx4 v238, s[20:23], s40 offen offset:256 lds
    v_exp_f32 v120, v120
    v_exp_f32 v121, v121
    v_cvt_pk_bf16_f32 v175, v118, v119
    v_mfma_f32_32x32x16_bf16 v[152:167], v[204:207], v[12:15], v[152:167]
    s_add_u32 m0, s41, 52656
    s_nop 0
    buffer_load_dwordx4 v238, s[20:23], s40 offen offset:384 lds
    s_add_u32 s40, s40, 16384
    v_exp_f32 v122, v122
    v_exp_f32 v123, v123
    v_cvt_pk_bf16_f32 v176, v120, v121
    v_mfma_f32_32x32x16_bf16 v[152:167], v[208:211], v[16:19], v[152:167]
    v_exp_f32 v124, v124
    v_exp_f32 v125, v125
    v_cvt_pk_bf16_f32 v177, v122, v123
    v_mfma_f32_32x32x16_bf16 v[152:167], v[212:215], v[20:23], v[152:167]
    v_exp_f32 v126, v126
    v_exp_f32 v127, v127
    v_cvt_pk_bf16_f32 v178, v124, v125
    s_waitcnt lgkmcnt(0)
    v_mfma_f32_32x32x16_bf16 v[152:167], v[216:219], v[24:27], v[152:167]
    v_exp_f32 v128, v128
    v_exp_f32 v129, v129
    v_cvt_pk_bf16_f32 v179, v126, v127
    v_mfma_f32_32x32x16_bf16 v[152:167], v[220:223], v[28:31], v[152:167]
    v_exp_f32 v130, v130
    v_exp_f32 v131, v131
    v_cvt_pk_bf16_f32 v180, v128, v129
    v_mfma_f32_32x32x16_bf16 v[152:167], v[224:227], v[32:35], v[152:167]
    v_exp_f32 v132, v132
    v_exp_f32 v133, v133
    v_cvt_pk_bf16_f32 v181, v130, v131
    v_mfma_f32_32x32x16_bf16 v[152:167], v[228:231], v[36:39], v[152:167]
    v_exp_f32 v134, v134
    v_exp_f32 v135, v135
    v_cvt_pk_bf16_f32 v182, v132, v133
    v_cvt_pk_bf16_f32 v183, v134, v135
    s_add_u32 s29, s38, 3
    s_cmp_ge_u32 s29, s37
    s_cbranch_scc1 L_attn_kernel_msk_8
    ds_read_b128 v[200:203], v239 offset:33280
    ds_read_b128 v[204:207], v239 offset:33792
    ds_read_b128 v[208:211], v240 offset:0
    ds_read_b128 v[212:215], v240 offset:512
    ds_read_b128 v[216:219], v239 offset:33312
    ds_read_b128 v[220:223], v239 offset:33824
    ds_read_b128 v[224:227], v240 offset:32
    ds_read_b128 v[228:231], v240 offset:544
    s_waitcnt lgkmcnt(4)
    v_mfma_f32_32x32x16_bf16 v[40:55], v[200:203], v[168:171], v[40:55]
    v_add_f32 v232, v232, v104
    v_add_f32 v233, v233, v105
    v_mfma_f32_32x32x16_bf16 v[56:71], v[204:207], v[168:171], v[56:71]
    v_add_f32 v232, v232, v106
    v_add_f32 v233, v233, v107
    v_mfma_f32_32x32x16_bf16 v[72:87], v[208:211], v[168:171], v[72:87]
    v_add_f32 v232, v232, v108
    v_add_f32 v233, v233, v109
    v_mfma_f32_32x32x16_bf16 v[88:103], v[212:215], v[168:171], v[88:103]
    ds_read_b128 v[200:203], v239 offset:33344
    ds_read_b128 v[204:207], v239 offset:33856
    ds_read_b128 v[208:211], v240 offset:64
    ds_read_b128 v[212:215], v240 offset:576
    v_add_f32 v232, v232, v110
    v_add_f32 v233, v233, v111
    s_waitcnt lgkmcnt(4)
    v_mfma_f32_32x32x16_bf16 v[40:55], v[216:219], v[172:175], v[40:55]
    v_add_f32 v232, v232, v112
    v_add_f32 v233, v233, v113
    v_mfma_f32_32x32x16_bf16 v[56:71], v[220:223], v[172:175], v[56:71]
    v_add_f32 v232, v232, v114
    v_add_f32 v233, v233, v115
    v_mfma_f32_32x32x16_bf16 v[72:87], v[224:227], v[172:175], v[72:87]
    v_add_f32 v232, v232, v116
    v_add_f32 v233, v233, v117
    v_mfma_f32_32x32x16_bf16 v[88:103], v[228:231], v[172:175], v[88:103]
    ds_read_b128 v[216:219], v239 offset:33376
    ds_read_b128 v[220:223], v239 offset:33888
    ds_read_b128 v[224:227], v240 offset:96
    ds_read_b128 v[228:231], v240 offset:608
    v_add_f32 v232, v232, v118
    v_add_f32 v233, v233, v119
    s_waitcnt lgkmcnt(4)
    v_mfma_f32_32x32x16_bf16 v[40:55], v[200:203], v[176:179], v[40:55]
    v_add_f32 v232, v232, v120
    v_add_f32 v233, v233, v121
    v_mfma_f32_32x32x16_bf16 v[56:71], v[204:207], v[176:179], v[56:71]
    v_add_f32 v232, v232, v122
    v_add_f32 v233, v233, v123
    v_mfma_f32_32x32x16_bf16 v[72:87], v[208:211], v[176:179], v[72:87]
    v_add_f32 v232, v232, v124
    v_add_f32 v233, v233, v125
    v_mfma_f32_32x32x16_bf16 v[88:103], v[212:215], v[176:179], v[88:103]
    v_add_f32 v232, v232, v126
    v_add_f32 v233, v233, v127
    s_waitcnt lgkmcnt(0)
    v_mfma_f32_32x32x16_bf16 v[40:55], v[216:219], v[180:183], v[40:55]
    v_add_f32 v232, v232, v128
    v_add_f32 v233, v233, v129
    v_mfma_f32_32x32x16_bf16 v[56:71], v[220:223], v[180:183], v[56:71]
    v_add_f32 v232, v232, v130
    v_add_f32 v233, v233, v131
    v_mfma_f32_32x32x16_bf16 v[72:87], v[224:227], v[180:183], v[72:87]
    v_add_f32 v232, v232, v132
    v_add_f32 v233, v233, v133
    v_mfma_f32_32x32x16_bf16 v[88:103], v[228:231], v[180:183], v[88:103]
    v_add_f32 v232, v232, v134
    v_add_f32 v233, v233, v135
    s_branch L_attn_kernel_join_9
L_attn_kernel_msk_8:
    s_lshl_b32 s30, s38, 6
    s_add_u32 s30, s30, 64
    ds_read_b128 v[200:203], v239 offset:33280
    ds_read_b128 v[204:207], v239 offset:33792
    ds_read_b128 v[208:211], v240 offset:0
    ds_read_b128 v[212:215], v240 offset:512
    ds_read_b128 v[216:219], v239 offset:33312
    ds_read_b128 v[220:223], v239 offset:33824
    ds_read_b128 v[224:227], v240 offset:32
    ds_read_b128 v[228:231], v240 offset:544
    s_waitcnt lgkmcnt(4)
    v_mfma_f32_32x32x16_bf16 v[40:55], v[200:203], v[168:171], v[40:55]
    v_add_f32 v232, v232, v104
    v_add_f32 v233, v233, v105
    v_mfma_f32_32x32x16_bf16 v[56:71], v[204:207], v[168:171], v[56:71]
    v_add_f32 v232, v232, v106
    v_add_f32 v233, v233, v107
    v_mfma_f32_32x32x16_bf16 v[72:87], v[208:211], v[168:171], v[72:87]
    v_add_f32 v232, v232, v108
    v_add_f32 v233, v233, v109
    v_mfma_f32_32x32x16_bf16 v[88:103], v[212:215], v[168:171], v[88:103]
    ds_read_b128 v[200:203], v239 offset:33344
    ds_read_b128 v[204:207], v239 offset:33856
    ds_read_b128 v[208:211], v240 offset:64
    ds_read_b128 v[212:215], v240 offset:576
    v_add_f32 v232, v232, v110
    v_add_f32 v233, v233, v111
    s_waitcnt lgkmcnt(4)
    v_mfma_f32_32x32x16_bf16 v[40:55], v[216:219], v[172:175], v[40:55]
    v_add_f32 v232, v232, v112
    v_add_f32 v233, v233, v113
    v_mfma_f32_32x32x16_bf16 v[56:71], v[220:223], v[172:175], v[56:71]
    v_add_f32 v232, v232, v114
    v_add_f32 v233, v233, v115
    v_mfma_f32_32x32x16_bf16 v[72:87], v[224:227], v[172:175], v[72:87]
    v_add_f32 v232, v232, v116
    v_add_f32 v233, v233, v117
    v_subrev_u32 v236, s30, v234
    v_sub_u32 v236, v236, v235
    v_mov_b32 v4, 0xff800000
    v_cmp_gt_i32 s[42:43], 0, v236
    v_cmp_gt_i32 s[44:45], 1, v236
    v_cmp_gt_i32 s[46:47], 2, v236
    v_cmp_gt_i32 s[48:49], 3, v236
    v_cndmask_b32 v136, v136, v4, s[42:43]
    v_cndmask_b32 v137, v137, v4, s[44:45]
    v_cndmask_b32 v138, v138, v4, s[46:47]
    v_cndmask_b32 v139, v139, v4, s[48:49]
    v_cmp_gt_i32 s[42:43], 8, v236
    v_cmp_gt_i32 s[44:45], 9, v236
    v_cmp_gt_i32 s[46:47], 10, v236
    v_cmp_gt_i32 s[48:49], 11, v236
    v_cndmask_b32 v140, v140, v4, s[42:43]
    v_cndmask_b32 v141, v141, v4, s[44:45]
    v_cndmask_b32 v142, v142, v4, s[46:47]
    v_cndmask_b32 v143, v143, v4, s[48:49]
    v_cmp_gt_i32 s[42:43], 16, v236
    v_cmp_gt_i32 s[44:45], 17, v236
    v_cmp_gt_i32 s[46:47], 18, v236
    v_cmp_gt_i32 s[48:49], 19, v236
    v_cndmask_b32 v144, v144, v4, s[42:43]
    v_cndmask_b32 v145, v145, v4, s[44:45]
    v_cndmask_b32 v146, v146, v4, s[46:47]
    v_cndmask_b32 v147, v147, v4, s[48:49]
    v_cmp_gt_i32 s[42:43], 24, v236
    v_cmp_gt_i32 s[44:45], 25, v236
    v_cmp_gt_i32 s[46:47], 26, v236
    v_cmp_gt_i32 s[48:49], 27, v236
    v_cndmask_b32 v148, v148, v4, s[42:43]
    v_cndmask_b32 v149, v149, v4, s[44:45]
    v_cndmask_b32 v150, v150, v4, s[46:47]
    v_cndmask_b32 v151, v151, v4, s[48:49]
    v_cmp_gt_i32 s[42:43], 32, v236
    v_cmp_gt_i32 s[44:45], 33, v236
    v_cmp_gt_i32 s[46:47], 34, v236
    v_cmp_gt_i32 s[48:49], 35, v236
    v_cndmask_b32 v152, v152, v4, s[42:43]
    v_cndmask_b32 v153, v153, v4, s[44:45]
    v_cndmask_b32 v154, v154, v4, s[46:47]
    v_cndmask_b32 v155, v155, v4, s[48:49]
    v_cmp_gt_i32 s[42:43], 40, v236
    v_cmp_gt_i32 s[44:45], 41, v236
    v_cmp_gt_i32 s[46:47], 42, v236
    v_cmp_gt_i32 s[48:49], 43, v236
    v_cndmask_b32 v156, v156, v4, s[42:43]
    v_cndmask_b32 v157, v157, v4, s[44:45]
    v_cndmask_b32 v158, v158, v4, s[46:47]
    v_cndmask_b32 v159, v159, v4, s[48:49]
    v_cmp_gt_i32 s[42:43], 48, v236
    v_cmp_gt_i32 s[44:45], 49, v236
    v_cmp_gt_i32 s[46:47], 50, v236
    v_cmp_gt_i32 s[48:49], 51, v236
    v_cndmask_b32 v160, v160, v4, s[42:43]
    v_cndmask_b32 v161, v161, v4, s[44:45]
    v_cndmask_b32 v162, v162, v4, s[46:47]
    v_cndmask_b32 v163, v163, v4, s[48:49]
    v_cmp_gt_i32 s[42:43], 56, v236
    v_cmp_gt_i32 s[44:45], 57, v236
    v_cmp_gt_i32 s[46:47], 58, v236
    v_cmp_gt_i32 s[48:49], 59, v236
    v_cndmask_b32 v164, v164, v4, s[42:43]
    v_cndmask_b32 v165, v165, v4, s[44:45]
    v_cndmask_b32 v166, v166, v4, s[46:47]
    v_cndmask_b32 v167, v167, v4, s[48:49]
    v_mfma_f32_32x32x16_bf16 v[88:103], v[228:231], v[172:175], v[88:103]
    ds_read_b128 v[216:219], v239 offset:33376
    ds_read_b128 v[220:223], v239 offset:33888
    ds_read_b128 v[224:227], v240 offset:96
    ds_read_b128 v[228:231], v240 offset:608
    v_add_f32 v232, v232, v118
    v_add_f32 v233, v233, v119
    s_waitcnt lgkmcnt(4)
    v_mfma_f32_32x32x16_bf16 v[40:55], v[200:203], v[176:179], v[40:55]
    v_add_f32 v232, v232, v120
    v_add_f32 v233, v233, v121
    v_mfma_f32_32x32x16_bf16 v[56:71], v[204:207], v[176:179], v[56:71]
    v_add_f32 v232, v232, v122
    v_add_f32 v233, v233, v123
    v_mfma_f32_32x32x16_bf16 v[72:87], v[208:211], v[176:179], v[72:87]
    v_add_f32 v232, v232, v124
    v_add_f32 v233, v233, v125
    v_mfma_f32_32x32x16_bf16 v[88:103], v[212:215], v[176:179], v[88:103]
    v_add_f32 v232, v232, v126
    v_add_f32 v233, v233, v127
    s_waitcnt lgkmcnt(0)
    v_mfma_f32_32x32x16_bf16 v[40:55], v[216:219], v[180:183], v[40:55]
    v_add_f32 v232, v232, v128
    v_add_f32 v233, v233, v129
    v_mfma_f32_32x32x16_bf16 v[56:71], v[220:223], v[180:183], v[56:71]
    v_add_f32 v232, v232, v130
    v_add_f32 v233, v233, v131
    v_mfma_f32_32x32x16_bf16 v[72:87], v[224:227], v[180:183], v[72:87]
    v_add_f32 v232, v232, v132
    v_add_f32 v233, v233, v133
    v_mfma_f32_32x32x16_bf16 v[88:103], v[228:231], v[180:183], v[88:103]
    v_add_f32 v232, v232, v134
    v_add_f32 v233, v233, v135
L_attn_kernel_join_9:
    s_add_u32 s38, s38, 1
    s_waitcnt vmcnt(0)
    s_barrier
    ds_read_b128 v[200:203], v239 offset:0
    ds_read_b128 v[204:207], v239 offset:32
    ds_read_b128 v[208:211], v239 offset:64
    ds_read_b128 v[212:215], v239 offset:96
    ds_read_b128 v[216:219], v239 offset:128
    ds_read_b128 v[220:223], v239 offset:160
    ds_read_b128 v[224:227], v239 offset:192
    ds_read_b128 v[228:231], v239 offset:224
    s_waitcnt lgkmcnt(4)
    v_mfma_f32_32x32x16_bf16 v[104:119], v[200:203], v[8:11], v[184:199]
    s_add_u32 m0, s41, 16640
    s_nop 0
    buffer_load_dwordx4 v237, s[16:19], s39 offen offset:0 lds
    v_exp_f32 v136, v136
    v_exp_f32 v137, v137
    v_mfma_f32_32x32x16_bf16 v[104:119], v[204:207], v[12:15], v[104:119]
    s_add_u32 m0, s41, 17424
    s_nop 0
    buffer_load_dwordx4 v237, s[16:19], s39 offen offset:256 lds
    v_exp_f32 v138, v138
    v_exp_f32 v139, v139
    v_cvt_pk_bf16_f32 v168, v136, v137
    v_mfma_f32_32x32x16_bf16 v[104:119], v[208:211], v[16:19], v[104:119]
    s_add_u32 m0, s41, 18208
    s_nop 0
    buffer_load_dwordx4 v237, s[16:19], s39 offen offset:512 lds
    v_exp_f32 v140, v140
    v_exp_f32 v141, v141
    v_cvt_pk_bf16_f32 v169, v138, v139
    v_mfma_f32_32x32x16_bf16 v[104:119], v[212:215], v[20:23], v[104:119]
    ds_read_b128 v[200:203], v239 offset:512
    ds_read_b128 v[204:207], v239 offset:544
    ds_read_b128 v[208:211], v239 offset:576
    ds_read_b128 v[212:215], v239 offset:608
    v_exp_f32 v142, v142
    v_exp_f32 v143, v143
    v_cvt_pk_bf16_f32 v170, v140, v141
    s_waitcnt lgkmcnt(4)
    v_mfma_f32_32x32x16_bf16 v[104:119], v[216:219], v[24:27], v[104:119]
    s_add_u32 m0, s41, 18992
    s_nop 0
    buffer_load_dwordx4 v237, s[16:19], s39 offen offset:768 lds
    s_add_u32 s39, s39, 16384
    v_exp_f32 v144, v144
    v_exp_f32 v145, v145
    v_cvt_pk_bf16_f32 v171, v142, v143
    v_mfma_f32_32x32x16_bf16 v[104:119], v[220:223], v[28:31], v[104:119]
    s_add_u32 m0, s41, 33280
    s_nop 0
    buffer_load_dwordx4 v238, s[20:23], s40 offen offset:0 lds
    v_exp_f32 v146, v146
    v_exp_f32 v147, v147
    v_cvt_pk_bf16_f32 v172, v144, v145
    v_mfma_f32_32x32x16_bf16 v[104:119], v[224:227], v[32:35], v[104:119]
    s_add_u32 m0, s41, 34192
    s_nop 0
    buffer_load_dwordx4 v238, s[20:23], s40 offen offset:128 lds
    v_exp_f32 v148, v148
    v_exp_f32 v149, v149
    v_cvt_pk_bf16_f32 v173, v146, v147
    v_mfma_f32_32x32x16_bf16 v[104:119], v[228:231], v[36:39], v[104:119]
    ds_read_b128 v[216:219], v239 offset:640
    ds_read_b128 v[220:223], v239 offset:672
    ds_read_b128 v[224:227], v239 offset:704
    ds_read_b128 v[228:231], v239 offset:736
    v_exp_f32 v150, v150
    v_exp_f32 v151, v151
    v_cvt_pk_bf16_f32 v174, v148, v149
    s_waitcnt lgkmcnt(4)
    v_mfma_f32_32x32x16_bf16 v[120:135], v[200:203], v[8:11], v[184:199]
    s_add_u32 m0, s41, 35104
    s_nop 0
    buffer_load_dwordx4 v238, s[20:23], s40 offen offset:256 lds
    v_exp_f32 v152, v152
    v_exp_f32 v153, v153
    v_cvt_pk_bf16_f32 v175, v150, v151
    v_mfma_f32_32x32x16_bf16 v[120:135], v[204:207], v[12:15], v[120:135]
    s_add_u32 m0, s41, 36016
    s_nop 0
    buffer_load_dwordx4 v238, s[20:23], s40 offen offset:384 lds
    s_add_u32 s40, s40, 16384
    v_exp_f32 v154, v154
    v_exp_f32 v155, v155
    v_cvt_pk_bf16_f32 v176, v152, v153
    v_mfma_f32_32x32x16_bf16 v[120:135], v[208:211], v[16:19], v[120:135]
    v_exp_f32 v156, v156
    v_exp_f32 v157, v157
    v_cvt_pk_bf16_f32 v177, v154, v155
    v_mfma_f32_32x32x16_bf16 v[120:135], v[212:215], v[20:23], v[120:135]
    v_exp_f32 v158, v158
    v_exp_f32 v159, v159
    v_cvt_pk_bf16_f32 v178, v156, v157
    s_waitcnt lgkmcnt(0)
    v_mfma_f32_32x32x16_bf16 v[120:135], v[216:219], v[24:27], v[120:135]
    v_exp_f32 v160, v160
    v_exp_f32 v161, v161
    v_cvt_pk_bf16_f32 v179, v158, v159
    v_mfma_f32_32x32x16_bf16 v[120:135], v[220:223], v[28:31], v[120:135]
    v_exp_f32 v162, v162
    v_exp_f32 v163, v163
    v_cvt_pk_bf16_f32 v180, v160, v161
    v_mfma_f32_32x32x16_bf16 v[120:135], v[224:227], v[32:35], v[120:135]
    v_exp_f32 v164, v164
    v_exp_f32 v165, v165
    v_cvt_pk_bf16_f32 v181, v162, v163
    v_mfma_f32_32x32x16_bf16 v[120:135], v[228:231], v[36:39], v[120:135]
    v_exp_f32 v166, v166
    v_exp_f32 v167, v167
    v_cvt_pk_bf16_f32 v182, v164, v165
    v_cvt_pk_bf16_f32 v183, v166, v167
    s_add_u32 s29, s38, 3
    s_cmp_ge_u32 s29, s37
    s_cbranch_scc1 L_attn_kernel_msk_10
    ds_read_b128 v[200:203], v239 offset:49920
    ds_read_b128 v[204:207], v239 offset:50432
    ds_read_b128 v[208:211], v240 offset:16640
    ds_read_b128 v[212:215], v240 offset:17152
    ds_read_b128 v[216:219], v239 offset:49952
    ds_read_b128 v[220:223], v239 offset:50464
    ds_read_b128 v[224:227], v240 offset:16672
    ds_read_b128 v[228:231], v240 offset:17184
    s_waitcnt lgkmcnt(4)
    v_mfma_f32_32x32x16_bf16 v[40:55], v[200:203], v[168:171], v[40:55]
    v_add_f32 v232, v232, v136
    v_add_f32 v233, v233, v137
    v_mfma_f32_32x32x16_bf16 v[56:71], v[204:207], v[168:171], v[56:71]
    v_add_f32 v232, v232, v138
    v_add_f32 v233, v233, v139
    v_mfma_f32_32x32x16_bf16 v[72:87], v[208:211], v[168:171], v[72:87]
    v_add_f32 v232, v232, v140
    v_add_f32 v233, v233, v141
    v_mfma_f32_32x32x16_bf16 v[88:103], v[212:215], v[168:171], v[88:103]
    ds_read_b128 v[200:203], v239 offset:49984
    ds_read_b128 v[204:207], v239 offset:50496
    ds_read_b128 v[208:211], v240 offset:16704
    ds_read_b128 v[212:215], v240 offset:17216
    v_add_f32 v232, v232, v142
    v_add_f32 v233, v233, v143
    s_waitcnt lgkmcnt(4)
    v_mfma_f32_32x32x16_bf16 v[40:55], v[216:219], v[172:175], v[40:55]
    v_add_f32 v232, v232, v144
    v_add_f32 v233, v233, v145
    v_mfma_f32_32x32x16_bf16 v[56:71], v[220:223], v[172:175], v[56:71]
    v_add_f32 v232, v232, v146
    v_add_f32 v233, v233, v147
    v_mfma_f32_32x32x16_bf16 v[72:87], v[224:227], v[172:175], v[72:87]
    v_add_f32 v232, v232, v148
    v_add_f32 v233, v233, v149
    v_mfma_f32_32x32x16_bf16 v[88:103], v[228:231], v[172:175], v[88:103]
    ds_read_b128 v[216:219], v239 offset:50016
    ds_read_b128 v[220:223], v239 offset:50528
    ds_read_b128 v[224:227], v240 offset:16736
    ds_read_b128 v[228:231], v240 offset:17248
    v_add_f32 v232, v232, v150
    v_add_f32 v233, v233, v151
    s_waitcnt lgkmcnt(4)
    v_mfma_f32_32x32x16_bf16 v[40:55], v[200:203], v[176:179], v[40:55]
    v_add_f32 v232, v232, v152
    v_add_f32 v233, v233, v153
    v_mfma_f32_32x32x16_bf16 v[56:71], v[204:207], v[176:179], v[56:71]
    v_add_f32 v232, v232, v154
    v_add_f32 v233, v233, v155
    v_mfma_f32_32x32x16_bf16 v[72:87], v[208:211], v[176:179], v[72:87]
    v_add_f32 v232, v232, v156
    v_add_f32 v233, v233, v157
    v_mfma_f32_32x32x16_bf16 v[88:103], v[212:215], v[176:179], v[88:103]
    v_add_f32 v232, v232, v158
    v_add_f32 v233, v233, v159
    s_waitcnt lgkmcnt(0)
    v_mfma_f32_32x32x16_bf16 v[40:55], v[216:219], v[180:183], v[40:55]
    v_add_f32 v232, v232, v160
    v_add_f32 v233, v233, v161
    v_mfma_f32_32x32x16_bf16 v[56:71], v[220:223], v[180:183], v[56:71]
    v_add_f32 v232, v232, v162
    v_add_f32 v233, v233, v163
    v_mfma_f32_32x32x16_bf16 v[72:87], v[224:227], v[180:183], v[72:87]
    v_add_f32 v232, v232, v164
    v_add_f32 v233, v233, v165
    v_mfma_f32_32x32x16_bf16 v[88:103], v[228:231], v[180:183], v[88:103]
    v_add_f32 v232, v232, v166
    v_add_f32 v233, v233, v167
    s_branch L_attn_kernel_join_11
L_attn_kernel_msk_10:
    s_lshl_b32 s30, s38, 6
    s_add_u32 s30, s30, 64
    ds_read_b128 v[200:203], v239 offset:49920
    ds_read_b128 v[204:207], v239 offset:50432
    ds_read_b128 v[208:211], v240 offset:16640
    ds_read_b128 v[212:215], v240 offset:17152
    ds_read_b128 v[216:219], v239 offset:49952
    ds_read_b128 v[220:223], v239 offset:50464
    ds_read_b128 v[224:227], v240 offset:16672
    ds_read_b128 v[228:231], v240 offset:17184
    s_waitcnt lgkmcnt(4)
    v_mfma_f32_32x32x16_bf16 v[40:55], v[200:203], v[168:171], v[40:55]
    v_add_f32 v232, v232, v136
    v_add_f32 v233, v233, v137
    v_mfma_f32_32x32x16_bf16 v[56:71], v[204:207], v[168:171], v[56:71]
    v_add_f32 v232, v232, v138
    v_add_f32 v233, v233, v139
    v_mfma_f32_32x32x16_bf16 v[72:87], v[208:211], v[168:171], v[72:87]
    v_add_f32 v232, v232, v140
    v_add_f32 v233, v233, v141
    v_mfma_f32_32x32x16_bf16 v[88:103], v[212:215], v[168:171], v[88:103]
    ds_read_b128 v[200:203], v239 offset:49984
    ds_read_b128 v[204:207], v239 offset:50496
    ds_read_b128 v[208:211], v240 offset:16704
    ds_read_b128 v[212:215], v240 offset:17216
    v_add_f32 v232, v232, v142
    v_add_f32 v233, v233, v143
    s_waitcnt lgkmcnt(4)
    v_mfma_f32_32x32x16_bf16 v[40:55], v[216:219], v[172:175], v[40:55]
    v_add_f32 v232, v232, v144
    v_add_f32 v233, v233, v145
    v_mfma_f32_32x32x16_bf16 v[56:71], v[220:223], v[172:175], v[56:71]
    v_add_f32 v232, v232, v146
    v_add_f32 v233, v233, v147
    v_mfma_f32_32x32x16_bf16 v[72:87], v[224:227], v[172:175], v[72:87]
    v_add_f32 v232, v232, v148
    v_add_f32 v233, v233, v149
    v_subrev_u32 v236, s30, v234
    v_sub_u32 v236, v236, v235
    v_mov_b32 v4, 0xff800000
    v_cmp_gt_i32 s[42:43], 0, v236
    v_cmp_gt_i32 s[44:45], 1, v236
    v_cmp_gt_i32 s[46:47], 2, v236
    v_cmp_gt_i32 s[48:49], 3, v236
    v_cndmask_b32 v104, v104, v4, s[42:43]
    v_cndmask_b32 v105, v105, v4, s[44:45]
    v_cndmask_b32 v106, v106, v4, s[46:47]
    v_cndmask_b32 v107, v107, v4, s[48:49]
    v_cmp_gt_i32 s[42:43], 8, v236
    v_cmp_gt_i32 s[44:45], 9, v236
    v_cmp_gt_i32 s[46:47], 10, v236
    v_cmp_gt_i32 s[48:49], 11, v236
    v_cndmask_b32 v108, v108, v4, s[42:43]
    v_cndmask_b32 v109, v109, v4, s[44:45]
    v_cndmask_b32 v110, v110, v4, s[46:47]
    v_cndmask_b32 v111, v111, v4, s[48:49]
    v_cmp_gt_i32 s[42:43], 16, v236
    v_cmp_gt_i32 s[44:45], 17, v236
    v_cmp_gt_i32 s[46:47], 18, v236
    v_cmp_gt_i32 s[48:49], 19, v236
    v_cndmask_b32 v112, v112, v4, s[42:43]
    v_cndmask_b32 v113, v113, v4, s[44:45]
    v_cndmask_b32 v114, v114, v4, s[46:47]
    v_cndmask_b32 v115, v115, v4, s[48:49]
    v_cmp_gt_i32 s[42:43], 24, v236
    v_cmp_gt_i32 s[44:45], 25, v236
    v_cmp_gt_i32 s[46:47], 26, v236
    v_cmp_gt_i32 s[48:49], 27, v236
    v_cndmask_b32 v116, v116, v4, s[42:43]
    v_cndmask_b32 v117, v117, v4, s[44:45]
    v_cndmask_b32 v118, v118, v4, s[46:47]
    v_cndmask_b32 v119, v119, v4, s[48:49]
    v_cmp_gt_i32 s[42:43], 32, v236
    v_cmp_gt_i32 s[44:45], 33, v236
    v_cmp_gt_i32 s[46:47], 34, v236
    v_cmp_gt_i32 s[48:49], 35, v236
    v_cndmask_b32 v120, v120, v4, s[42:43]
    v_cndmask_b32 v121, v121, v4, s[44:45]
    v_cndmask_b32 v122, v122, v4, s[46:47]
    v_cndmask_b32 v123, v123, v4, s[48:49]
    v_cmp_gt_i32 s[42:43], 40, v236
    v_cmp_gt_i32 s[44:45], 41, v236
    v_cmp_gt_i32 s[46:47], 42, v236
    v_cmp_gt_i32 s[48:49], 43, v236
    v_cndmask_b32 v124, v124, v4, s[42:43]
    v_cndmask_b32 v125, v125, v4, s[44:45]
    v_cndmask_b32 v126, v126, v4, s[46:47]
    v_cndmask_b32 v127, v127, v4, s[48:49]
    v_cmp_gt_i32 s[42:43], 48, v236
    v_cmp_gt_i32 s[44:45], 49, v236
    v_cmp_gt_i32 s[46:47], 50, v236
    v_cmp_gt_i32 s[48:49], 51, v236
    v_cndmask_b32 v128, v128, v4, s[42:43]
    v_cndmask_b32 v129, v129, v4, s[44:45]
    v_cndmask_b32 v130, v130, v4, s[46:47]
    v_cndmask_b32 v131, v131, v4, s[48:49]
    v_cmp_gt_i32 s[42:43], 56, v236
    v_cmp_gt_i32 s[44:45], 57, v236
    v_cmp_gt_i32 s[46:47], 58, v236
    v_cmp_gt_i32 s[48:49], 59, v236
    v_cndmask_b32 v132, v132, v4, s[42:43]
    v_cndmask_b32 v133, v133, v4, s[44:45]
    v_cndmask_b32 v134, v134, v4, s[46:47]
    v_cndmask_b32 v135, v135, v4, s[48:49]
    v_mfma_f32_32x32x16_bf16 v[88:103], v[228:231], v[172:175], v[88:103]
    ds_read_b128 v[216:219], v239 offset:50016
    ds_read_b128 v[220:223], v239 offset:50528
    ds_read_b128 v[224:227], v240 offset:16736
    ds_read_b128 v[228:231], v240 offset:17248
    v_add_f32 v232, v232, v150
    v_add_f32 v233, v233, v151
    s_waitcnt lgkmcnt(4)
    v_mfma_f32_32x32x16_bf16 v[40:55], v[200:203], v[176:179], v[40:55]
    v_add_f32 v232, v232, v152
    v_add_f32 v233, v233, v153
    v_mfma_f32_32x32x16_bf16 v[56:71], v[204:207], v[176:179], v[56:71]
    v_add_f32 v232, v232, v154
    v_add_f32 v233, v233, v155
    v_mfma_f32_32x32x16_bf16 v[72:87], v[208:211], v[176:179], v[72:87]
    v_add_f32 v232, v232, v156
    v_add_f32 v233, v233, v157
    v_mfma_f32_32x32x16_bf16 v[88:103], v[212:215], v[176:179], v[88:103]
    v_add_f32 v232, v232, v158
    v_add_f32 v233, v233, v159
    s_waitcnt lgkmcnt(0)
    v_mfma_f32_32x32x16_bf16 v[40:55], v[216:219], v[180:183], v[40:55]
    v_add_f32 v232, v232, v160
    v_add_f32 v233, v233, v161
    v_mfma_f32_32x32x16_bf16 v[56:71], v[220:223], v[180:183], v[56:71]
    v_add_f32 v232, v232, v162
    v_add_f32 v233, v233, v163
    v_mfma_f32_32x32x16_bf16 v[72:87], v[224:227], v[180:183], v[72:87]
    v_add_f32 v232, v232, v164
    v_add_f32 v233, v233, v165
    v_mfma_f32_32x32x16_bf16 v[88:103], v[228:231], v[180:183], v[88:103]
    v_add_f32 v232, v232, v166
    v_add_f32 v233, v233, v167
L_attn_kernel_join_11:
    s_add_u32 s38, s38, 1
    s_waitcnt vmcnt(0)
    s_barrier
    s_add_u32 s29, s38, 2
    s_cmp_lt_u32 s29, s37
    s_cbranch_scc1 L_attn_kernel_bloop_6
L_attn_kernel_blast_7:
    ds_read_b128 v[200:203], v239 offset:16640
    ds_read_b128 v[204:207], v239 offset:16672
    ds_read_b128 v[208:211], v239 offset:16704
    ds_read_b128 v[212:215], v239 offset:16736
    ds_read_b128 v[216:219], v239 offset:16768
    ds_read_b128 v[220:223], v239 offset:16800
    ds_read_b128 v[224:227], v239 offset:16832
    ds_read_b128 v[228:231], v239 offset:16864
    s_waitcnt lgkmcnt(4)
    v_mfma_f32_32x32x16_bf16 v[136:151], v[200:203], v[8:11], v[184:199]
    s_add_u32 m0, s41, 0
    s_nop 0
    buffer_load_dwordx4 v237, s[16:19], s39 offen offset:0 lds
    v_exp_f32 v104, v104
    v_exp_f32 v105, v105
    v_mfma_f32_32x32x16_bf16 v[136:151], v[204:207], v[12:15], v[136:151]
    s_add_u32 m0, s41, 784
    s_nop 0
    buffer_load_dwordx4 v237, s[16:19], s39 offen offset:256 lds
    v_exp_f32 v106, v106
    v_exp_f32 v107, v107
    v_cvt_pk_bf16_f32 v168, v104, v105
    v_mfma_f32_32x32x16_bf16 v[136:151], v[208:211], v[16:19], v[136:151]
    s_add_u32 m0, s41, 1568
    s_nop 0
    buffer_load_dwordx4 v237, s[16:19], s39 offen offset:512 lds
    v_exp_f32 v108, v108
    v_exp_f32 v109, v109
    v_cvt_pk_bf16_f32 v169, v106, v107
    v_mfma_f32_32x32x16_bf16 v[136:151], v[212:215], v[20:23], v[136:151]
    ds_read_b128 v[200:203], v239 offset:17152
    ds_read_b128 v[204:207], v239 offset:17184
    ds_read_b128 v[208:211], v239 offset:17216
    ds_read_b128 v[212:215], v239 offset:17248
    v_exp_f32 v110, v110
    v_exp_f32 v111, v111
    v_cvt_pk_bf16_f32 v170, v108, v109
    s_waitcnt lgkmcnt(4)
    v_mfma_f32_32x32x16_bf16 v[136:151], v[216:219], v[24:27], v[136:151]
    s_add_u32 m0, s41, 2352
    s_nop 0
    buffer_load_dwordx4 v237, s[16:19], s39 offen offset:768 lds
    s_add_u32 s39, s39, 16384
    v_exp_f32 v112, v112
    v_exp_f32 v113, v113
    v_cvt_pk_bf16_f32 v171, v110, v111
    v_mfma_f32_32x32x16_bf16 v[136:151], v[220:223], v[28:31], v[136:151]
    s_add_u32 m0, s41, 49920
    s_nop 0
    buffer_load_dwordx4 v238, s[20:23], s40 offen offset:0 lds
    v_exp_f32 v114, v114
    v_exp_f32 v115, v115
    v_cvt_pk_bf16_f32 v172, v112, v113
    v_mfma_f32_32x32x16_bf16 v[136:151], v[224:227], v[32:35], v[136:151]
    s_add_u32 m0, s41, 50832
    s_nop 0
    buffer_load_dwordx4 v238, s[20:23], s40 offen offset:128 lds
    v_exp_f32 v116, v116
    v_exp_f32 v117, v117
    v_cvt_pk_bf16_f32 v173, v114, v115
    v_mfma_f32_32x32x16_bf16 v[136:151], v[228:231], v[36:39], v[136:151]
    ds_read_b128 v[216:219], v239 offset:17280
    ds_read_b128 v[220:223], v239 offset:17312
    ds_read_b128 v[224:227], v239 offset:17344
    ds_read_b128 v[228:231], v239 offset:17376
    v_exp_f32 v118, v118
    v_exp_f32 v119, v119
    v_cvt_pk_bf16_f32 v174, v116, v117
    s_waitcnt lgkmcnt(4)
    v_mfma_f32_32x32x16_bf16 v[152:167], v[200:203], v[8:11], v[184:199]
    s_add_u32 m0, s41, 51744
    s_nop 0
    buffer_load_dwordx4 v238, s[20:23], s40 offen offset:256 lds
    v_exp_f32 v120, v120
    v_exp_f32 v121, v121
    v_cvt_pk_bf16_f32 v175, v118, v119
    v_mfma_f32_32x32x16_bf16 v[152:167], v[204:207], v[12:15], v[152:167]
    s_add_u32 m0, s41, 52656
    s_nop 0
    buffer_load_dwordx4 v238, s[20:23], s40 offen offset:384 lds
    s_add_u32 s40, s40, 16384
    v_exp_f32 v122, v122
    v_exp_f32 v123, v123
    v_cvt_pk_bf16_f32 v176, v120, v121
    v_mfma_f32_32x32x16_bf16 v[152:167], v[208:211], v[16:19], v[152:167]
    v_exp_f32 v124, v124
    v_exp_f32 v125, v125
    v_cvt_pk_bf16_f32 v177, v122, v123
    v_mfma_f32_32x32x16_bf16 v[152:167], v[212:215], v[20:23], v[152:167]
    v_exp_f32 v126, v126
    v_exp_f32 v127, v127
    v_cvt_pk_bf16_f32 v178, v124, v125
    s_waitcnt lgkmcnt(0)
    v_mfma_f32_32x32x16_bf16 v[152:167], v[216:219], v[24:27], v[152:167]
    v_exp_f32 v128, v128
    v_exp_f32 v129, v129
    v_cvt_pk_bf16_f32 v179, v126, v127
    v_mfma_f32_32x32x16_bf16 v[152:167], v[220:223], v[28:31], v[152:167]
    v_exp_f32 v130, v130
    v_exp_f32 v131, v131
    v_cvt_pk_bf16_f32 v180, v128, v129
    v_mfma_f32_32x32x16_bf16 v[152:167], v[224:227], v[32:35], v[152:167]
    v_exp_f32 v132, v132
    v_exp_f32 v133, v133
    v_cvt_pk_bf16_f32 v181, v130, v131
    v_mfma_f32_32x32x16_bf16 v[152:167], v[228:231], v[36:39], v[152:167]
    v_exp_f32 v134, v134
    v_exp_f32 v135, v135
    v_cvt_pk_bf16_f32 v182, v132, v133
    v_cvt_pk_bf16_f32 v183, v134, v135
    s_add_u32 s29, s38, 3
    s_cmp_ge_u32 s29, s37
    s_cbranch_scc1 L_attn_kernel_msk_12
    ds_read_b128 v[200:203], v239 offset:33280
    ds_read_b128 v[204:207], v239 offset:33792
    ds_read_b128 v[208:211], v240 offset:0
    ds_read_b128 v[212:215], v240 offset:512
    ds_read_b128 v[216:219], v239 offset:33312
    ds_read_b128 v[220:223], v239 offset:33824
    ds_read_b128 v[224:227], v240 offset:32
    ds_read_b128 v[228:231], v240 offset:544
    s_waitcnt lgkmcnt(4)
    v_mfma_f32_32x32x16_bf16 v[40:55], v[200:203], v[168:171], v[40:55]
    v_add_f32 v232, v232, v104
    v_add_f32 v233, v233, v105
    v_mfma_f32_32x32x16_bf16 v[56:71], v[204:207], v[168:171], v[56:71]
    v_add_f32 v232, v232, v106
    v_add_f32 v233, v233, v107
    v_mfma_f32_32x32x16_bf16 v[72:87], v[208:211], v[168:171], v[72:87]
    v_add_f32 v232, v232, v108
    v_add_f32 v233, v233, v109
    v_mfma_f32_32x32x16_bf16 v[88:103], v[212:215], v[168:171], v[88:103]
    ds_read_b128 v[200:203], v239 offset:33344
    ds_read_b128 v[204:207], v239 offset:33856
    ds_read_b128 v[208:211], v240 offset:64
    ds_read_b128 v[212:215], v240 offset:576
    v_add_f32 v232, v232, v110
    v_add_f32 v233, v233, v111
    s_waitcnt lgkmcnt(4)
    v_mfma_f32_32x32x16_bf16 v[40:55], v[216:219], v[172:175], v[40:55]
    v_add_f32 v232, v232, v112
    v_add_f32 v233, v233, v113
    v_mfma_f32_32x32x16_bf16 v[56:71], v[220:223], v[172:175], v[56:71]
    v_add_f32 v232, v232, v114
    v_add_f32 v233, v233, v115
    v_mfma_f32_32x32x16_bf16 v[72:87], v[224:227], v[172:175], v[72:87]
    v_add_f32 v232, v232, v116
    v_add_f32 v233, v233, v117
    v_mfma_f32_32x32x16_bf16 v[88:103], v[228:231], v[172:175], v[88:103]
    ds_read_b128 v[216:219], v239 offset:33376
    ds_read_b128 v[220:223], v239 offset:33888
    ds_read_b128 v[224:227], v240 offset:96
    ds_read_b128 v[228:231], v240 offset:608
    v_add_f32 v232, v232, v118
    v_add_f32 v233, v233, v119
    s_waitcnt lgkmcnt(4)
    v_mfma_f32_32x32x16_bf16 v[40:55], v[200:203], v[176:179], v[40:55]
    v_add_f32 v232, v232, v120
    v_add_f32 v233, v233, v121
    v_mfma_f32_32x32x16_bf16 v[56:71], v[204:207], v[176:179], v[56:71]
    v_add_f32 v232, v232, v122
    v_add_f32 v233, v233, v123
    v_mfma_f32_32x32x16_bf16 v[72:87], v[208:211], v[176:179], v[72:87]
    v_add_f32 v232, v232, v124
    v_add_f32 v233, v233, v125
    v_mfma_f32_32x32x16_bf16 v[88:103], v[212:215], v[176:179], v[88:103]
    v_add_f32 v232, v232, v126
    v_add_f32 v233, v233, v127
    s_waitcnt lgkmcnt(0)
    v_mfma_f32_32x32x16_bf16 v[40:55], v[216:219], v[180:183], v[40:55]
    v_add_f32 v232, v232, v128
    v_add_f32 v233, v233, v129
    v_mfma_f32_32x32x16_bf16 v[56:71], v[220:223], v[180:183], v[56:71]
    v_add_f32 v232, v232, v130
    v_add_f32 v233, v233, v131
    v_mfma_f32_32x32x16_bf16 v[72:87], v[224:227], v[180:183], v[72:87]
    v_add_f32 v232, v232, v132
    v_add_f32 v233, v233, v133
    v_mfma_f32_32x32x16_bf16 v[88:103], v[228:231], v[180:183], v[88:103]
    v_add_f32 v232, v232, v134
    v_add_f32 v233, v233, v135
    s_branch L_attn_kernel_join_13
L_attn_kernel_msk_12:
    s_lshl_b32 s30, s38, 6
    s_add_u32 s30, s30, 64
    ds_read_b128 v[200:203], v239 offset:33280
    ds_read_b128 v[204:207], v239 offset:33792
    ds_read_b128 v[208:211], v240 offset:0
    ds_read_b128 v[212:215], v240 offset:512
    ds_read_b128 v[216:219], v239 offset:33312
    ds_read_b128 v[220:223], v239 offset:33824
    ds_read_b128 v[224:227], v240 offset:32
    ds_read_b128 v[228:231], v240 offset:544
    s_waitcnt lgkmcnt(4)
    v_mfma_f32_32x32x16_bf16 v[40:55], v[200:203], v[168:171], v[40:55]
    v_add_f32 v232, v232, v104
    v_add_f32 v233, v233, v105
    v_mfma_f32_32x32x16_bf16 v[56:71], v[204:207], v[168:171], v[56:71]
    v_add_f32 v232, v232, v106
    v_add_f32 v233, v233, v107
    v_mfma_f32_32x32x16_bf16 v[72:87], v[208:211], v[168:171], v[72:87]
    v_add_f32 v232, v232, v108
    v_add_f32 v233, v233, v109
    v_mfma_f32_32x32x16_bf16 v[88:103], v[212:215], v[168:171], v[88:103]
    ds_read_b128 v[200:203], v239 offset:33344
    ds_read_b128 v[204:207], v239 offset:33856
    ds_read_b128 v[208:211], v240 offset:64
    ds_read_b128 v[212:215], v240 offset:576
    v_add_f32 v232, v232, v110
    v_add_f32 v233, v233, v111
    s_waitcnt lgkmcnt(4)
    v_mfma_f32_32x32x16_bf16 v[40:55], v[216:219], v[172:175], v[40:55]
    v_add_f32 v232, v232, v112
    v_add_f32 v233, v233, v113
    v_mfma_f32_32x32x16_bf16 v[56:71], v[220:223], v[172:175], v[56:71]
    v_add_f32 v232, v232, v114
    v_add_f32 v233, v233, v115
    v_mfma_f32_32x32x16_bf16 v[72:87], v[224:227], v[172:175], v[72:87]
    v_add_f32 v232, v232, v116
    v_add_f32 v233, v233, v117
    v_subrev_u32 v236, s30, v234
    v_sub_u32 v236, v236, v235
    v_mov_b32 v4, 0xff800000
    v_cmp_gt_i32 s[42:43], 0, v236
    v_cmp_gt_i32 s[44:45], 1, v236
    v_cmp_gt_i32 s[46:47], 2, v236
    v_cmp_gt_i32 s[48:49], 3, v236
    v_cndmask_b32 v136, v136, v4, s[42:43]
    v_cndmask_b32 v137, v137, v4, s[44:45]
    v_cndmask_b32 v138, v138, v4, s[46:47]
    v_cndmask_b32 v139, v139, v4, s[48:49]
    v_cmp_gt_i32 s[42:43], 8, v236
    v_cmp_gt_i32 s[44:45], 9, v236
    v_cmp_gt_i32 s[46:47], 10, v236
    v_cmp_gt_i32 s[48:49], 11, v236
    v_cndmask_b32 v140, v140, v4, s[42:43]
    v_cndmask_b32 v141, v141, v4, s[44:45]
    v_cndmask_b32 v142, v142, v4, s[46:47]
    v_cndmask_b32 v143, v143, v4, s[48:49]
    v_cmp_gt_i32 s[42:43], 16, v236
    v_cmp_gt_i32 s[44:45], 17, v236
    v_cmp_gt_i32 s[46:47], 18, v236
    v_cmp_gt_i32 s[48:49], 19, v236
    v_cndmask_b32 v144, v144, v4, s[42:43]
    v_cndmask_b32 v145, v145, v4, s[44:45]
    v_cndmask_b32 v146, v146, v4, s[46:47]
    v_cndmask_b32 v147, v147, v4, s[48:49]
    v_cmp_gt_i32 s[42:43], 24, v236
    v_cmp_gt_i32 s[44:45], 25, v236
    v_cmp_gt_i32 s[46:47], 26, v236
    v_cmp_gt_i32 s[48:49], 27, v236
    v_cndmask_b32 v148, v148, v4, s[42:43]
    v_cndmask_b32 v149, v149, v4, s[44:45]
    v_cndmask_b32 v150, v150, v4, s[46:47]
    v_cndmask_b32 v151, v151, v4, s[48:49]
    v_cmp_gt_i32 s[42:43], 32, v236
    v_cmp_gt_i32 s[44:45], 33, v236
    v_cmp_gt_i32 s[46:47], 34, v236
    v_cmp_gt_i32 s[48:49], 35, v236
    v_cndmask_b32 v152, v152, v4, s[42:43]
    v_cndmask_b32 v153, v153, v4, s[44:45]
    v_cndmask_b32 v154, v154, v4, s[46:47]
    v_cndmask_b32 v155, v155, v4, s[48:49]
    v_cmp_gt_i32 s[42:43], 40, v236
    v_cmp_gt_i32 s[44:45], 41, v236
    v_cmp_gt_i32 s[46:47], 42, v236
    v_cmp_gt_i32 s[48:49], 43, v236
    v_cndmask_b32 v156, v156, v4, s[42:43]
    v_cndmask_b32 v157, v157, v4, s[44:45]
    v_cndmask_b32 v158, v158, v4, s[46:47]
    v_cndmask_b32 v159, v159, v4, s[48:49]
    v_cmp_gt_i32 s[42:43], 48, v236
    v_cmp_gt_i32 s[44:45], 49, v236
    v_cmp_gt_i32 s[46:47], 50, v236
    v_cmp_gt_i32 s[48:49], 51, v236
    v_cndmask_b32 v160, v160, v4, s[42:43]
    v_cndmask_b32 v161, v161, v4, s[44:45]
    v_cndmask_b32 v162, v162, v4, s[46:47]
    v_cndmask_b32 v163, v163, v4, s[48:49]
    v_cmp_gt_i32 s[42:43], 56, v236
    v_cmp_gt_i32 s[44:45], 57, v236
    v_cmp_gt_i32 s[46:47], 58, v236
    v_cmp_gt_i32 s[48:49], 59, v236
    v_cndmask_b32 v164, v164, v4, s[42:43]
    v_cndmask_b32 v165, v165, v4, s[44:45]
    v_cndmask_b32 v166, v166, v4, s[46:47]
    v_cndmask_b32 v167, v167, v4, s[48:49]
    v_mfma_f32_32x32x16_bf16 v[88:103], v[228:231], v[172:175], v[88:103]
    ds_read_b128 v[216:219], v239 offset:33376
    ds_read_b128 v[220:223], v239 offset:33888
    ds_read_b128 v[224:227], v240 offset:96
    ds_read_b128 v[228:231], v240 offset:608
    v_add_f32 v232, v232, v118
    v_add_f32 v233, v233, v119
    s_waitcnt lgkmcnt(4)
    v_mfma_f32_32x32x16_bf16 v[40:55], v[200:203], v[176:179], v[40:55]
    v_add_f32 v232, v232, v120
    v_add_f32 v233, v233, v121
    v_mfma_f32_32x32x16_bf16 v[56:71], v[204:207], v[176:179], v[56:71]
    v_add_f32 v232, v232, v122
    v_add_f32 v233, v233, v123
    v_mfma_f32_32x32x16_bf16 v[72:87], v[208:211], v[176:179], v[72:87]
    v_add_f32 v232, v232, v124
    v_add_f32 v233, v233, v125
    v_mfma_f32_32x32x16_bf16 v[88:103], v[212:215], v[176:179], v[88:103]
    v_add_f32 v232, v232, v126
    v_add_f32 v233, v233, v127
    s_waitcnt lgkmcnt(0)
    v_mfma_f32_32x32x16_bf16 v[40:55], v[216:219], v[180:183], v[40:55]
    v_add_f32 v232, v232, v128
    v_add_f32 v233, v233, v129
    v_mfma_f32_32x32x16_bf16 v[56:71], v[220:223], v[180:183], v[56:71]
    v_add_f32 v232, v232, v130
    v_add_f32 v233, v233, v131
    v_mfma_f32_32x32x16_bf16 v[72:87], v[224:227], v[180:183], v[72:87]
    v_add_f32 v232, v232, v132
    v_add_f32 v233, v233, v133
    v_mfma_f32_32x32x16_bf16 v[88:103], v[228:231], v[180:183], v[88:103]
    v_add_f32 v232, v232, v134
    v_add_f32 v233, v233, v135
L_attn_kernel_join_13:
    s_add_u32 s38, s38, 1
    s_waitcnt vmcnt(0)
    s_barrier
    s_sub_u32 s35, 15, s35
    s_cmp_lg_u32 s31, 0
    s_cbranch_scc1 L_attn_kernel_nopf_14
    s_lshl_b32 s36, s35, 7
    s_lshl_b32 s29, s28, 5
    s_add_u32 s36, s36, s29
    s_lshl_b32 s39, s34, 19
    s_mov_b32 s40, s39
    v_and_b32 v2, 31, v1
    v_add_u32 v2, s36, v2
    v_lshlrev_b32 v3, 8, v2
    v_lshl_add_u32 v3, v235, 2, v3
    buffer_load_dwordx4 v[8:11], v3, s[12:15], s39 offen offset:0
    buffer_load_dwordx4 v[12:15], v3, s[12:15], s39 offen offset:32
    buffer_load_dwordx4 v[16:19], v3, s[12:15], s39 offen offset:64
    buffer_load_dwordx4 v[20:23], v3, s[12:15], s39 offen offset:96
    buffer_load_dwordx4 v[24:27], v3, s[12:15], s39 offen offset:128
    buffer_load_dwordx4 v[28:31], v3, s[12:15], s39 offen offset:160
    buffer_load_dwordx4 v[32:35], v3, s[12:15], s39 offen offset:192
    buffer_load_dwordx4 v[36:39], v3, s[12:15], s39 offen offset:224
    s_add_u32 m0, s41, 0
    s_nop 0
    buffer_load_dwordx4 v237, s[16:19], s39 offen offset:0 lds
    s_add_u32 m0, s41, 784
    s_nop 0
    buffer_load_dwordx4 v237, s[16:19], s39 offen offset:256 lds
    s_add_u32 m0, s41, 1568
    s_nop 0
    buffer_load_dwordx4 v237, s[16:19], s39 offen offset:512 lds
    s_add_u32 m0, s41, 2352
    s_nop 0
    buffer_load_dwordx4 v237, s[16:19], s39 offen offset:768 lds
    s_add_u32 s39, s39, 16384
    s_add_u32 m0, s41, 16640
    s_nop 0
    buffer_load_dwordx4 v237, s[16:19], s39 offen offset:0 lds
    s_add_u32 m0, s41, 17424
    s_nop 0
    buffer_load_dwordx4 v237, s[16:19], s39 offen offset:256 lds
    s_add_u32 m0, s41, 18208
    s_nop 0
    buffer_load_dwordx4 v237, s[16:19], s39 offen offset:512 lds
    s_add_u32 m0, s41, 18992
    s_nop 0
    buffer_load_dwordx4 v237, s[16:19], s39 offen offset:768 lds
    s_add_u32 s39, s39, 16384
    s_add_u32 m0, s41, 33280
    s_nop 0
    buffer_load_dwordx4 v238, s[20:23], s40 offen offset:0 lds
    s_add_u32 m0, s41, 34192
    s_nop 0
    buffer_load_dwordx4 v238, s[20:23], s40 offen offset:128 lds
    s_add_u32 m0, s41, 35104
    s_nop 0
    buffer_load_dwordx4 v238, s[20:23], s40 offen offset:256 lds
    s_add_u32 m0, s41, 36016
    s_nop 0
    buffer_load_dwordx4 v238, s[20:23], s40 offen offset:384 lds
    s_add_u32 s40, s40, 16384
L_attn_kernel_nopf_14:
    v_exp_f32 v136, v136
    v_exp_f32 v137, v137
    v_exp_f32 v138, v138
    v_exp_f32 v139, v139
    v_cvt_pk_bf16_f32 v168, v136, v137
    v_exp_f32 v140, v140
    v_exp_f32 v141, v141
    v_cvt_pk_bf16_f32 v169, v138, v139
    v_exp_f32 v142, v142
    v_exp_f32 v143, v143
    v_cvt_pk_bf16_f32 v170, v140, v141
    v_exp_f32 v144, v144
    v_exp_f32 v145, v145
    v_cvt_pk_bf16_f32 v171, v142, v143
    v_exp_f32 v146, v146
    v_exp_f32 v147, v147
    v_cvt_pk_bf16_f32 v172, v144, v145
    v_exp_f32 v148, v148
    v_exp_f32 v149, v149
    v_cvt_pk_bf16_f32 v173, v146, v147
    v_exp_f32 v150, v150
    v_exp_f32 v151, v151
    v_cvt_pk_bf16_f32 v174, v148, v149
    v_exp_f32 v152, v152
    v_exp_f32 v153, v153
    v_cvt_pk_bf16_f32 v175, v150, v151
    v_exp_f32 v154, v154
    v_exp_f32 v155, v155
    v_cvt_pk_bf16_f32 v176, v152, v153
    v_exp_f32 v156, v156
    v_exp_f32 v157, v157
    v_cvt_pk_bf16_f32 v177, v154, v155
    v_exp_f32 v158, v158
    v_exp_f32 v159, v159
    v_cvt_pk_bf16_f32 v178, v156, v157
    v_exp_f32 v160, v160
    v_exp_f32 v161, v161
    v_cvt_pk_bf16_f32 v179, v158, v159
    v_exp_f32 v162, v162
    v_exp_f32 v163, v163
    v_cvt_pk_bf16_f32 v180, v160, v161
    v_exp_f32 v164, v164
    v_exp_f32 v165, v165
    v_cvt_pk_bf16_f32 v181, v162, v163
    v_exp_f32 v166, v166
    v_exp_f32 v167, v167
    v_cvt_pk_bf16_f32 v182, v164, v165
    s_nop 0
    v_cvt_pk_bf16_f32 v183, v166, v167
    ds_read_b128 v[200:203], v239 offset:49920
    ds_read_b128 v[204:207], v239 offset:50432
    ds_read_b128 v[208:211], v240 offset:16640
    ds_read_b128 v[212:215], v240 offset:17152
    ds_read_b128 v[216:219], v239 offset:49952
    ds_read_b128 v[220:223], v239 offset:50464
    ds_read_b128 v[224:227], v240 offset:16672
    ds_read_b128 v[228:231], v240 offset:17184
    s_waitcnt lgkmcnt(4)
    v_mfma_f32_32x32x16_bf16 v[40:55], v[200:203], v[168:171], v[40:55]
    v_add_f32 v232, v232, v136
    v_add_f32 v233, v233, v137
    v_mfma_f32_32x32x16_bf16 v[56:71], v[204:207], v[168:171], v[56:71]
    v_add_f32 v232, v232, v138
    v_add_f32 v233, v233, v139
    v_mfma_f32_32x32x16_bf16 v[72:87], v[208:211], v[168:171], v[72:87]
    v_add_f32 v232, v232, v140
    v_add_f32 v233, v233, v141
    v_mfma_f32_32x32x16_bf16 v[88:103], v[212:215], v[168:171], v[88:103]
    ds_read_b128 v[200:203], v239 offset:49984
    ds_read_b128 v[204:207], v239 offset:50496
    ds_read_b128 v[208:211], v240 offset:16704
    ds_read_b128 v[212:215], v240 offset:17216
    v_add_f32 v232, v232, v142
    v_add_f32 v233, v233, v143
    s_waitcnt lgkmcnt(4)
    v_mfma_f32_32x32x16_bf16 v[40:55], v[216:219], v[172:175], v[40:55]
    v_add_f32 v232, v232, v144
    v_add_f32 v233, v233, v145
    v_mfma_f32_32x32x16_bf16 v[56:71], v[220:223], v[172:175], v[56:71]
    v_add_f32 v232, v232, v146
    v_add_f32 v233, v233, v147
    v_mfma_f32_32x32x16_bf16 v[72:87], v[224:227], v[172:175], v[72:87]
    v_add_f32 v232, v232, v148
    v_add_f32 v233, v233, v149
    v_mfma_f32_32x32x16_bf16 v[88:103], v[228:231], v[172:175], v[88:103]
    ds_read_b128 v[216:219], v239 offset:50016
    ds_read_b128 v[220:223], v239 offset:50528
    ds_read_b128 v[224:227], v240 offset:16736
    ds_read_b128 v[228:231], v240 offset:17248
    v_add_f32 v232, v232, v150
    v_add_f32 v233, v233, v151
    s_waitcnt lgkmcnt(4)
    v_mfma_f32_32x32x16_bf16 v[40:55], v[200:203], v[176:179], v[40:55]
    v_add_f32 v232, v232, v152
    v_add_f32 v233, v233, v153
    v_mfma_f32_32x32x16_bf16 v[56:71], v[204:207], v[176:179], v[56:71]
    v_add_f32 v232, v232, v154
    v_add_f32 v233, v233, v155
    v_mfma_f32_32x32x16_bf16 v[72:87], v[208:211], v[176:179], v[72:87]
    v_add_f32 v232, v232, v156
    v_add_f32 v233, v233, v157
    v_mfma_f32_32x32x16_bf16 v[88:103], v[212:215], v[176:179], v[88:103]
    v_add_f32 v232, v232, v158
    v_add_f32 v233, v233, v159
    s_waitcnt lgkmcnt(0)
    v_mfma_f32_32x32x16_bf16 v[40:55], v[216:219], v[180:183], v[40:55]
    v_add_f32 v232, v232, v160
    v_add_f32 v233, v233, v161
    v_mfma_f32_32x32x16_bf16 v[56:71], v[220:223], v[180:183], v[56:71]
    v_add_f32 v232, v232, v162
    v_add_f32 v233, v233, v163
    v_mfma_f32_32x32x16_bf16 v[72:87], v[224:227], v[180:183], v[72:87]
    v_add_f32 v232, v232, v164
    v_add_f32 v233, v233, v165
    v_mfma_f32_32x32x16_bf16 v[88:103], v[228:231], v[180:183], v[88:103]
    v_add_f32 v232, v232, v166
    v_add_f32 v233, v233, v167
    s_nop 15
    v_lshrrev_b32 v2, 7, v234
    v_lshlrev_b32 v236, 20, v2
    v_and_b32 v2, 127, v234
    v_lshl_add_u32 v236, v2, 7, v236
    v_lshl_add_u32 v236, v235, 2, v236
    s_lshl_b32 s29, s34, 15
    s_add_u32 s30, s29, 16384
    v_add_f32 v2, v232, v233
    v_mov_b32 v3, v2
    s_nop 1
    v_permlane32_swap_b32 v2, v3
    s_nop 1
    v_add_f32 v2, v2, v3
    v_mov_b32 v3, 0x71800000
    v_cmp_nlt_f32 vcc, v2, v3
    s_nop 1
    s_or_b32 s33, s33, vcc_lo
    s_or_b32 s33, s33, vcc_hi
    v_rcp_f32 v2, v2
    s_nop 0
    v_mul_f32 v40, v40, v2
    v_mul_f32 v41, v41, v2
    v_mul_f32 v42, v42, v2
    v_mul_f32 v43, v43, v2
    v_mul_f32 v44, v44, v2
    v_mul_f32 v45, v45, v2
    v_mul_f32 v46, v46, v2
    v_mul_f32 v47, v47, v2
    v_mul_f32 v48, v48, v2
    v_mul_f32 v49, v49, v2
    v_mul_f32 v50, v50, v2
    v_mul_f32 v51, v51, v2
    v_mul_f32 v52, v52, v2
    v_mul_f32 v53, v53, v2
    v_mul_f32 v54, v54, v2
    v_mul_f32 v55, v55, v2
    v_cvt_pk_bf16_f32 v40, v40, v41
    v_cvt_pk_bf16_f32 v41, v42, v43
    v_cvt_pk_bf16_f32 v42, v44, v45
    v_cvt_pk_bf16_f32 v43, v46, v47
    v_cvt_pk_bf16_f32 v44, v48, v49
    v_cvt_pk_bf16_f32 v45, v50, v51
    v_cvt_pk_bf16_f32 v46, v52, v53
    v_cvt_pk_bf16_f32 v47, v54, v55
    s_nop 1
    v_permlane32_swap_b32 v40, v42
    v_permlane32_swap_b32 v41, v43
    v_permlane32_swap_b32 v44, v46
    v_permlane32_swap_b32 v45, v47
    s_nop 1
    buffer_store_dwordx4 v[40:43], v236, s[24:27], s29 offen offset:0
    buffer_store_dwordx4 v[44:47], v236, s[24:27], s29 offen offset:32
    v_mul_f32 v56, v56, v2
    v_mul_f32 v57, v57, v2
    v_mul_f32 v58, v58, v2
    v_mul_f32 v59, v59, v2
    v_mul_f32 v60, v60, v2
    v_mul_f32 v61, v61, v2
    v_mul_f32 v62, v62, v2
    v_mul_f32 v63, v63, v2
    v_mul_f32 v64, v64, v2
    v_mul_f32 v65, v65, v2
    v_mul_f32 v66, v66, v2
    v_mul_f32 v67, v67, v2
    v_mul_f32 v68, v68, v2
    v_mul_f32 v69, v69, v2
    v_mul_f32 v70, v70, v2
    v_mul_f32 v71, v71, v2
    v_cvt_pk_bf16_f32 v56, v56, v57
    v_cvt_pk_bf16_f32 v57, v58, v59
    v_cvt_pk_bf16_f32 v58, v60, v61
    v_cvt_pk_bf16_f32 v59, v62, v63
    v_cvt_pk_bf16_f32 v60, v64, v65
    v_cvt_pk_bf16_f32 v61, v66, v67
    v_cvt_pk_bf16_f32 v62, v68, v69
    v_cvt_pk_bf16_f32 v63, v70, v71
    s_nop 1
    v_permlane32_swap_b32 v56, v58
    v_permlane32_swap_b32 v57, v59
    v_permlane32_swap_b32 v60, v62
    v_permlane32_swap_b32 v61, v63
    s_nop 1
    buffer_store_dwordx4 v[56:59], v236, s[24:27], s29 offen offset:64
    buffer_store_dwordx4 v[60:63], v236, s[24:27], s29 offen offset:96
    v_mul_f32 v72, v72, v2
    v_mul_f32 v73, v73, v2
    v_mul_f32 v74, v74, v2
    v_mul_f32 v75, v75, v2
    v_mul_f32 v76, v76, v2
    v_mul_f32 v77, v77, v2
    v_mul_f32 v78, v78, v2
    v_mul_f32 v79, v79, v2
    v_mul_f32 v80, v80, v2
    v_mul_f32 v81, v81, v2
    v_mul_f32 v82, v82, v2
    v_mul_f32 v83, v83, v2
    v_mul_f32 v84, v84, v2
    v_mul_f32 v85, v85, v2
    v_mul_f32 v86, v86, v2
    v_mul_f32 v87, v87, v2
    v_cvt_pk_bf16_f32 v72, v72, v73
    v_cvt_pk_bf16_f32 v73, v74, v75
    v_cvt_pk_bf16_f32 v74, v76, v77
    v_cvt_pk_bf16_f32 v75, v78, v79
    v_cvt_pk_bf16_f32 v76, v80, v81
    v_cvt_pk_bf16_f32 v77, v82, v83
    v_cvt_pk_bf16_f32 v78, v84, v85
    v_cvt_pk_bf16_f32 v79, v86, v87
    s_nop 1
    v_permlane32_swap_b32 v72, v74
    v_permlane32_swap_b32 v73, v75
    v_permlane32_swap_b32 v76, v78
    v_permlane32_swap_b32 v77, v79
    s_nop 1
    buffer_store_dwordx4 v[72:75], v236, s[24:27], s30 offen offset:0
    buffer_store_dwordx4 v[76:79], v236, s[24:27], s30 offen offset:32
    v_mul_f32 v88, v88, v2
    v_mul_f32 v89, v89, v2
    v_mul_f32 v90, v90, v2
    v_mul_f32 v91, v91, v2
    v_mul_f32 v92, v92, v2
    v_mul_f32 v93, v93, v2
    v_mul_f32 v94, v94, v2
    v_mul_f32 v95, v95, v2
    v_mul_f32 v96, v96, v2
    v_mul_f32 v97, v97, v2
    v_mul_f32 v98, v98, v2
    v_mul_f32 v99, v99, v2
    v_mul_f32 v100, v100, v2
    v_mul_f32 v101, v101, v2
    v_mul_f32 v102, v102, v2
    v_mul_f32 v103, v103, v2
    v_cvt_pk_bf16_f32 v88, v88, v89
    v_cvt_pk_bf16_f32 v89, v90, v91
    v_cvt_pk_bf16_f32 v90, v92, v93
    v_cvt_pk_bf16_f32 v91, v94, v95
    v_cvt_pk_bf16_f32 v92, v96, v97
    v_cvt_pk_bf16_f32 v93, v98, v99
    v_cvt_pk_bf16_f32 v94, v100, v101
    v_cvt_pk_bf16_f32 v95, v102, v103
    s_nop 1
    v_permlane32_swap_b32 v88, v90
    v_permlane32_swap_b32 v89, v91
    v_permlane32_swap_b32 v92, v94
    v_permlane32_swap_b32 v93, v95
    s_nop 1
    buffer_store_dwordx4 v[88:91], v236, s[24:27], s30 offen offset:64
    buffer_store_dwordx4 v[92:95], v236, s[24:27], s30 offen offset:96
    s_nop 1
    s_add_u32 s31, s31, 1
    s_cmp_lt_u32 s31, 2
    s_cbranch_scc1 L_attn_kernel_btop_4
    s_branch L_attn_kernel_vote_2
L_attn_kernel_attnA_3:
    s_sub_u32 s28, s32, 4
    s_add_u32 s12, s4, 0x4000000
    s_addc_u32 s13, s5, 0
    s_and_b32 s13, s13, 0xffff
    s_mov_b32 s14, 0x400000
    s_mov_b32 s15, 0x20000
    s_add_u32 s16, s4, 0x4800000
    s_addc_u32 s17, s5, 0
    s_and_b32 s17, s17, 0xffff
    s_mov_b32 s18, 0x20000
    s_mov_b32 s19, 0x20000
    s_add_u32 s20, s4, 0x4900000
    s_addc_u32 s21, s5, 0
    s_and_b32 s21, s21, 0xffff
    s_mov_b32 s22, 0x20000
    s_mov_b32 s23, 0x20000
    s_add_u32 s24, s4, 0x4400000
    s_addc_u32 s25, s5, 0
    s_and_b32 s25, s25, 0xffff
    s_mov_b32 s26, 0x400000
    s_mov_b32 s27, 0x20000
L_attn_kernel_atop_15:
    s_and_b32 s35, s2, 15
    s_lshr_b32 s34, s2, 4
    s_lshl_b32 s34, s34, 1
    s_add_u32 s34, s34, s31
    s_lshl_b32 s35, s35, 7
    s_lshl_b32 s29, s28, 5
    s_add_u32 s35, s35, s29
    s_lshl_b32 s38, s34, 6
    v_and_b32 v2, 31, v1
    v_lshrrev_b32 v4, 5, v1
    v_add_u32 v3, s35, v2
    v_lshlrev_b32 v3, 11, v3
    v_lshl_add_u32 v236, v4, 4, v3
    buffer_load_dwordx4 v[8:11], v236, s[12:15], s38 offen offset:0
    buffer_load_dwordx4 v[12:15], v236, s[12:15], s38 offen offset:32
    buffer_load_dwordx4 v[16:19], v236, s[12:15], s38 offen offset:64
    buffer_load_dwordx4 v[20:23], v236, s[12:15], s38 offen offset:96
    v_bfe_u32 v3, v1, 2, 2
    v_xor_b32 v3, v3, v4
    v_lshlrev_b32 v2, 6, v2
    v_xor_b32 v4, 0, v3
    v_lshl_add_u32 v238, v4, 4, v2
    v_xor_b32 v4, 2, v3
    v_lshl_add_u32 v239, v4, 4, v2
    v_lshrrev_b32 v2, 2, v1
    v_lshrrev_b32 v3, 4, v1
    v_xor_b32 v3, v3, v1
    v_and_b32 v3, 3, v3
    v_lshlrev_b32 v2, 6, v2
    v_lshl_add_u32 v2, v3, 4, v2
    s_lshl_b32 s42, s28, 11
    v_add_u32 v237, s42, v2
    s_mov_b32 s36, 0
    s_mov_b32 s37, 0
    s_mov_b32 s39, 66560
    s_mov_b32 s40, 66560
    s_mov_b32 s41, 82944
    s_add_u32 s29, s39, s42
    s_mov_b32 m0, s29
    s_nop 0
    buffer_load_dwordx4 v237, s[16:19], s37 offen offset:0 lds
    s_mov_b32 m0, s29
    s_nop 0
    buffer_load_dwordx4 v237, s[16:19], s37 offen offset:1024 lds
    s_add_u32 m0, s29, 8192
    s_nop 0
    buffer_load_dwordx4 v237, s[20:23], s37 offen offset:0 lds
    s_add_u32 m0, s29, 8192
    s_nop 0
    buffer_load_dwordx4 v237, s[20:23], s37 offen offset:1024 lds
    s_add_u32 s37, s37, 8192
    s_add_u32 s39, s39, 16384
    s_cmp_eq_u32 s39, 115712
    s_cselect_b32 s39, 66560, s39
    s_add_u32 s29, s39, s42
    s_mov_b32 m0, s29
    s_nop 0
    buffer_load_dwordx4 v237, s[16:19], s37 offen offset:0 lds
    s_mov_b32 m0, s29
    s_nop 0
    buffer_load_dwordx4 v237, s[16:19], s37 offen offset:1024 lds
    s_add_u32 m0, s29, 8192
    s_nop 0
    buffer_load_dwordx4 v237, s[20:23], s37 offen offset:0 lds
    s_add_u32 m0, s29, 8192
    s_nop 0
    buffer_load_dwordx4 v237, s[20:23], s37 offen offset:1024 lds
    s_add_u32 s37, s37, 8192
    s_add_u32 s39, s39, 16384
    s_cmp_eq_u32 s39, 115712
    s_cselect_b32 s39, 66560, s39
    v_mov_b32 v24, 0
    v_mov_b32 v56, 0
    v_mov_b32 v25, 0
    v_mov_b32 v57, 0
    v_mov_b32 v26, 0
    v_mov_b32 v58, 0
    v_mov_b32 v27, 0
    v_mov_b32 v59, 0
    v_mov_b32 v28, 0
    v_mov_b32 v60, 0
    v_mov_b32 v29, 0
    v_mov_b32 v61, 0
    v_mov_b32 v30, 0
    v_mov_b32 v62, 0
    v_mov_b32 v31, 0
    v_mov_b32 v63, 0
    v_mov_b32 v32, 0
    v_mov_b32 v64, 0
    v_mov_b32 v33, 0
    v_mov_b32 v65, 0
    v_mov_b32 v34, 0
    v_mov_b32 v66, 0
    v_mov_b32 v35, 0
    v_mov_b32 v67, 0
    v_mov_b32 v36, 0
    v_mov_b32 v68, 0
    v_mov_b32 v37, 0
    v_mov_b32 v69, 0
    v_mov_b32 v38, 0
    v_mov_b32 v70, 0
    v_mov_b32 v39, 0
    v_mov_b32 v71, 0
    v_mov_b32 v40, 0
    v_mov_b32 v72, 0
    v_mov_b32 v41, 0
    v_mov_b32 v73, 0
    v_mov_b32 v42, 0
    v_mov_b32 v74, 0
    v_mov_b32 v43, 0
    v_mov_b32 v75, 0
    v_mov_b32 v44, 0
    v_mov_b32 v76, 0
    v_mov_b32 v45, 0
    v_mov_b32 v77, 0
    v_mov_b32 v46, 0
    v_mov_b32 v78, 0
    v_mov_b32 v47, 0
    v_mov_b32 v79, 0
    v_mov_b32 v48, 0
    v_mov_b32 v80, 0
    v_mov_b32 v49, 0
    v_mov_b32 v81, 0
    v_mov_b32 v50, 0
    v_mov_b32 v82, 0
    v_mov_b32 v51, 0
    v_mov_b32 v83, 0
    v_mov_b32 v52, 0
    v_mov_b32 v84, 0
    v_mov_b32 v53, 0
    v_mov_b32 v85, 0
    v_mov_b32 v54, 0
    v_mov_b32 v86, 0
    v_mov_b32 v55, 0
    v_mov_b32 v87, 0
    v_mov_b32 v232, 0x3f803f80
    v_mov_b32 v233, 0x3f803f80
    v_mov_b32 v234, 0x3f803f80
    v_mov_b32 v235, 0x3f803f80
    s_waitcnt vmcnt(0)
    s_barrier
    v_add_u32 v240, s40, v238
    v_add_u32 v242, s41, v238
    v_add_u32 v241, s40, v239
    v_add_u32 v243, s41, v239
    ds_read_b128 v[200:203], v240 offset:0
    ds_read_b128 v[204:207], v241 offset:0
    ds_read_b128 v[208:211], v240 offset:2048
    ds_read_b128 v[212:215], v241 offset:2048
    s_waitcnt lgkmcnt(0)
    v_mfma_f32_32x32x16_bf16 v[88:103], v[200:203], v[8:11], 0
    v_mfma_f32_32x32x16_bf16 v[88:103], v[204:207], v[12:15], v[88:103]
    v_mfma_f32_32x32x16_bf16 v[104:119], v[208:211], v[8:11], 0
    v_mfma_f32_32x32x16_bf16 v[104:119], v[212:215], v[12:15], v[104:119]
    v_mfma_f32_32x32x16_bf16 v[120:135], v[200:203], v[16:19], 0
    v_mfma_f32_32x32x16_bf16 v[120:135], v[204:207], v[20:23], v[120:135]
    v_mfma_f32_32x32x16_bf16 v[136:151], v[208:211], v[16:19], 0
    v_mfma_f32_32x32x16_bf16 v[136:151], v[212:215], v[20:23], v[136:151]
    s_nop 15
    v_max3_f32 v2, v88, v89, v90
    v_max3_f32 v2, v2, v91, v92
    v_max3_f32 v2, v2, v93, v94
    v_max3_f32 v2, v2, v95, v96
    v_max3_f32 v2, v2, v97, v98
    v_max3_f32 v2, v2, v99, v100
    v_max3_f32 v2, v2, v101, v102
    v_max3_f32 v2, v2, v103, v104
    v_max3_f32 v2, v2, v105, v106
    v_max3_f32 v2, v2, v107, v108
    v_max3_f32 v2, v2, v109, v110
    v_max3_f32 v2, v2, v111, v112
    v_max3_f32 v2, v2, v113, v114
    v_max3_f32 v2, v2, v115, v116
    v_max3_f32 v2, v2, v117, v118
    v_max_f32 v2, v2, v119
    v_max3_f32 v4, v120, v121, v122
    v_max3_f32 v4, v4, v123, v124
    v_max3_f32 v4, v4, v125, v126
    v_max3_f32 v4, v4, v127, v128
    v_max3_f32 v4, v4, v129, v130
    v_max3_f32 v4, v4, v131, v132
    v_max3_f32 v4, v4, v133, v134
    v_max3_f32 v4, v4, v135, v136
    v_max3_f32 v4, v4, v137, v138
    v_max3_f32 v4, v4, v139, v140
    v_max3_f32 v4, v4, v141, v142
    v_max3_f32 v4, v4, v143, v144
    v_max3_f32 v4, v4, v145, v146
    v_max3_f32 v4, v4, v147, v148
    v_max3_f32 v4, v4, v149, v150
    v_max_f32 v4, v4, v151
    v_max_f32 v2, v2, v4
    v_mov_b32 v3, v2
    s_nop 1
    v_permlane32_swap_b32 v2, v3
    s_nop 1
    v_max_f32 v2, v2, v3
    v_sub_f32 v88, v88, v2
    v_sub_f32 v89, v89, v2
    v_sub_f32 v90, v90, v2
    v_sub_f32 v91, v91, v2
    v_sub_f32 v92, v92, v2
    v_sub_f32 v93, v93, v2
    v_sub_f32 v94, v94, v2
    v_sub_f32 v95, v95, v2
    v_sub_f32 v96, v96, v2
    v_sub_f32 v97, v97, v2
    v_sub_f32 v98, v98, v2
    v_sub_f32 v99, v99, v2
    v_sub_f32 v100, v100, v2
    v_sub_f32 v101, v101, v2
    v_sub_f32 v102, v102, v2
    v_sub_f32 v103, v103, v2
    v_sub_f32 v104, v104, v2
    v_sub_f32 v105, v105, v2
    v_sub_f32 v106, v106, v2
    v_sub_f32 v107, v107, v2
    v_sub_f32 v108, v108, v2
    v_sub_f32 v109, v109, v2
    v_sub_f32 v110, v110, v2
    v_sub_f32 v111, v111, v2
    v_sub_f32 v112, v112, v2
    v_sub_f32 v113, v113, v2
    v_sub_f32 v114, v114, v2
    v_sub_f32 v115, v115, v2
    v_sub_f32 v116, v116, v2
    v_sub_f32 v117, v117, v2
    v_sub_f32 v118, v118, v2
    v_sub_f32 v119, v119, v2
    v_sub_f32 v120, v120, v2
    v_sub_f32 v121, v121, v2
    v_sub_f32 v122, v122, v2
    v_sub_f32 v123, v123, v2
    v_sub_f32 v124, v124, v2
    v_sub_f32 v125, v125, v2
    v_sub_f32 v126, v126, v2
    v_sub_f32 v127, v127, v2
    v_sub_f32 v128, v128, v2
    v_sub_f32 v129, v129, v2
    v_sub_f32 v130, v130, v2
    v_sub_f32 v131, v131, v2
    v_sub_f32 v132, v132, v2
    v_sub_f32 v133, v133, v2
    v_sub_f32 v134, v134, v2
    v_sub_f32 v135, v135, v2
    v_sub_f32 v136, v136, v2
    v_sub_f32 v137, v137, v2
    v_sub_f32 v138, v138, v2
    v_sub_f32 v139, v139, v2
    v_sub_f32 v140, v140, v2
    v_sub_f32 v141, v141, v2
    v_sub_f32 v142, v142, v2
    v_sub_f32 v143, v143, v2
    v_sub_f32 v144, v144, v2
    v_sub_f32 v145, v145, v2
    v_sub_f32 v146, v146, v2
    v_sub_f32 v147, v147, v2
    v_sub_f32 v148, v148, v2
    v_sub_f32 v149, v149, v2
    v_sub_f32 v150, v150, v2
    v_sub_f32 v151, v151, v2
    v_sub_f32 v3, 0, v2
    v_mov_b32 v184, v3
    v_mov_b32 v185, v3
    v_mov_b32 v186, v3
    v_mov_b32 v187, v3
    v_mov_b32 v188, v3
    v_mov_b32 v189, v3
    v_mov_b32 v190, v3
    v_mov_b32 v191, v3
    v_mov_b32 v192, v3
    v_mov_b32 v193, v3
    v_mov_b32 v194, v3
    v_mov_b32 v195, v3
    v_mov_b32 v196, v3
    v_mov_b32 v197, v3
    v_mov_b32 v198, v3
    v_mov_b32 v199, v3
    s_mov_b32 s44, s6
    s_and_b32 s45, s7, 0xffff
    s_mov_b32 s46, 0x800000
    s_mov_b32 s47, 0x20000
    s_lshl_b32 s48, s2, 15
    s_lshl_b32 s29, s28, 10
    s_add_u32 s48, s48, s29
    v_lshlrev_b32 v64, 4, v1
    s_barrier
    s_barrier
    s_barrier
    s_cmp_lg_u32 s36, 8
    s_cbranch_scc1 L_attn_kernel_pfsw_16
    s_mov_b32 s44, s8
    s_and_b32 s45, s9, 0xffff
    s_mov_b32 s46, 0x200000
    s_mov_b32 s47, 0x20000
    s_lshl_b32 s48, s2, 13
    s_lshl_b32 s29, s28, 10
    s_add_u32 s48, s48, s29
L_attn_kernel_pfsw_16:
    buffer_load_dwordx4 v[60:63], v64, s[44:47], s48 offen
    s_add_u32 s48, s48, 4096
    v_exp_f32 v88, v88
    v_exp_f32 v89, v89
    v_exp_f32 v90, v90
    v_exp_f32 v91, v91
    v_cvt_pk_bf16_f32 v152, v88, v89
    v_add_f32 v56, v56, v88
    v_add_f32 v57, v57, v89
    v_exp_f32 v92, v92
    v_exp_f32 v93, v93
    v_cvt_pk_bf16_f32 v153, v90, v91
    v_add_f32 v56, v56, v90
    v_add_f32 v57, v57, v91
    v_exp_f32 v94, v94
    v_exp_f32 v95, v95
    v_cvt_pk_bf16_f32 v154, v92, v93
    v_add_f32 v56, v56, v92
    v_add_f32 v57, v57, v93
    v_exp_f32 v96, v96
    v_exp_f32 v97, v97
    v_cvt_pk_bf16_f32 v155, v94, v95
    v_add_f32 v56, v56, v94
    v_add_f32 v57, v57, v95
    v_exp_f32 v98, v98
    v_exp_f32 v99, v99
    v_cvt_pk_bf16_f32 v156, v96, v97
    v_add_f32 v56, v56, v96
    v_add_f32 v57, v57, v97
    v_exp_f32 v100, v100
    v_exp_f32 v101, v101
    v_cvt_pk_bf16_f32 v157, v98, v99
    v_add_f32 v56, v56, v98
    v_add_f32 v57, v57, v99
    v_exp_f32 v102, v102
    v_exp_f32 v103, v103
    v_cvt_pk_bf16_f32 v158, v100, v101
    v_add_f32 v56, v56, v100
    v_add_f32 v57, v57, v101
    v_exp_f32 v104, v104
    v_exp_f32 v105, v105
    v_cvt_pk_bf16_f32 v159, v102, v103
    v_add_f32 v56, v56, v102
    v_add_f32 v57, v57, v103
    v_exp_f32 v106, v106
    v_exp_f32 v107, v107
    v_cvt_pk_bf16_f32 v160, v104, v105
    v_add_f32 v56, v56, v104
    v_add_f32 v57, v57, v105
    v_exp_f32 v108, v108
    v_exp_f32 v109, v109
    v_cvt_pk_bf16_f32 v161, v106, v107
    v_add_f32 v56, v56, v106
    v_add_f32 v57, v57, v107
    v_exp_f32 v110, v110
    v_exp_f32 v111, v111
    v_cvt_pk_bf16_f32 v162, v108, v109
    v_add_f32 v56, v56, v108
    v_add_f32 v57, v57, v109
    v_exp_f32 v112, v112
    v_exp_f32 v113, v113
    v_cvt_pk_bf16_f32 v163, v110, v111
    v_add_f32 v56, v56, v110
    v_add_f32 v57, v57, v111
    ds_read_b128 v[216:219], v240 offset:8192
    ds_read_b128 v[220:223], v241 offset:8192
    ds_read_b128 v[224:227], v240 offset:10240
    ds_read_b128 v[228:231], v241 offset:10240
    ds_read_b128 v[200:203], v240 offset:4096
    ds_read_b128 v[204:207], v241 offset:4096
    ds_read_b128 v[208:211], v240 offset:6144
    ds_read_b128 v[212:215], v241 offset:6144
    v_exp_f32 v114, v114
    v_exp_f32 v115, v115
    v_cvt_pk_bf16_f32 v164, v112, v113
    v_add_f32 v56, v56, v112
    v_add_f32 v57, v57, v113
    v_exp_f32 v116, v116
    v_exp_f32 v117, v117
    v_cvt_pk_bf16_f32 v165, v114, v115
    v_add_f32 v56, v56, v114
    v_add_f32 v57, v57, v115
    v_exp_f32 v118, v118
    v_exp_f32 v119, v119
    v_cvt_pk_bf16_f32 v166, v116, v117
    v_add_f32 v56, v56, v116
    v_add_f32 v57, v57, v117
    s_nop 0
    v_cvt_pk_bf16_f32 v167, v118, v119
    v_add_f32 v56, v56, v118
    v_add_f32 v57, v57, v119
    s_waitcnt lgkmcnt(0)
    v_exp_f32 v120, v120
    v_exp_f32 v121, v121
    v_mfma_f32_32x32x16_bf16 v[24:39], v[216:219], v[152:155], v[24:39]
    v_exp_f32 v122, v122
    v_exp_f32 v123, v123
    v_cvt_pk_bf16_f32 v168, v120, v121
    v_add_f32 v72, v72, v120
    v_add_f32 v73, v73, v121
    v_exp_f32 v124, v124
    v_exp_f32 v125, v125
    v_cvt_pk_bf16_f32 v169, v122, v123
    v_add_f32 v72, v72, v122
    v_add_f32 v73, v73, v123
    v_mfma_f32_32x32x16_bf16 v[24:39], v[220:223], v[156:159], v[24:39]
    v_exp_f32 v126, v126
    v_exp_f32 v127, v127
    v_cvt_pk_bf16_f32 v170, v124, v125
    v_add_f32 v72, v72, v124
    v_add_f32 v73, v73, v125
    v_exp_f32 v128, v128
    v_exp_f32 v129, v129
    v_cvt_pk_bf16_f32 v171, v126, v127
    v_add_f32 v72, v72, v126
    v_add_f32 v73, v73, v127
    v_mfma_f32_32x32x16_bf16 v[24:39], v[224:227], v[160:163], v[24:39]
    v_exp_f32 v130, v130
    v_exp_f32 v131, v131
    v_cvt_pk_bf16_f32 v172, v128, v129
    v_add_f32 v72, v72, v128
    v_add_f32 v73, v73, v129
    v_exp_f32 v132, v132
    v_exp_f32 v133, v133
    v_cvt_pk_bf16_f32 v173, v130, v131
    v_add_f32 v72, v72, v130
    v_add_f32 v73, v73, v131
    v_mfma_f32_32x32x16_bf16 v[24:39], v[228:231], v[164:167], v[24:39]
    v_exp_f32 v134, v134
    v_exp_f32 v135, v135
    v_cvt_pk_bf16_f32 v174, v132, v133
    v_add_f32 v72, v72, v132
    v_add_f32 v73, v73, v133
    v_exp_f32 v136, v136
    v_exp_f32 v137, v137
    v_cvt_pk_bf16_f32 v175, v134, v135
    v_add_f32 v72, v72, v134
    v_add_f32 v73, v73, v135
    v_mfma_f32_32x32x16_bf16 v[88:103], v[200:203], v[8:11], v[184:199]
    v_exp_f32 v138, v138
    v_exp_f32 v139, v139
    v_cvt_pk_bf16_f32 v176, v136, v137
    v_add_f32 v72, v72, v136
    v_add_f32 v73, v73, v137
    v_mfma_f32_32x32x16_bf16 v[88:103], v[204:207], v[12:15], v[88:103]
    v_exp_f32 v140, v140
    v_exp_f32 v141, v141
    v_cvt_pk_bf16_f32 v177, v138, v139
    v_add_f32 v72, v72, v138
    v_add_f32 v73, v73, v139
    v_mfma_f32_32x32x16_bf16 v[104:119], v[208:211], v[8:11], v[184:199]
    v_exp_f32 v142, v142
    v_exp_f32 v143, v143
    v_cvt_pk_bf16_f32 v178, v140, v141
    v_add_f32 v72, v72, v140
    v_add_f32 v73, v73, v141
    v_mfma_f32_32x32x16_bf16 v[104:119], v[212:215], v[12:15], v[104:119]
    v_exp_f32 v144, v144
    v_exp_f32 v145, v145
    v_cvt_pk_bf16_f32 v179, v142, v143
    v_add_f32 v72, v72, v142
    v_add_f32 v73, v73, v143
    s_add_u32 s29, s39, s42
    v_exp_f32 v146, v146
    v_exp_f32 v147, v147
    v_cvt_pk_bf16_f32 v180, v144, v145
    v_add_f32 v72, v72, v144
    v_add_f32 v73, v73, v145
    s_mov_b32 m0, s29
    s_nop 0
    buffer_load_dwordx4 v237, s[16:19], s37 offen offset:0 lds
    v_exp_f32 v148, v148
    v_exp_f32 v149, v149
    v_cvt_pk_bf16_f32 v181, v146, v147
    v_add_f32 v72, v72, v146
    v_add_f32 v73, v73, v147
    s_mov_b32 m0, s29
    s_nop 0
    buffer_load_dwordx4 v237, s[16:19], s37 offen offset:1024 lds
    v_exp_f32 v150, v150
    v_exp_f32 v151, v151
    v_cvt_pk_bf16_f32 v182, v148, v149
    v_add_f32 v72, v72, v148
    v_add_f32 v73, v73, v149
    s_add_u32 m0, s29, 8192
    s_nop 0
    buffer_load_dwordx4 v237, s[20:23], s37 offen offset:0 lds
    s_add_u32 m0, s29, 8192
    s_nop 0
    buffer_load_dwordx4 v237, s[20:23], s37 offen offset:1024 lds
    s_add_u32 s37, s37, 8192
    s_add_u32 s39, s39, 16384
    s_cmp_eq_u32 s39, 115712
    s_cselect_b32 s39, 66560, s39
    s_nop 0
    v_cvt_pk_bf16_f32 v183, v150, v151
    v_add_f32 v72, v72, v150
    v_add_f32 v73, v73, v151
    s_barrier
    v_exp_f32 v88, v88
    v_exp_f32 v89, v89
    v_mfma_f32_32x32x16_bf16 v[40:55], v[216:219], v[168:171], v[40:55]
    v_exp_f32 v90, v90
    v_exp_f32 v91, v91
    v_cvt_pk_bf16_f32 v152, v88, v89
    v_add_f32 v56, v56, v88
    v_add_f32 v57, v57, v89
    v_exp_f32 v92, v92
    v_exp_f32 v93, v93
    v_cvt_pk_bf16_f32 v153, v90, v91
    v_add_f32 v56, v56, v90
    v_add_f32 v57, v57, v91
    v_mfma_f32_32x32x16_bf16 v[40:55], v[220:223], v[172:175], v[40:55]
    v_exp_f32 v94, v94
    v_exp_f32 v95, v95
    v_cvt_pk_bf16_f32 v154, v92, v93
    v_add_f32 v56, v56, v92
    v_add_f32 v57, v57, v93
    v_exp_f32 v96, v96
    v_exp_f32 v97, v97
    v_cvt_pk_bf16_f32 v155, v94, v95
    v_add_f32 v56, v56, v94
    v_add_f32 v57, v57, v95
    v_mfma_f32_32x32x16_bf16 v[40:55], v[224:227], v[176:179], v[40:55]
    v_exp_f32 v98, v98
    v_exp_f32 v99, v99
    v_cvt_pk_bf16_f32 v156, v96, v97
    v_add_f32 v56, v56, v96
    v_add_f32 v57, v57, v97
    v_exp_f32 v100, v100
    v_exp_f32 v101, v101
    v_cvt_pk_bf16_f32 v157, v98, v99
    v_add_f32 v56, v56, v98
    v_add_f32 v57, v57, v99
    v_mfma_f32_32x32x16_bf16 v[40:55], v[228:231], v[180:183], v[40:55]
    v_exp_f32 v102, v102
    v_exp_f32 v103, v103
    v_cvt_pk_bf16_f32 v158, v100, v101
    v_add_f32 v56, v56, v100
    v_add_f32 v57, v57, v101
    v_exp_f32 v104, v104
    v_exp_f32 v105, v105
    v_cvt_pk_bf16_f32 v159, v102, v103
    v_add_f32 v56, v56, v102
    v_add_f32 v57, v57, v103
    v_mfma_f32_32x32x16_bf16 v[120:135], v[200:203], v[16:19], v[184:199]
    v_exp_f32 v106, v106
    v_exp_f32 v107, v107
    v_cvt_pk_bf16_f32 v160, v104, v105
    v_add_f32 v56, v56, v104
    v_add_f32 v57, v57, v105
    v_mfma_f32_32x32x16_bf16 v[120:135], v[204:207], v[20:23], v[120:135]
    v_exp_f32 v108, v108
    v_exp_f32 v109, v109
    v_cvt_pk_bf16_f32 v161, v106, v107
    v_add_f32 v56, v56, v106
    v_add_f32 v57, v57, v107
    v_mfma_f32_32x32x16_bf16 v[136:151], v[208:211], v[16:19], v[184:199]
    v_exp_f32 v110, v110
    v_exp_f32 v111, v111
    v_cvt_pk_bf16_f32 v162, v108, v109
    v_add_f32 v56, v56, v108
    v_add_f32 v57, v57, v109
    v_mfma_f32_32x32x16_bf16 v[136:151], v[212:215], v[20:23], v[136:151]
    v_exp_f32 v112, v112
    v_exp_f32 v113, v113
    v_cvt_pk_bf16_f32 v163, v110, v111
    v_add_f32 v56, v56, v110
    v_add_f32 v57, v57, v111
    ds_read_b128 v[216:219], v240 offset:12288
    ds_read_b128 v[220:223], v241 offset:12288
    ds_read_b128 v[224:227], v240 offset:14336
    ds_read_b128 v[228:231], v241 offset:14336
    ds_read_b128 v[200:203], v242 offset:0
    ds_read_b128 v[204:207], v243 offset:0
    ds_read_b128 v[208:211], v242 offset:2048
    ds_read_b128 v[212:215], v243 offset:2048
    v_exp_f32 v114, v114
    v_exp_f32 v115, v115
    v_cvt_pk_bf16_f32 v164, v112, v113
    v_add_f32 v56, v56, v112
    v_add_f32 v57, v57, v113
    v_exp_f32 v116, v116
    v_exp_f32 v117, v117
    v_cvt_pk_bf16_f32 v165, v114, v115
    v_add_f32 v56, v56, v114
    v_add_f32 v57, v57, v115
    v_exp_f32 v118, v118
    v_exp_f32 v119, v119
    v_cvt_pk_bf16_f32 v166, v116, v117
    v_add_f32 v56, v56, v116
    v_add_f32 v57, v57, v117
    s_nop 0
    v_cvt_pk_bf16_f32 v167, v118, v119
    v_add_f32 v56, v56, v118
    v_add_f32 v57, v57, v119
    s_waitcnt lgkmcnt(0)
    v_exp_f32 v120, v120
    v_exp_f32 v121, v121
    v_mfma_f32_32x32x16_bf16 v[24:39], v[216:219], v[152:155], v[24:39]
    v_exp_f32 v122, v122
    v_exp_f32 v123, v123
    v_cvt_pk_bf16_f32 v168, v120, v121
    v_add_f32 v72, v72, v120
    v_add_f32 v73, v73, v121
    v_exp_f32 v124, v124
    v_exp_f32 v125, v125
    v_cvt_pk_bf16_f32 v169, v122, v123
    v_add_f32 v72, v72, v122
    v_add_f32 v73, v73, v123
    v_mfma_f32_32x32x16_bf16 v[24:39], v[220:223], v[156:159], v[24:39]
    v_exp_f32 v126, v126
    v_exp_f32 v127, v127
    v_cvt_pk_bf16_f32 v170, v124, v125
    v_add_f32 v72, v72, v124
    v_add_f32 v73, v73, v125
    v_exp_f32 v128, v128
    v_exp_f32 v129, v129
    v_cvt_pk_bf16_f32 v171, v126, v127
    v_add_f32 v72, v72, v126
    v_add_f32 v73, v73, v127
    v_mfma_f32_32x32x16_bf16 v[24:39], v[224:227], v[160:163], v[24:39]
    v_exp_f32 v130, v130
    v_exp_f32 v131, v131
    v_cvt_pk_bf16_f32 v172, v128, v129
    v_add_f32 v72, v72, v128
    v_add_f32 v73, v73, v129
    v_exp_f32 v132, v132
    v_exp_f32 v133, v133
    v_cvt_pk_bf16_f32 v173, v130, v131
    v_add_f32 v72, v72, v130
    v_add_f32 v73, v73, v131
    v_mfma_f32_32x32x16_bf16 v[24:39], v[228:231], v[164:167], v[24:39]
    v_exp_f32 v134, v134
    v_exp_f32 v135, v135
    v_cvt_pk_bf16_f32 v174, v132, v133
    v_add_f32 v72, v72, v132
    v_add_f32 v73, v73, v133
    v_exp_f32 v136, v136
    v_exp_f32 v137, v137
    v_cvt_pk_bf16_f32 v175, v134, v135
    v_add_f32 v72, v72, v134
    v_add_f32 v73, v73, v135
    v_mfma_f32_32x32x16_bf16 v[88:103], v[200:203], v[8:11], v[184:199]
    v_exp_f32 v138, v138
    v_exp_f32 v139, v139
    v_cvt_pk_bf16_f32 v176, v136, v137
    v_add_f32 v72, v72, v136
    v_add_f32 v73, v73, v137
    v_mfma_f32_32x32x16_bf16 v[88:103], v[204:207], v[12:15], v[88:103]
    v_exp_f32 v140, v140
    v_exp_f32 v141, v141
    v_cvt_pk_bf16_f32 v177, v138, v139
    v_add_f32 v72, v72, v138
    v_add_f32 v73, v73, v139
    v_mfma_f32_32x32x16_bf16 v[104:119], v[208:211], v[8:11], v[184:199]
    v_exp_f32 v142, v142
    v_exp_f32 v143, v143
    v_cvt_pk_bf16_f32 v178, v140, v141
    v_add_f32 v72, v72, v140
    v_add_f32 v73, v73, v141
    v_mfma_f32_32x32x16_bf16 v[104:119], v[212:215], v[12:15], v[104:119]
    v_exp_f32 v144, v144
    v_exp_f32 v145, v145
    v_cvt_pk_bf16_f32 v179, v142, v143
    v_add_f32 v72, v72, v142
    v_add_f32 v73, v73, v143
    v_exp_f32 v146, v146
    v_exp_f32 v147, v147
    v_cvt_pk_bf16_f32 v180, v144, v145
    v_add_f32 v72, v72, v144
    v_add_f32 v73, v73, v145
    v_exp_f32 v148, v148
    v_exp_f32 v149, v149
    v_cvt_pk_bf16_f32 v181, v146, v147
    v_add_f32 v72, v72, v146
    v_add_f32 v73, v73, v147
    v_exp_f32 v150, v150
    v_exp_f32 v151, v151
    v_cvt_pk_bf16_f32 v182, v148, v149
    v_add_f32 v72, v72, v148
    v_add_f32 v73, v73, v149
    s_nop 0
    v_cvt_pk_bf16_f32 v183, v150, v151
    v_add_f32 v72, v72, v150
    v_add_f32 v73, v73, v151
    s_mov_b32 s40, s41
    s_add_u32 s41, s41, 16384
    s_cmp_eq_u32 s41, 115712
    s_cselect_b32 s41, 66560, s41
    v_add_u32 v240, s40, v238
    v_add_u32 v242, s41, v238
    v_add_u32 v241, s40, v239
    v_add_u32 v243, s41, v239
    s_add_u32 s36, s36, 1
    s_waitcnt vmcnt(0) lgkmcnt(0)
    s_barrier
L_attn_kernel_aloop_17:
    s_cmp_lg_u32 s36, 8
    s_cbranch_scc1 L_attn_kernel_pfsw_18
    s_mov_b32 s44, s8
    s_and_b32 s45, s9, 0xffff
    s_mov_b32 s46, 0x200000
    s_mov_b32 s47, 0x20000
    s_lshl_b32 s48, s2, 13
    s_lshl_b32 s29, s28, 10
    s_add_u32 s48, s48, s29
L_attn_kernel_pfsw_18:
    buffer_load_dwordx4 v[60:63], v64, s[44:47], s48 offen
    s_add_u32 s48, s48, 4096
    v_exp_f32 v88, v88
    v_exp_f32 v89, v89
    v_mfma_f32_32x32x16_bf16 v[40:55], v[216:219], v[168:171], v[40:55]
    v_exp_f32 v90, v90
    v_exp_f32 v91, v91
    v_cvt_pk_bf16_f32 v152, v88, v89
    v_add_f32 v56, v56, v88
    v_add_f32 v57, v57, v89
    v_exp_f32 v92, v92
    v_exp_f32 v93, v93
    v_cvt_pk_bf16_f32 v153, v90, v91
    v_add_f32 v56, v56, v90
    v_add_f32 v57, v57, v91
    v_mfma_f32_32x32x16_bf16 v[40:55], v[220:223], v[172:175], v[40:55]
    v_exp_f32 v94, v94
    v_exp_f32 v95, v95
    v_cvt_pk_bf16_f32 v154, v92, v93
    v_add_f32 v56, v56, v92
    v_add_f32 v57, v57, v93
    v_exp_f32 v96, v96
    v_exp_f32 v97, v97
    v_cvt_pk_bf16_f32 v155, v94, v95
    v_add_f32 v56, v56, v94
    v_add_f32 v57, v57, v95
    v_mfma_f32_32x32x16_bf16 v[40:55], v[224:227], v[176:179], v[40:55]
    v_exp_f32 v98, v98
    v_exp_f32 v99, v99
    v_cvt_pk_bf16_f32 v156, v96, v97
    v_add_f32 v56, v56, v96
    v_add_f32 v57, v57, v97
    v_exp_f32 v100, v100
    v_exp_f32 v101, v101
    v_cvt_pk_bf16_f32 v157, v98, v99
    v_add_f32 v56, v56, v98
    v_add_f32 v57, v57, v99
    v_mfma_f32_32x32x16_bf16 v[40:55], v[228:231], v[180:183], v[40:55]
    v_exp_f32 v102, v102
    v_exp_f32 v103, v103
    v_cvt_pk_bf16_f32 v158, v100, v101
    v_add_f32 v56, v56, v100
    v_add_f32 v57, v57, v101
    v_exp_f32 v104, v104
    v_exp_f32 v105, v105
    v_cvt_pk_bf16_f32 v159, v102, v103
    v_add_f32 v56, v56, v102
    v_add_f32 v57, v57, v103
    v_mfma_f32_32x32x16_bf16 v[120:135], v[200:203], v[16:19], v[184:199]
    v_exp_f32 v106, v106
    v_exp_f32 v107, v107
    v_cvt_pk_bf16_f32 v160, v104, v105
    v_add_f32 v56, v56, v104
    v_add_f32 v57, v57, v105
    v_mfma_f32_32x32x16_bf16 v[120:135], v[204:207], v[20:23], v[120:135]
    v_exp_f32 v108, v108
    v_exp_f32 v109, v109
    v_cvt_pk_bf16_f32 v161, v106, v107
    v_add_f32 v56, v56, v106
    v_add_f32 v57, v57, v107
    v_mfma_f32_32x32x16_bf16 v[136:151], v[208:211], v[16:19], v[184:199]
    v_exp_f32 v110, v110
    v_exp_f32 v111, v111
    v_cvt_pk_bf16_f32 v162, v108, v109
    v_add_f32 v56, v56, v108
    v_add_f32 v57, v57, v109
    v_mfma_f32_32x32x16_bf16 v[136:151], v[212:215], v[20:23], v[136:151]
    v_exp_f32 v112, v112
    v_exp_f32 v113, v113
    v_cvt_pk_bf16_f32 v163, v110, v111
    v_add_f32 v56, v56, v110
    v_add_f32 v57, v57, v111
    ds_read_b128 v[216:219], v240 offset:8192
    ds_read_b128 v[220:223], v241 offset:8192
    ds_read_b128 v[224:227], v240 offset:10240
    ds_read_b128 v[228:231], v241 offset:10240
    ds_read_b128 v[200:203], v240 offset:4096
    ds_read_b128 v[204:207], v241 offset:4096
    ds_read_b128 v[208:211], v240 offset:6144
    ds_read_b128 v[212:215], v241 offset:6144
    v_exp_f32 v114, v114
    v_exp_f32 v115, v115
    v_cvt_pk_bf16_f32 v164, v112, v113
    v_add_f32 v56, v56, v112
    v_add_f32 v57, v57, v113
    v_exp_f32 v116, v116
    v_exp_f32 v117, v117
    v_cvt_pk_bf16_f32 v165, v114, v115
    v_add_f32 v56, v56, v114
    v_add_f32 v57, v57, v115
    v_exp_f32 v118, v118
    v_exp_f32 v119, v119
    v_cvt_pk_bf16_f32 v166, v116, v117
    v_add_f32 v56, v56, v116
    v_add_f32 v57, v57, v117
    s_nop 0
    v_cvt_pk_bf16_f32 v167, v118, v119
    v_add_f32 v56, v56, v118
    v_add_f32 v57, v57, v119
    s_waitcnt lgkmcnt(0)
    v_exp_f32 v120, v120
    v_exp_f32 v121, v121
    v_mfma_f32_32x32x16_bf16 v[24:39], v[216:219], v[152:155], v[24:39]
    v_exp_f32 v122, v122
    v_exp_f32 v123, v123
    v_cvt_pk_bf16_f32 v168, v120, v121
    v_add_f32 v72, v72, v120
    v_add_f32 v73, v73, v121
    v_exp_f32 v124, v124
    v_exp_f32 v125, v125
    v_cvt_pk_bf16_f32 v169, v122, v123
    v_add_f32 v72, v72, v122
    v_add_f32 v73, v73, v123
    v_mfma_f32_32x32x16_bf16 v[24:39], v[220:223], v[156:159], v[24:39]
    v_exp_f32 v126, v126
    v_exp_f32 v127, v127
    v_cvt_pk_bf16_f32 v170, v124, v125
    v_add_f32 v72, v72, v124
    v_add_f32 v73, v73, v125
    v_exp_f32 v128, v128
    v_exp_f32 v129, v129
    v_cvt_pk_bf16_f32 v171, v126, v127
    v_add_f32 v72, v72, v126
    v_add_f32 v73, v73, v127
    v_mfma_f32_32x32x16_bf16 v[24:39], v[224:227], v[160:163], v[24:39]
    v_exp_f32 v130, v130
    v_exp_f32 v131, v131
    v_cvt_pk_bf16_f32 v172, v128, v129
    v_add_f32 v72, v72, v128
    v_add_f32 v73, v73, v129
    v_exp_f32 v132, v132
    v_exp_f32 v133, v133
    v_cvt_pk_bf16_f32 v173, v130, v131
    v_add_f32 v72, v72, v130
    v_add_f32 v73, v73, v131
    v_mfma_f32_32x32x16_bf16 v[24:39], v[228:231], v[164:167], v[24:39]
    v_exp_f32 v134, v134
    v_exp_f32 v135, v135
    v_cvt_pk_bf16_f32 v174, v132, v133
    v_add_f32 v72, v72, v132
    v_add_f32 v73, v73, v133
    v_exp_f32 v136, v136
    v_exp_f32 v137, v137
    v_cvt_pk_bf16_f32 v175, v134, v135
    v_add_f32 v72, v72, v134
    v_add_f32 v73, v73, v135
    v_mfma_f32_32x32x16_bf16 v[88:103], v[200:203], v[8:11], v[184:199]
    v_exp_f32 v138, v138
    v_exp_f32 v139, v139
    v_cvt_pk_bf16_f32 v176, v136, v137
    v_add_f32 v72, v72, v136
    v_add_f32 v73, v73, v137
    v_mfma_f32_32x32x16_bf16 v[88:103], v[204:207], v[12:15], v[88:103]
    v_exp_f32 v140, v140
    v_exp_f32 v141, v141
    v_cvt_pk_bf16_f32 v177, v138, v139
    v_add_f32 v72, v72, v138
    v_add_f32 v73, v73, v139
    v_mfma_f32_32x32x16_bf16 v[104:119], v[208:211], v[8:11], v[184:199]
    v_exp_f32 v142, v142
    v_exp_f32 v143, v143
    v_cvt_pk_bf16_f32 v178, v140, v141
    v_add_f32 v72, v72, v140
    v_add_f32 v73, v73, v141
    v_mfma_f32_32x32x16_bf16 v[104:119], v[212:215], v[12:15], v[104:119]
    v_exp_f32 v144, v144
    v_exp_f32 v145, v145
    v_cvt_pk_bf16_f32 v179, v142, v143
    v_add_f32 v72, v72, v142
    v_add_f32 v73, v73, v143
    s_add_u32 s29, s39, s42
    v_exp_f32 v146, v146
    v_exp_f32 v147, v147
    v_cvt_pk_bf16_f32 v180, v144, v145
    v_add_f32 v72, v72, v144
    v_add_f32 v73, v73, v145
    s_mov_b32 m0, s29
    s_nop 0
    buffer_load_dwordx4 v237, s[16:19], s37 offen offset:0 lds
    v_exp_f32 v148, v148
    v_exp_f32 v149, v149
    v_cvt_pk_bf16_f32 v181, v146, v147
    v_add_f32 v72, v72, v146
    v_add_f32 v73, v73, v147
    s_mov_b32 m0, s29
    s_nop 0
    buffer_load_dwordx4 v237, s[16:19], s37 offen offset:1024 lds
    v_exp_f32 v150, v150
    v_exp_f32 v151, v151
    v_cvt_pk_bf16_f32 v182, v148, v149
    v_add_f32 v72, v72, v148
    v_add_f32 v73, v73, v149
    s_add_u32 m0, s29, 8192
    s_nop 0
    buffer_load_dwordx4 v237, s[20:23], s37 offen offset:0 lds
    s_add_u32 m0, s29, 8192
    s_nop 0
    buffer_load_dwordx4 v237, s[20:23], s37 offen offset:1024 lds
    s_add_u32 s37, s37, 8192
    s_add_u32 s39, s39, 16384
    s_cmp_eq_u32 s39, 115712
    s_cselect_b32 s39, 66560, s39
    s_nop 0
    v_cvt_pk_bf16_f32 v183, v150, v151
    v_add_f32 v72, v72, v150
    v_add_f32 v73, v73, v151
    s_barrier
    v_exp_f32 v88, v88
    v_exp_f32 v89, v89
    v_mfma_f32_32x32x16_bf16 v[40:55], v[216:219], v[168:171], v[40:55]
    v_exp_f32 v90, v90
    v_exp_f32 v91, v91
    v_cvt_pk_bf16_f32 v152, v88, v89
    v_add_f32 v56, v56, v88
    v_add_f32 v57, v57, v89
    v_exp_f32 v92, v92
    v_exp_f32 v93, v93
    v_cvt_pk_bf16_f32 v153, v90, v91
    v_add_f32 v56, v56, v90
    v_add_f32 v57, v57, v91
    v_mfma_f32_32x32x16_bf16 v[40:55], v[220:223], v[172:175], v[40:55]
    v_exp_f32 v94, v94
    v_exp_f32 v95, v95
    v_cvt_pk_bf16_f32 v154, v92, v93
    v_add_f32 v56, v56, v92
    v_add_f32 v57, v57, v93
    v_exp_f32 v96, v96
    v_exp_f32 v97, v97
    v_cvt_pk_bf16_f32 v155, v94, v95
    v_add_f32 v56, v56, v94
    v_add_f32 v57, v57, v95
    v_mfma_f32_32x32x16_bf16 v[40:55], v[224:227], v[176:179], v[40:55]
    v_exp_f32 v98, v98
    v_exp_f32 v99, v99
    v_cvt_pk_bf16_f32 v156, v96, v97
    v_add_f32 v56, v56, v96
    v_add_f32 v57, v57, v97
    v_exp_f32 v100, v100
    v_exp_f32 v101, v101
    v_cvt_pk_bf16_f32 v157, v98, v99
    v_add_f32 v56, v56, v98
    v_add_f32 v57, v57, v99
    v_mfma_f32_32x32x16_bf16 v[40:55], v[228:231], v[180:183], v[40:55]
    v_exp_f32 v102, v102
    v_exp_f32 v103, v103
    v_cvt_pk_bf16_f32 v158, v100, v101
    v_add_f32 v56, v56, v100
    v_add_f32 v57, v57, v101
    v_exp_f32 v104, v104
    v_exp_f32 v105, v105
    v_cvt_pk_bf16_f32 v159, v102, v103
    v_add_f32 v56, v56, v102
    v_add_f32 v57, v57, v103
    v_mfma_f32_32x32x16_bf16 v[120:135], v[200:203], v[16:19], v[184:199]
    v_exp_f32 v106, v106
    v_exp_f32 v107, v107
    v_cvt_pk_bf16_f32 v160, v104, v105
    v_add_f32 v56, v56, v104
    v_add_f32 v57, v57, v105
    v_mfma_f32_32x32x16_bf16 v[120:135], v[204:207], v[20:23], v[120:135]
    v_exp_f32 v108, v108
    v_exp_f32 v109, v109
    v_cvt_pk_bf16_f32 v161, v106, v107
    v_add_f32 v56, v56, v106
    v_add_f32 v57, v57, v107
    v_mfma_f32_32x32x16_bf16 v[136:151], v[208:211], v[16:19], v[184:199]
    v_exp_f32 v110, v110
    v_exp_f32 v111, v111
    v_cvt_pk_bf16_f32 v162, v108, v109
    v_add_f32 v56, v56, v108
    v_add_f32 v57, v57, v109
    v_mfma_f32_32x32x16_bf16 v[136:151], v[212:215], v[20:23], v[136:151]
    v_exp_f32 v112, v112
    v_exp_f32 v113, v113
    v_cvt_pk_bf16_f32 v163, v110, v111
    v_add_f32 v56, v56, v110
    v_add_f32 v57, v57, v111
    ds_read_b128 v[216:219], v240 offset:12288
    ds_read_b128 v[220:223], v241 offset:12288
    ds_read_b128 v[224:227], v240 offset:14336
    ds_read_b128 v[228:231], v241 offset:14336
    ds_read_b128 v[200:203], v242 offset:0
    ds_read_b128 v[204:207], v243 offset:0
    ds_read_b128 v[208:211], v242 offset:2048
    ds_read_b128 v[212:215], v243 offset:2048
    v_exp_f32 v114, v114
    v_exp_f32 v115, v115
    v_cvt_pk_bf16_f32 v164, v112, v113
    v_add_f32 v56, v56, v112
    v_add_f32 v57, v57, v113
    v_exp_f32 v116, v116
    v_exp_f32 v117, v117
    v_cvt_pk_bf16_f32 v165, v114, v115
    v_add_f32 v56, v56, v114
    v_add_f32 v57, v57, v115
    v_exp_f32 v118, v118
    v_exp_f32 v119, v119
    v_cvt_pk_bf16_f32 v166, v116, v117
    v_add_f32 v56, v56, v116
    v_add_f32 v57, v57, v117
    s_nop 0
    v_cvt_pk_bf16_f32 v167, v118, v119
    v_add_f32 v56, v56, v118
    v_add_f32 v57, v57, v119
    s_waitcnt lgkmcnt(0)
    v_exp_f32 v120, v120
    v_exp_f32 v121, v121
    v_mfma_f32_32x32x16_bf16 v[24:39], v[216:219], v[152:155], v[24:39]
    v_exp_f32 v122, v122
    v_exp_f32 v123, v123
    v_cvt_pk_bf16_f32 v168, v120, v121
    v_add_f32 v72, v72, v120
    v_add_f32 v73, v73, v121
    v_exp_f32 v124, v124
    v_exp_f32 v125, v125
    v_cvt_pk_bf16_f32 v169, v122, v123
    v_add_f32 v72, v72, v122
    v_add_f32 v73, v73, v123
    v_mfma_f32_32x32x16_bf16 v[24:39], v[220:223], v[156:159], v[24:39]
    v_exp_f32 v126, v126
    v_exp_f32 v127, v127
    v_cvt_pk_bf16_f32 v170, v124, v125
    v_add_f32 v72, v72, v124
    v_add_f32 v73, v73, v125
    v_exp_f32 v128, v128
    v_exp_f32 v129, v129
    v_cvt_pk_bf16_f32 v171, v126, v127
    v_add_f32 v72, v72, v126
    v_add_f32 v73, v73, v127
    v_mfma_f32_32x32x16_bf16 v[24:39], v[224:227], v[160:163], v[24:39]
    v_exp_f32 v130, v130
    v_exp_f32 v131, v131
    v_cvt_pk_bf16_f32 v172, v128, v129
    v_add_f32 v72, v72, v128
    v_add_f32 v73, v73, v129
    v_exp_f32 v132, v132
    v_exp_f32 v133, v133
    v_cvt_pk_bf16_f32 v173, v130, v131
    v_add_f32 v72, v72, v130
    v_add_f32 v73, v73, v131
    v_mfma_f32_32x32x16_bf16 v[24:39], v[228:231], v[164:167], v[24:39]
    v_exp_f32 v134, v134
    v_exp_f32 v135, v135
    v_cvt_pk_bf16_f32 v174, v132, v133
    v_add_f32 v72, v72, v132
    v_add_f32 v73, v73, v133
    v_exp_f32 v136, v136
    v_exp_f32 v137, v137
    v_cvt_pk_bf16_f32 v175, v134, v135
    v_add_f32 v72, v72, v134
    v_add_f32 v73, v73, v135
    v_mfma_f32_32x32x16_bf16 v[88:103], v[200:203], v[8:11], v[184:199]
    v_exp_f32 v138, v138
    v_exp_f32 v139, v139
    v_cvt_pk_bf16_f32 v176, v136, v137
    v_add_f32 v72, v72, v136
    v_add_f32 v73, v73, v137
    v_mfma_f32_32x32x16_bf16 v[88:103], v[204:207], v[12:15], v[88:103]
    v_exp_f32 v140, v140
    v_exp_f32 v141, v141
    v_cvt_pk_bf16_f32 v177, v138, v139
    v_add_f32 v72, v72, v138
    v_add_f32 v73, v73, v139
    v_mfma_f32_32x32x16_bf16 v[104:119], v[208:211], v[8:11], v[184:199]
    v_exp_f32 v142, v142
    v_exp_f32 v143, v143
    v_cvt_pk_bf16_f32 v178, v140, v141
    v_add_f32 v72, v72, v140
    v_add_f32 v73, v73, v141
    v_mfma_f32_32x32x16_bf16 v[104:119], v[212:215], v[12:15], v[104:119]
    v_exp_f32 v144, v144
    v_exp_f32 v145, v145
    v_cvt_pk_bf16_f32 v179, v142, v143
    v_add_f32 v72, v72, v142
    v_add_f32 v73, v73, v143
    v_exp_f32 v146, v146
    v_exp_f32 v147, v147
    v_cvt_pk_bf16_f32 v180, v144, v145
    v_add_f32 v72, v72, v144
    v_add_f32 v73, v73, v145
    v_exp_f32 v148, v148
    v_exp_f32 v149, v149
    v_cvt_pk_bf16_f32 v181, v146, v147
    v_add_f32 v72, v72, v146
    v_add_f32 v73, v73, v147
    v_exp_f32 v150, v150
    v_exp_f32 v151, v151
    v_cvt_pk_bf16_f32 v182, v148, v149
    v_add_f32 v72, v72, v148
    v_add_f32 v73, v73, v149
    s_nop 0
    v_cvt_pk_bf16_f32 v183, v150, v151
    v_add_f32 v72, v72, v150
    v_add_f32 v73, v73, v151
    s_mov_b32 s40, s41
    s_add_u32 s41, s41, 16384
    s_cmp_eq_u32 s41, 115712
    s_cselect_b32 s41, 66560, s41
    v_add_u32 v240, s40, v238
    v_add_u32 v242, s41, v238
    v_add_u32 v241, s40, v239
    v_add_u32 v243, s41, v239
    s_add_u32 s36, s36, 1
    s_waitcnt vmcnt(0) lgkmcnt(0)
    s_barrier
    s_cmp_lt_u32 s36, 15
    s_cbranch_scc1 L_attn_kernel_aloop_17
    v_exp_f32 v88, v88
    v_exp_f32 v89, v89
    v_mfma_f32_32x32x16_bf16 v[40:55], v[216:219], v[168:171], v[40:55]
    v_exp_f32 v90, v90
    v_exp_f32 v91, v91
    v_cvt_pk_bf16_f32 v152, v88, v89
    v_add_f32 v56, v56, v88
    v_add_f32 v57, v57, v89
    v_exp_f32 v92, v92
    v_exp_f32 v93, v93
    v_cvt_pk_bf16_f32 v153, v90, v91
    v_add_f32 v56, v56, v90
    v_add_f32 v57, v57, v91
    v_mfma_f32_32x32x16_bf16 v[40:55], v[220:223], v[172:175], v[40:55]
    v_exp_f32 v94, v94
    v_exp_f32 v95, v95
    v_cvt_pk_bf16_f32 v154, v92, v93
    v_add_f32 v56, v56, v92
    v_add_f32 v57, v57, v93
    v_exp_f32 v96, v96
    v_exp_f32 v97, v97
    v_cvt_pk_bf16_f32 v155, v94, v95
    v_add_f32 v56, v56, v94
    v_add_f32 v57, v57, v95
    v_mfma_f32_32x32x16_bf16 v[40:55], v[224:227], v[176:179], v[40:55]
    v_exp_f32 v98, v98
    v_exp_f32 v99, v99
    v_cvt_pk_bf16_f32 v156, v96, v97
    v_add_f32 v56, v56, v96
    v_add_f32 v57, v57, v97
    v_exp_f32 v100, v100
    v_exp_f32 v101, v101
    v_cvt_pk_bf16_f32 v157, v98, v99
    v_add_f32 v56, v56, v98
    v_add_f32 v57, v57, v99
    v_mfma_f32_32x32x16_bf16 v[40:55], v[228:231], v[180:183], v[40:55]
    v_exp_f32 v102, v102
    v_exp_f32 v103, v103
    v_cvt_pk_bf16_f32 v158, v100, v101
    v_add_f32 v56, v56, v100
    v_add_f32 v57, v57, v101
    v_exp_f32 v104, v104
    v_exp_f32 v105, v105
    v_cvt_pk_bf16_f32 v159, v102, v103
    v_add_f32 v56, v56, v102
    v_add_f32 v57, v57, v103
    v_mfma_f32_32x32x16_bf16 v[120:135], v[200:203], v[16:19], v[184:199]
    v_exp_f32 v106, v106
    v_exp_f32 v107, v107
    v_cvt_pk_bf16_f32 v160, v104, v105
    v_add_f32 v56, v56, v104
    v_add_f32 v57, v57, v105
    v_mfma_f32_32x32x16_bf16 v[120:135], v[204:207], v[20:23], v[120:135]
    v_exp_f32 v108, v108
    v_exp_f32 v109, v109
    v_cvt_pk_bf16_f32 v161, v106, v107
    v_add_f32 v56, v56, v106
    v_add_f32 v57, v57, v107
    v_mfma_f32_32x32x16_bf16 v[136:151], v[208:211], v[16:19], v[184:199]
    v_exp_f32 v110, v110
    v_exp_f32 v111, v111
    v_cvt_pk_bf16_f32 v162, v108, v109
    v_add_f32 v56, v56, v108
    v_add_f32 v57, v57, v109
    v_mfma_f32_32x32x16_bf16 v[136:151], v[212:215], v[20:23], v[136:151]
    v_exp_f32 v112, v112
    v_exp_f32 v113, v113
    v_cvt_pk_bf16_f32 v163, v110, v111
    v_add_f32 v56, v56, v110
    v_add_f32 v57, v57, v111
    ds_read_b128 v[216:219], v240 offset:8192
    ds_read_b128 v[220:223], v241 offset:8192
    ds_read_b128 v[224:227], v240 offset:10240
    ds_read_b128 v[228:231], v241 offset:10240
    ds_read_b128 v[200:203], v240 offset:4096
    ds_read_b128 v[204:207], v241 offset:4096
    ds_read_b128 v[208:211], v240 offset:6144
    ds_read_b128 v[212:215], v241 offset:6144
    v_exp_f32 v114, v114
    v_exp_f32 v115, v115
    v_cvt_pk_bf16_f32 v164, v112, v113
    v_add_f32 v56, v56, v112
    v_add_f32 v57, v57, v113
    v_exp_f32 v116, v116
    v_exp_f32 v117, v117
    v_cvt_pk_bf16_f32 v165, v114, v115
    v_add_f32 v56, v56, v114
    v_add_f32 v57, v57, v115
    v_exp_f32 v118, v118
    v_exp_f32 v119, v119
    v_cvt_pk_bf16_f32 v166, v116, v117
    v_add_f32 v56, v56, v116
    v_add_f32 v57, v57, v117
    s_nop 0
    v_cvt_pk_bf16_f32 v167, v118, v119
    v_add_f32 v56, v56, v118
    v_add_f32 v57, v57, v119
    s_waitcnt lgkmcnt(0)
    v_exp_f32 v120, v120
    v_exp_f32 v121, v121
    v_mfma_f32_32x32x16_bf16 v[24:39], v[216:219], v[152:155], v[24:39]
    v_exp_f32 v122, v122
    v_exp_f32 v123, v123
    v_cvt_pk_bf16_f32 v168, v120, v121
    v_add_f32 v72, v72, v120
    v_add_f32 v73, v73, v121
    v_exp_f32 v124, v124
    v_exp_f32 v125, v125
    v_cvt_pk_bf16_f32 v169, v122, v123
    v_add_f32 v72, v72, v122
    v_add_f32 v73, v73, v123
    v_mfma_f32_32x32x16_bf16 v[24:39], v[220:223], v[156:159], v[24:39]
    v_exp_f32 v126, v126
    v_exp_f32 v127, v127
    v_cvt_pk_bf16_f32 v170, v124, v125
    v_add_f32 v72, v72, v124
    v_add_f32 v73, v73, v125
    v_exp_f32 v128, v128
    v_exp_f32 v129, v129
    v_cvt_pk_bf16_f32 v171, v126, v127
    v_add_f32 v72, v72, v126
    v_add_f32 v73, v73, v127
    v_mfma_f32_32x32x16_bf16 v[24:39], v[224:227], v[160:163], v[24:39]
    v_exp_f32 v130, v130
    v_exp_f32 v131, v131
    v_cvt_pk_bf16_f32 v172, v128, v129
    v_add_f32 v72, v72, v128
    v_add_f32 v73, v73, v129
    v_exp_f32 v132, v132
    v_exp_f32 v133, v133
    v_cvt_pk_bf16_f32 v173, v130, v131
    v_add_f32 v72, v72, v130
    v_add_f32 v73, v73, v131
    v_mfma_f32_32x32x16_bf16 v[24:39], v[228:231], v[164:167], v[24:39]
    v_exp_f32 v134, v134
    v_exp_f32 v135, v135
    v_cvt_pk_bf16_f32 v174, v132, v133
    v_add_f32 v72, v72, v132
    v_add_f32 v73, v73, v133
    v_exp_f32 v136, v136
    v_exp_f32 v137, v137
    v_cvt_pk_bf16_f32 v175, v134, v135
    v_add_f32 v72, v72, v134
    v_add_f32 v73, v73, v135
    v_mfma_f32_32x32x16_bf16 v[88:103], v[200:203], v[8:11], v[184:199]
    v_exp_f32 v138, v138
    v_exp_f32 v139, v139
    v_cvt_pk_bf16_f32 v176, v136, v137
    v_add_f32 v72, v72, v136
    v_add_f32 v73, v73, v137
    v_mfma_f32_32x32x16_bf16 v[88:103], v[204:207], v[12:15], v[88:103]
    v_exp_f32 v140, v140
    v_exp_f32 v141, v141
    v_cvt_pk_bf16_f32 v177, v138, v139
    v_add_f32 v72, v72, v138
    v_add_f32 v73, v73, v139
    v_mfma_f32_32x32x16_bf16 v[104:119], v[208:211], v[8:11], v[184:199]
    v_exp_f32 v142, v142
    v_exp_f32 v143, v143
    v_cvt_pk_bf16_f32 v178, v140, v141
    v_add_f32 v72, v72, v140
    v_add_f32 v73, v73, v141
    v_mfma_f32_32x32x16_bf16 v[104:119], v[212:215], v[12:15], v[104:119]
    v_exp_f32 v144, v144
    v_exp_f32 v145, v145
    v_cvt_pk_bf16_f32 v179, v142, v143
    v_add_f32 v72, v72, v142
    v_add_f32 v73, v73, v143
    v_exp_f32 v146, v146
    v_exp_f32 v147, v147
    v_cvt_pk_bf16_f32 v180, v144, v145
    v_add_f32 v72, v72, v144
    v_add_f32 v73, v73, v145
    v_exp_f32 v148, v148
    v_exp_f32 v149, v149
    v_cvt_pk_bf16_f32 v181, v146, v147
    v_add_f32 v72, v72, v146
    v_add_f32 v73, v73, v147
    v_exp_f32 v150, v150
    v_exp_f32 v151, v151
    v_cvt_pk_bf16_f32 v182, v148, v149
    v_add_f32 v72, v72, v148
    v_add_f32 v73, v73, v149
    s_nop 0
    v_cvt_pk_bf16_f32 v183, v150, v151
    v_add_f32 v72, v72, v150
    v_add_f32 v73, v73, v151
    s_barrier
    v_exp_f32 v88, v88
    v_exp_f32 v89, v89
    v_mfma_f32_32x32x16_bf16 v[40:55], v[216:219], v[168:171], v[40:55]
    v_exp_f32 v90, v90
    v_exp_f32 v91, v91
    v_cvt_pk_bf16_f32 v152, v88, v89
    v_add_f32 v56, v56, v88
    v_add_f32 v57, v57, v89
    v_exp_f32 v92, v92
    v_exp_f32 v93, v93
    v_cvt_pk_bf16_f32 v153, v90, v91
    v_add_f32 v56, v56, v90
    v_add_f32 v57, v57, v91
    v_mfma_f32_32x32x16_bf16 v[40:55], v[220:223], v[172:175], v[40:55]
    v_exp_f32 v94, v94
    v_exp_f32 v95, v95
    v_cvt_pk_bf16_f32 v154, v92, v93
    v_add_f32 v56, v56, v92
    v_add_f32 v57, v57, v93
    v_exp_f32 v96, v96
    v_exp_f32 v97, v97
    v_cvt_pk_bf16_f32 v155, v94, v95
    v_add_f32 v56, v56, v94
    v_add_f32 v57, v57, v95
    v_mfma_f32_32x32x16_bf16 v[40:55], v[224:227], v[176:179], v[40:55]
    v_exp_f32 v98, v98
    v_exp_f32 v99, v99
    v_cvt_pk_bf16_f32 v156, v96, v97
    v_add_f32 v56, v56, v96
    v_add_f32 v57, v57, v97
    v_exp_f32 v100, v100
    v_exp_f32 v101, v101
    v_cvt_pk_bf16_f32 v157, v98, v99
    v_add_f32 v56, v56, v98
    v_add_f32 v57, v57, v99
    v_mfma_f32_32x32x16_bf16 v[40:55], v[228:231], v[180:183], v[40:55]
    v_exp_f32 v102, v102
    v_exp_f32 v103, v103
    v_cvt_pk_bf16_f32 v158, v100, v101
    v_add_f32 v56, v56, v100
    v_add_f32 v57, v57, v101
    v_exp_f32 v104, v104
    v_exp_f32 v105, v105
    v_cvt_pk_bf16_f32 v159, v102, v103
    v_add_f32 v56, v56, v102
    v_add_f32 v57, v57, v103
    v_mfma_f32_32x32x16_bf16 v[120:135], v[200:203], v[16:19], v[184:199]
    v_exp_f32 v106, v106
    v_exp_f32 v107, v107
    v_cvt_pk_bf16_f32 v160, v104, v105
    v_add_f32 v56, v56, v104
    v_add_f32 v57, v57, v105
    v_mfma_f32_32x32x16_bf16 v[120:135], v[204:207], v[20:23], v[120:135]
    v_exp_f32 v108, v108
    v_exp_f32 v109, v109
    v_cvt_pk_bf16_f32 v161, v106, v107
    v_add_f32 v56, v56, v106
    v_add_f32 v57, v57, v107
    v_mfma_f32_32x32x16_bf16 v[136:151], v[208:211], v[16:19], v[184:199]
    v_exp_f32 v110, v110
    v_exp_f32 v111, v111
    v_cvt_pk_bf16_f32 v162, v108, v109
    v_add_f32 v56, v56, v108
    v_add_f32 v57, v57, v109
    v_mfma_f32_32x32x16_bf16 v[136:151], v[212:215], v[20:23], v[136:151]
    v_exp_f32 v112, v112
    v_exp_f32 v113, v113
    v_cvt_pk_bf16_f32 v163, v110, v111
    v_add_f32 v56, v56, v110
    v_add_f32 v57, v57, v111
    ds_read_b128 v[216:219], v240 offset:12288
    ds_read_b128 v[220:223], v241 offset:12288
    ds_read_b128 v[224:227], v240 offset:14336
    ds_read_b128 v[228:231], v241 offset:14336
    v_exp_f32 v114, v114
    v_exp_f32 v115, v115
    v_cvt_pk_bf16_f32 v164, v112, v113
    v_add_f32 v56, v56, v112
    v_add_f32 v57, v57, v113
    v_exp_f32 v116, v116
    v_exp_f32 v117, v117
    v_cvt_pk_bf16_f32 v165, v114, v115
    v_add_f32 v56, v56, v114
    v_add_f32 v57, v57, v115
    v_exp_f32 v118, v118
    v_exp_f32 v119, v119
    v_cvt_pk_bf16_f32 v166, v116, v117
    v_add_f32 v56, v56, v116
    v_add_f32 v57, v57, v117
    s_nop 0
    v_cvt_pk_bf16_f32 v167, v118, v119
    v_add_f32 v56, v56, v118
    v_add_f32 v57, v57, v119
    s_waitcnt lgkmcnt(0)
    v_exp_f32 v120, v120
    v_exp_f32 v121, v121
    v_mfma_f32_32x32x16_bf16 v[24:39], v[216:219], v[152:155], v[24:39]
    v_exp_f32 v122, v122
    v_exp_f32 v123, v123
    v_cvt_pk_bf16_f32 v168, v120, v121
    v_add_f32 v72, v72, v120
    v_add_f32 v73, v73, v121
    v_exp_f32 v124, v124
    v_exp_f32 v125, v125
    v_cvt_pk_bf16_f32 v169, v122, v123
    v_add_f32 v72, v72, v122
    v_add_f32 v73, v73, v123
    v_mfma_f32_32x32x16_bf16 v[24:39], v[220:223], v[156:159], v[24:39]
    v_exp_f32 v126, v126
    v_exp_f32 v127, v127
    v_cvt_pk_bf16_f32 v170, v124, v125
    v_add_f32 v72, v72, v124
    v_add_f32 v73, v73, v125
    v_exp_f32 v128, v128
    v_exp_f32 v129, v129
    v_cvt_pk_bf16_f32 v171, v126, v127
    v_add_f32 v72, v72, v126
    v_add_f32 v73, v73, v127
    v_mfma_f32_32x32x16_bf16 v[24:39], v[224:227], v[160:163], v[24:39]
    v_exp_f32 v130, v130
    v_exp_f32 v131, v131
    v_cvt_pk_bf16_f32 v172, v128, v129
    v_add_f32 v72, v72, v128
    v_add_f32 v73, v73, v129
    v_exp_f32 v132, v132
    v_exp_f32 v133, v133
    v_cvt_pk_bf16_f32 v173, v130, v131
    v_add_f32 v72, v72, v130
    v_add_f32 v73, v73, v131
    v_mfma_f32_32x32x16_bf16 v[24:39], v[228:231], v[164:167], v[24:39]
    v_exp_f32 v134, v134
    v_exp_f32 v135, v135
    v_cvt_pk_bf16_f32 v174, v132, v133
    v_add_f32 v72, v72, v132
    v_add_f32 v73, v73, v133
    v_exp_f32 v136, v136
    v_exp_f32 v137, v137
    v_cvt_pk_bf16_f32 v175, v134, v135
    v_add_f32 v72, v72, v134
    v_add_f32 v73, v73, v135
    v_exp_f32 v138, v138
    v_exp_f32 v139, v139
    v_cvt_pk_bf16_f32 v176, v136, v137
    v_add_f32 v72, v72, v136
    v_add_f32 v73, v73, v137
    v_exp_f32 v140, v140
    v_exp_f32 v141, v141
    v_cvt_pk_bf16_f32 v177, v138, v139
    v_add_f32 v72, v72, v138
    v_add_f32 v73, v73, v139
    v_exp_f32 v142, v142
    v_exp_f32 v143, v143
    v_cvt_pk_bf16_f32 v178, v140, v141
    v_add_f32 v72, v72, v140
    v_add_f32 v73, v73, v141
    v_exp_f32 v144, v144
    v_exp_f32 v145, v145
    v_cvt_pk_bf16_f32 v179, v142, v143
    v_add_f32 v72, v72, v142
    v_add_f32 v73, v73, v143
    v_exp_f32 v146, v146
    v_exp_f32 v147, v147
    v_cvt_pk_bf16_f32 v180, v144, v145
    v_add_f32 v72, v72, v144
    v_add_f32 v73, v73, v145
    v_exp_f32 v148, v148
    v_exp_f32 v149, v149
    v_cvt_pk_bf16_f32 v181, v146, v147
    v_add_f32 v72, v72, v146
    v_add_f32 v73, v73, v147
    v_exp_f32 v150, v150
    v_exp_f32 v151, v151
    v_cvt_pk_bf16_f32 v182, v148, v149
    v_add_f32 v72, v72, v148
    v_add_f32 v73, v73, v149
    s_nop 0
    v_cvt_pk_bf16_f32 v183, v150, v151
    v_add_f32 v72, v72, v150
    v_add_f32 v73, v73, v151
    s_barrier
    s_nop 1
    v_mfma_f32_32x32x16_bf16 v[40:55], v[216:219], v[168:171], v[40:55]
    v_mfma_f32_32x32x16_bf16 v[40:55], v[220:223], v[172:175], v[40:55]
    v_mfma_f32_32x32x16_bf16 v[40:55], v[224:227], v[176:179], v[40:55]
    v_mfma_f32_32x32x16_bf16 v[40:55], v[228:231], v[180:183], v[40:55]
    s_nop 15
    v_and_b32 v2, 31, v1
    v_add_u32 v2, s35, v2
    v_lshrrev_b32 v3, 7, v2
    v_lshlrev_b32 v237, 18, v3
    v_and_b32 v2, 127, v2
    v_lshl_add_u32 v237, v2, 7, v237
    v_lshrrev_b32 v3, 5, v1
    v_lshl_add_u32 v237, v3, 4, v237
    s_lshr_b32 s30, s34, 1
    s_lshl_b32 s30, s30, 14
    s_and_b32 s29, s34, 1
    s_lshl_b32 s29, s29, 6
    s_add_u32 s30, s30, s29
    s_add_u32 s29, s30, 0
    v_add_f32 v2, v56, v57
    v_mov_b32 v3, v2
    s_nop 1
    v_permlane32_swap_b32 v2, v3
    s_nop 1
    v_add_f32 v2, v2, v3
    v_mov_b32 v3, 0x71800000
    v_cmp_nlt_f32 vcc, v2, v3
    s_nop 1
    s_or_b32 s33, s33, vcc_lo
    s_or_b32 s33, s33, vcc_hi
    v_mov_b32 v3, 0x21800000
    v_cmp_ngt_f32 vcc, v2, v3
    s_nop 1
    s_or_b32 s33, s33, vcc_lo
    s_or_b32 s33, s33, vcc_hi
    v_rcp_f32 v2, v2
    s_nop 0
    v_mul_f32 v24, v24, v2
    v_mul_f32 v25, v25, v2
    v_mul_f32 v26, v26, v2
    v_mul_f32 v27, v27, v2
    v_mul_f32 v28, v28, v2
    v_mul_f32 v29, v29, v2
    v_mul_f32 v30, v30, v2
    v_mul_f32 v31, v31, v2
    v_mul_f32 v32, v32, v2
    v_mul_f32 v33, v33, v2
    v_mul_f32 v34, v34, v2
    v_mul_f32 v35, v35, v2
    v_mul_f32 v36, v36, v2
    v_mul_f32 v37, v37, v2
    v_mul_f32 v38, v38, v2
    v_mul_f32 v39, v39, v2
    v_cvt_pk_bf16_f32 v24, v24, v25
    v_cvt_pk_bf16_f32 v25, v26, v27
    v_cvt_pk_bf16_f32 v26, v28, v29
    v_cvt_pk_bf16_f32 v27, v30, v31
    v_cvt_pk_bf16_f32 v28, v32, v33
    v_cvt_pk_bf16_f32 v29, v34, v35
    v_cvt_pk_bf16_f32 v30, v36, v37
    v_cvt_pk_bf16_f32 v31, v38, v39
    s_nop 1
    v_permlane32_swap_b32 v24, v26
    v_permlane32_swap_b32 v25, v27
    v_permlane32_swap_b32 v28, v30
    v_permlane32_swap_b32 v29, v31
    s_nop 1
    buffer_store_dwordx4 v[24:27], v237, s[24:27], s29 offen offset:0
    buffer_store_dwordx4 v[28:31], v237, s[24:27], s29 offen offset:32
    s_nop 1
    s_add_u32 s29, s30, 64
    v_add_f32 v2, v72, v73
    v_mov_b32 v3, v2
    s_nop 1
    v_permlane32_swap_b32 v2, v3
    s_nop 1
    v_add_f32 v2, v2, v3
    v_mov_b32 v3, 0x71800000
    v_cmp_nlt_f32 vcc, v2, v3
    s_nop 1
    s_or_b32 s33, s33, vcc_lo
    s_or_b32 s33, s33, vcc_hi
    v_mov_b32 v3, 0x21800000
    v_cmp_ngt_f32 vcc, v2, v3
    s_nop 1
    s_or_b32 s33, s33, vcc_lo
    s_or_b32 s33, s33, vcc_hi
    v_rcp_f32 v2, v2
    s_nop 0
    v_mul_f32 v40, v40, v2
    v_mul_f32 v41, v41, v2
    v_mul_f32 v42, v42, v2
    v_mul_f32 v43, v43, v2
    v_mul_f32 v44, v44, v2
    v_mul_f32 v45, v45, v2
    v_mul_f32 v46, v46, v2
    v_mul_f32 v47, v47, v2
    v_mul_f32 v48, v48, v2
    v_mul_f32 v49, v49, v2
    v_mul_f32 v50, v50, v2
    v_mul_f32 v51, v51, v2
    v_mul_f32 v52, v52, v2
    v_mul_f32 v53, v53, v2
    v_mul_f32 v54, v54, v2
    v_mul_f32 v55, v55, v2
    v_cvt_pk_bf16_f32 v40, v40, v41
    v_cvt_pk_bf16_f32 v41, v42, v43
    v_cvt_pk_bf16_f32 v42, v44, v45
    v_cvt_pk_bf16_f32 v43, v46, v47
    v_cvt_pk_bf16_f32 v44, v48, v49
    v_cvt_pk_bf16_f32 v45, v50, v51
    v_cvt_pk_bf16_f32 v46, v52, v53
    v_cvt_pk_bf16_f32 v47, v54, v55
    s_nop 1
    v_permlane32_swap_b32 v40, v42
    v_permlane32_swap_b32 v41, v43
    v_permlane32_swap_b32 v44, v46
    v_permlane32_swap_b32 v45, v47
    s_nop 1
    buffer_store_dwordx4 v[40:43], v237, s[24:27], s29 offen offset:0
    buffer_store_dwordx4 v[44:47], v237, s[24:27], s29 offen offset:32
    s_nop 1
    s_branch L_attn_kernel_vote_2
L_attn_kernel_vote_2:
    s_barrier
    v_mov_b32 v2, s33
    s_lshl_b32 s29, s32, 2
    v_mov_b32 v3, s29
    ds_write_b32 v3, v2 offset:0
    s_waitcnt lgkmcnt(0)
    s_barrier
    v_and_b32 v3, 7, v1
    v_lshlrev_b32 v3, 2, v3
    ds_read_b32 v2, v3 offset:0
    s_waitcnt lgkmcnt(0)
    v_cmp_ne_u32 vcc, 0, v2
    s_barrier
    s_cbranch_vccz L_attn_kernel_end_1
    s_mov_b32 s31, 0
    s_cmp_ge_u32 s32, 4
    s_cbranch_scc1 L_attn_kernel_attnA_19
    s_mov_b32 s28, s32
    s_mov_b32 s12, s4
    s_and_b32 s13, s5, 0xffff
    s_mov_b32 s14, 0x1000000
    s_mov_b32 s15, 0x20000
    s_add_u32 s16, s4, 0x1000000
    s_addc_u32 s17, s5, 0
    s_and_b32 s17, s17, 0xffff
    s_mov_b32 s18, 0x1000000
    s_mov_b32 s19, 0x20000
    s_add_u32 s20, s4, 0x2000000
    s_addc_u32 s21, s5, 0
    s_and_b32 s21, s21, 0xffff
    s_mov_b32 s22, 0x1000000
    s_mov_b32 s23, 0x20000
    s_add_u32 s24, s4, 0x3000000
    s_addc_u32 s25, s5, 0
    s_and_b32 s25, s25, 0xffff
    s_mov_b32 s26, 0x1000000
    s_mov_b32 s27, 0x20000
    s_and_b32 s34, s2, 31
    s_lshr_b32 s35, s2, 5
    s_sub_u32 s35, 15, s35
    v_lshrrev_b32 v4, 5, v1
    v_lshlrev_b32 v235, 2, v4
    v_lshrrev_b32 v2, 4, v1
    v_lshlrev_b32 v2, 12, v2
    v_and_b32 v3, 15, v1
    v_lshl_add_u32 v2, v3, 4, v2
    s_lshl_b32 s29, s28, 10
    v_add_u32 v237, s29, v2
    v_lshrrev_b32 v2, 4, v1
    v_lshlrev_b32 v2, 4, v2
    v_bfe_u32 v3, v1, 3, 1
    v_lshl_add_u32 v2, v3, 6, v2
    s_lshl_b32 s29, s28, 2
    v_lshlrev_b32 v3, 3, v3
    v_add_u32 v3, s29, v3
    v_and_b32 v3, 15, v3
    v_add_u32 v2, v2, v3
    v_lshlrev_b32 v2, 7, v2
    v_and_b32 v3, 7, v1
    v_lshl_add_u32 v238, v3, 4, v2
    v_and_b32 v2, 15, v1
    v_mul_u32_u24 v3, 1040, v2
    v_bfe_u32 v4, v1, 4, 1
    v_lshlrev_b32 v4, 8, v4
    v_lshl_add_u32 v4, v235, 2, v4
    v_add_u32 v239, v3, v4
    v_add_u32 v2, 8, v2
    v_and_b32 v2, 15, v2
    v_mul_u32_u24 v3, 1040, v2
    v_add_u32 v3, 33408, v3
    v_add_u32 v240, v3, v4
    s_mul_i32 s41, s28, 4160
    s_lshl_b32 s36, s35, 7
    s_lshl_b32 s29, s28, 5
    s_add_u32 s36, s36, s29
    s_lshl_b32 s39, s34, 19
    s_mov_b32 s40, s39
    v_and_b32 v2, 31, v1
    v_add_u32 v2, s36, v2
    v_lshlrev_b32 v3, 8, v2
    v_lshl_add_u32 v3, v235, 2, v3
    buffer_load_dwordx4 v[8:11], v3, s[12:15], s39 offen offset:0
    buffer_load_dwordx4 v[12:15], v3, s[12:15], s39 offen offset:32
    buffer_load_dwordx4 v[16:19], v3, s[12:15], s39 offen offset:64
    buffer_load_dwordx4 v[20:23], v3, s[12:15], s39 offen offset:96
    buffer_load_dwordx4 v[24:27], v3, s[12:15], s39 offen offset:128
    buffer_load_dwordx4 v[28:31], v3, s[12:15], s39 offen offset:160
    buffer_load_dwordx4 v[32:35], v3, s[12:15], s39 offen offset:192
    buffer_load_dwordx4 v[36:39], v3, s[12:15], s39 offen offset:224
    s_add_u32 m0, s41, 0
    s_nop 0
    buffer_load_dwordx4 v237, s[16:19], s39 offen offset:0 lds
    s_add_u32 m0, s41, 784
    s_nop 0
    buffer_load_dwordx4 v237, s[16:19], s39 offen offset:256 lds
    s_add_u32 m0, s41, 1568
    s_nop 0
    buffer_load_dwordx4 v237, s[16:19], s39 offen offset:512 lds
    s_add_u32 m0, s41, 2352
    s_nop 0
    buffer_load_dwordx4 v237, s[16:19], s39 offen offset:768 lds
    s_add_u32 s39, s39, 16384
    s_add_u32 m0, s41, 16640
    s_nop 0
    buffer_load_dwordx4 v237, s[16:19], s39 offen offset:0 lds
    s_add_u32 m0, s41, 17424
    s_nop 0
    buffer_load_dwordx4 v237, s[16:19], s39 offen offset:256 lds
    s_add_u32 m0, s41, 18208
    s_nop 0
    buffer_load_dwordx4 v237, s[16:19], s39 offen offset:512 lds
    s_add_u32 m0, s41, 18992
    s_nop 0
    buffer_load_dwordx4 v237, s[16:19], s39 offen offset:768 lds
    s_add_u32 s39, s39, 16384
    s_add_u32 m0, s41, 33280
    s_nop 0
    buffer_load_dwordx4 v238, s[20:23], s40 offen offset:0 lds
    s_add_u32 m0, s41, 34192
    s_nop 0
    buffer_load_dwordx4 v238, s[20:23], s40 offen offset:128 lds
    s_add_u32 m0, s41, 35104
    s_nop 0
    buffer_load_dwordx4 v238, s[20:23], s40 offen offset:256 lds
    s_add_u32 m0, s41, 36016
    s_nop 0
    buffer_load_dwordx4 v238, s[20:23], s40 offen offset:384 lds
    s_add_u32 s40, s40, 16384
L_attn_kernel_btop_20:
    v_and_b32 v2, 31, v1
    v_add_u32 v234, s36, v2
    s_lshl_b32 s37, s35, 1
    s_add_u32 s37, s37, 2
    v_mov_b32 v40, 0
    v_mov_b32 v41, 0
    v_mov_b32 v42, 0
    v_mov_b32 v43, 0
    v_mov_b32 v44, 0
    v_mov_b32 v45, 0
    v_mov_b32 v46, 0
    v_mov_b32 v47, 0
    v_mov_b32 v48, 0
    v_mov_b32 v49, 0
    v_mov_b32 v50, 0
    v_mov_b32 v51, 0
    v_mov_b32 v52, 0
    v_mov_b32 v53, 0
    v_mov_b32 v54, 0
    v_mov_b32 v55, 0
    v_mov_b32 v56, 0
    v_mov_b32 v57, 0
    v_mov_b32 v58, 0
    v_mov_b32 v59, 0
    v_mov_b32 v60, 0
    v_mov_b32 v61, 0
    v_mov_b32 v62, 0
    v_mov_b32 v63, 0
    v_mov_b32 v64, 0
    v_mov_b32 v65, 0
    v_mov_b32 v66, 0
    v_mov_b32 v67, 0
    v_mov_b32 v68, 0
    v_mov_b32 v69, 0
    v_mov_b32 v70, 0
    v_mov_b32 v71, 0
    v_mov_b32 v72, 0
    v_mov_b32 v73, 0
    v_mov_b32 v74, 0
    v_mov_b32 v75, 0
    v_mov_b32 v76, 0
    v_mov_b32 v77, 0
    v_mov_b32 v78, 0
    v_mov_b32 v79, 0
    v_mov_b32 v80, 0
    v_mov_b32 v81, 0
    v_mov_b32 v82, 0
    v_mov_b32 v83, 0
    v_mov_b32 v84, 0
    v_mov_b32 v85, 0
    v_mov_b32 v86, 0
    v_mov_b32 v87, 0
    v_mov_b32 v88, 0
    v_mov_b32 v89, 0
    v_mov_b32 v90, 0
    v_mov_b32 v91, 0
    v_mov_b32 v92, 0
    v_mov_b32 v93, 0
    v_mov_b32 v94, 0
    v_mov_b32 v95, 0
    v_mov_b32 v96, 0
    v_mov_b32 v97, 0
    v_mov_b32 v98, 0
    v_mov_b32 v99, 0
    v_mov_b32 v100, 0
    v_mov_b32 v101, 0
    v_mov_b32 v102, 0
    v_mov_b32 v103, 0
    v_mov_b32 v232, 0
    v_mov_b32 v233, 0
    s_mov_b32 s38, 0
    s_waitcnt vmcnt(0)
    s_barrier
    ds_read_b128 v[200:203], v239 offset:0
    ds_read_b128 v[204:207], v239 offset:32
    ds_read_b128 v[208:211], v239 offset:64
    ds_read_b128 v[212:215], v239 offset:96
    ds_read_b128 v[216:219], v239 offset:128
    ds_read_b128 v[220:223], v239 offset:160
    ds_read_b128 v[224:227], v239 offset:192
    ds_read_b128 v[228:231], v239 offset:224
    s_waitcnt lgkmcnt(4)
    v_mfma_f32_32x32x16_bf16 v[104:119], v[200:203], v[8:11], 0
    v_mfma_f32_32x32x16_bf16 v[104:119], v[204:207], v[12:15], v[104:119]
    v_mfma_f32_32x32x16_bf16 v[104:119], v[208:211], v[16:19], v[104:119]
    v_mfma_f32_32x32x16_bf16 v[104:119], v[212:215], v[20:23], v[104:119]
    ds_read_b128 v[200:203], v239 offset:512
    ds_read_b128 v[204:207], v239 offset:544
    ds_read_b128 v[208:211], v239 offset:576
    ds_read_b128 v[212:215], v239 offset:608
    s_waitcnt lgkmcnt(4)
    v_mfma_f32_32x32x16_bf16 v[104:119], v[216:219], v[24:27], v[104:119]
    v_mfma_f32_32x32x16_bf16 v[104:119], v[220:223], v[28:31], v[104:119]
    v_mfma_f32_32x32x16_bf16 v[104:119], v[224:227], v[32:35], v[104:119]
    v_mfma_f32_32x32x16_bf16 v[104:119], v[228:231], v[36:39], v[104:119]
    ds_read_b128 v[216:219], v239 offset:640
    ds_read_b128 v[220:223], v239 offset:672
    ds_read_b128 v[224:227], v239 offset:704
    ds_read_b128 v[228:231], v239 offset:736
    s_waitcnt lgkmcnt(4)
    v_mfma_f32_32x32x16_bf16 v[120:135], v[200:203], v[8:11], 0
    v_mfma_f32_32x32x16_bf16 v[120:135], v[204:207], v[12:15], v[120:135]
    v_mfma_f32_32x32x16_bf16 v[120:135], v[208:211], v[16:19], v[120:135]
    v_mfma_f32_32x32x16_bf16 v[120:135], v[212:215], v[20:23], v[120:135]
    s_waitcnt lgkmcnt(0)
    v_mfma_f32_32x32x16_bf16 v[120:135], v[216:219], v[24:27], v[120:135]
    v_mfma_f32_32x32x16_bf16 v[120:135], v[220:223], v[28:31], v[120:135]
    v_mfma_f32_32x32x16_bf16 v[120:135], v[224:227], v[32:35], v[120:135]
    v_mfma_f32_32x32x16_bf16 v[120:135], v[228:231], v[36:39], v[120:135]
    s_nop 15
    s_cmp_lg_u32 s37, 2
    s_cbranch_scc1 L_attn_kernel_nm0_21
    s_mov_b32 s30, 0
    v_subrev_u32 v236, s30, v234
    v_sub_u32 v236, v236, v235
    v_mov_b32 v4, 0xff800000
    v_cmp_gt_i32 s[42:43], 0, v236
    v_cmp_gt_i32 s[44:45], 1, v236
    v_cmp_gt_i32 s[46:47], 2, v236
    v_cmp_gt_i32 s[48:49], 3, v236
    v_cndmask_b32 v104, v104, v4, s[42:43]
    v_cndmask_b32 v105, v105, v4, s[44:45]
    v_cndmask_b32 v106, v106, v4, s[46:47]
    v_cndmask_b32 v107, v107, v4, s[48:49]
    v_cmp_gt_i32 s[42:43], 8, v236
    v_cmp_gt_i32 s[44:45], 9, v236
    v_cmp_gt_i32 s[46:47], 10, v236
    v_cmp_gt_i32 s[48:49], 11, v236
    v_cndmask_b32 v108, v108, v4, s[42:43]
    v_cndmask_b32 v109, v109, v4, s[44:45]
    v_cndmask_b32 v110, v110, v4, s[46:47]
    v_cndmask_b32 v111, v111, v4, s[48:49]
    v_cmp_gt_i32 s[42:43], 16, v236
    v_cmp_gt_i32 s[44:45], 17, v236
    v_cmp_gt_i32 s[46:47], 18, v236
    v_cmp_gt_i32 s[48:49], 19, v236
    v_cndmask_b32 v112, v112, v4, s[42:43]
    v_cndmask_b32 v113, v113, v4, s[44:45]
    v_cndmask_b32 v114, v114, v4, s[46:47]
    v_cndmask_b32 v115, v115, v4, s[48:49]
    v_cmp_gt_i32 s[42:43], 24, v236
    v_cmp_gt_i32 s[44:45], 25, v236
    v_cmp_gt_i32 s[46:47], 26, v236
    v_cmp_gt_i32 s[48:49], 27, v236
    v_cndmask_b32 v116, v116, v4, s[42:43]
    v_cndmask_b32 v117, v117, v4, s[44:45]
    v_cndmask_b32 v118, v118, v4, s[46:47]
    v_cndmask_b32 v119, v119, v4, s[48:49]
    v_cmp_gt_i32 s[42:43], 32, v236
    v_cmp_gt_i32 s[44:45], 33, v236
    v_cmp_gt_i32 s[46:47], 34, v236
    v_cmp_gt_i32 s[48:49], 35, v236
    v_cndmask_b32 v120, v120, v4, s[42:43]
    v_cndmask_b32 v121, v121, v4, s[44:45]
    v_cndmask_b32 v122, v122, v4, s[46:47]
    v_cndmask_b32 v123, v123, v4, s[48:49]
    v_cmp_gt_i32 s[42:43], 40, v236
    v_cmp_gt_i32 s[44:45], 41, v236
    v_cmp_gt_i32 s[46:47], 42, v236
    v_cmp_gt_i32 s[48:49], 43, v236
    v_cndmask_b32 v124, v124, v4, s[42:43]
    v_cndmask_b32 v125, v125, v4, s[44:45]
    v_cndmask_b32 v126, v126, v4, s[46:47]
    v_cndmask_b32 v127, v127, v4, s[48:49]
    v_cmp_gt_i32 s[42:43], 48, v236
    v_cmp_gt_i32 s[44:45], 49, v236
    v_cmp_gt_i32 s[46:47], 50, v236
    v_cmp_gt_i32 s[48:49], 51, v236
    v_cndmask_b32 v128, v128, v4, s[42:43]
    v_cndmask_b32 v129, v129, v4, s[44:45]
    v_cndmask_b32 v130, v130, v4, s[46:47]
    v_cndmask_b32 v131, v131, v4, s[48:49]
    v_cmp_gt_i32 s[42:43], 56, v236
    v_cmp_gt_i32 s[44:45], 57, v236
    v_cmp_gt_i32 s[46:47], 58, v236
    v_cmp_gt_i32 s[48:49], 59, v236
    v_cndmask_b32 v132, v132, v4, s[42:43]
    v_cndmask_b32 v133, v133, v4, s[44:45]
    v_cndmask_b32 v134, v134, v4, s[46:47]
    v_cndmask_b32 v135, v135, v4, s[48:49]
L_attn_kernel_nm0_21:
    v_max3_f32 v2, v104, v105, v106
    v_max3_f32 v2, v2, v107, v108
    v_max3_f32 v2, v2, v109, v110
    v_max3_f32 v2, v2, v111, v112
    v_max3_f32 v2, v2, v113, v114
    v_max3_f32 v2, v2, v115, v116
    v_max3_f32 v2, v2, v117, v118
    v_max3_f32 v2, v2, v119, v120
    v_max3_f32 v2, v2, v121, v122
    v_max3_f32 v2, v2, v123, v124
    v_max3_f32 v2, v2, v125, v126
    v_max3_f32 v2, v2, v127, v128
    v_max3_f32 v2, v2, v129, v130
    v_max3_f32 v2, v2, v131, v132
    v_max3_f32 v2, v2, v133, v134
    v_max_f32 v2, v2, v135
    v_mov_b32 v3, v2
    s_nop 1
    v_permlane32_swap_b32 v2, v3
    s_nop 1
    v_max_f32 v2, v2, v3
    v_sub_f32 v104, v104, v2
    v_sub_f32 v105, v105, v2
    v_sub_f32 v106, v106, v2
    v_sub_f32 v107, v107, v2
    v_sub_f32 v108, v108, v2
    v_sub_f32 v109, v109, v2
    v_sub_f32 v110, v110, v2
    v_sub_f32 v111, v111, v2
    v_sub_f32 v112, v112, v2
    v_sub_f32 v113, v113, v2
    v_sub_f32 v114, v114, v2
    v_sub_f32 v115, v115, v2
    v_sub_f32 v116, v116, v2
    v_sub_f32 v117, v117, v2
    v_sub_f32 v118, v118, v2
    v_sub_f32 v119, v119, v2
    v_sub_f32 v120, v120, v2
    v_sub_f32 v121, v121, v2
    v_sub_f32 v122, v122, v2
    v_sub_f32 v123, v123, v2
    v_sub_f32 v124, v124, v2
    v_sub_f32 v125, v125, v2
    v_sub_f32 v126, v126, v2
    v_sub_f32 v127, v127, v2
    v_sub_f32 v128, v128, v2
    v_sub_f32 v129, v129, v2
    v_sub_f32 v130, v130, v2
    v_sub_f32 v131, v131, v2
    v_sub_f32 v132, v132, v2
    v_sub_f32 v133, v133, v2
    v_sub_f32 v134, v134, v2
    v_sub_f32 v135, v135, v2
    v_sub_f32 v3, 0, v2
    v_mov_b32 v184, v3
    v_mov_b32 v185, v3
    v_mov_b32 v186, v3
    v_mov_b32 v187, v3
    v_mov_b32 v188, v3
    v_mov_b32 v189, v3
    v_mov_b32 v190, v3
    v_mov_b32 v191, v3
    v_mov_b32 v192, v3
    v_mov_b32 v193, v3
    v_mov_b32 v194, v3
    v_mov_b32 v195, v3
    v_mov_b32 v196, v3
    v_mov_b32 v197, v3
    v_mov_b32 v198, v3
    v_mov_b32 v199, v3
    s_barrier
    s_cmp_eq_u32 s37, 2
    s_cbranch_scc1 L_attn_kernel_blast_23
L_attn_kernel_bloop_22:
    ds_read_b128 v[200:203], v239 offset:16640
    ds_read_b128 v[204:207], v239 offset:16672
    ds_read_b128 v[208:211], v239 offset:16704
    ds_read_b128 v[212:215], v239 offset:16736
    ds_read_b128 v[216:219], v239 offset:16768
    ds_read_b128 v[220:223], v239 offset:16800
    ds_read_b128 v[224:227], v239 offset:16832
    ds_read_b128 v[228:231], v239 offset:16864
    s_waitcnt lgkmcnt(4)
    v_mfma_f32_32x32x16_bf16 v[136:151], v[200:203], v[8:11], v[184:199]
    s_add_u32 m0, s41, 0
    s_nop 0
    buffer_load_dwordx4 v237, s[16:19], s39 offen offset:0 lds
    v_exp_f32 v104, v104
    v_exp_f32 v105, v105
    v_mfma_f32_32x32x16_bf16 v[136:151], v[204:207], v[12:15], v[136:151]
    s_add_u32 m0, s41, 784
    s_nop 0
    buffer_load_dwordx4 v237, s[16:19], s39 offen offset:256 lds
    v_exp_f32 v106, v106
    v_exp_f32 v107, v107
    v_cvt_pk_bf16_f32 v168, v104, v105
    v_mfma_f32_32x32x16_bf16 v[136:151], v[208:211], v[16:19], v[136:151]
    s_add_u32 m0, s41, 1568
    s_nop 0
    buffer_load_dwordx4 v237, s[16:19], s39 offen offset:512 lds
    v_exp_f32 v108, v108
    v_exp_f32 v109, v109
    v_cvt_pk_bf16_f32 v169, v106, v107
    v_mfma_f32_32x32x16_bf16 v[136:151], v[212:215], v[20:23], v[136:151]
    ds_read_b128 v[200:203], v239 offset:17152
    ds_read_b128 v[204:207], v239 offset:17184
    ds_read_b128 v[208:211], v239 offset:17216
    ds_read_b128 v[212:215], v239 offset:17248
    v_exp_f32 v110, v110
    v_exp_f32 v111, v111
    v_cvt_pk_bf16_f32 v170, v108, v109
    s_waitcnt lgkmcnt(4)
    v_mfma_f32_32x32x16_bf16 v[136:151], v[216:219], v[24:27], v[136:151]
    s_add_u32 m0, s41, 2352
    s_nop 0
    buffer_load_dwordx4 v237, s[16:19], s39 offen offset:768 lds
    s_add_u32 s39, s39, 16384
    v_exp_f32 v112, v112
    v_exp_f32 v113, v113
    v_cvt_pk_bf16_f32 v171, v110, v111
    v_mfma_f32_32x32x16_bf16 v[136:151], v[220:223], v[28:31], v[136:151]
    s_add_u32 m0, s41, 49920
    s_nop 0
    buffer_load_dwordx4 v238, s[20:23], s40 offen offset:0 lds
    v_exp_f32 v114, v114
    v_exp_f32 v115, v115
    v_cvt_pk_bf16_f32 v172, v112, v113
    v_mfma_f32_32x32x16_bf16 v[136:151], v[224:227], v[32:35], v[136:151]
    s_add_u32 m0, s41, 50832
    s_nop 0
    buffer_load_dwordx4 v238, s[20:23], s40 offen offset:128 lds
    v_exp_f32 v116, v116
    v_exp_f32 v117, v117
    v_cvt_pk_bf16_f32 v173, v114, v115
    v_mfma_f32_32x32x16_bf16 v[136:151], v[228:231], v[36:39], v[136:151]
    ds_read_b128 v[216:219], v239 offset:17280
    ds_read_b128 v[220:223], v239 offset:17312
    ds_read_b128 v[224:227], v239 offset:17344
    ds_read_b128 v[228:231], v239 offset:17376
    v_exp_f32 v118, v118
    v_exp_f32 v119, v119
    v_cvt_pk_bf16_f32 v174, v116, v117
    s_waitcnt lgkmcnt(4)
    v_mfma_f32_32x32x16_bf16 v[152:167], v[200:203], v[8:11], v[184:199]
    s_add_u32 m0, s41, 51744
    s_nop 0
    buffer_load_dwordx4 v238, s[20:23], s40 offen offset:256 lds
    v_exp_f32 v120, v120
    v_exp_f32 v121, v121
    v_cvt_pk_bf16_f32 v175, v118, v119
    v_mfma_f32_32x32x16_bf16 v[152:167], v[204:207], v[12:15], v[152:167]
    s_add_u32 m0, s41, 52656
    s_nop 0
    buffer_load_dwordx4 v238, s[20:23], s40 offen offset:384 lds
    s_add_u32 s40, s40, 16384
    v_exp_f32 v122, v122
    v_exp_f32 v123, v123
    v_cvt_pk_bf16_f32 v176, v120, v121
    v_mfma_f32_32x32x16_bf16 v[152:167], v[208:211], v[16:19], v[152:167]
    v_exp_f32 v124, v124
    v_exp_f32 v125, v125
    v_cvt_pk_bf16_f32 v177, v122, v123
    v_mfma_f32_32x32x16_bf16 v[152:167], v[212:215], v[20:23], v[152:167]
    v_exp_f32 v126, v126
    v_exp_f32 v127, v127
    v_cvt_pk_bf16_f32 v178, v124, v125
    s_waitcnt lgkmcnt(0)
    v_mfma_f32_32x32x16_bf16 v[152:167], v[216:219], v[24:27], v[152:167]
    v_exp_f32 v128, v128
    v_exp_f32 v129, v129
    v_cvt_pk_bf16_f32 v179, v126, v127
    v_mfma_f32_32x32x16_bf16 v[152:167], v[220:223], v[28:31], v[152:167]
    v_exp_f32 v130, v130
    v_exp_f32 v131, v131
    v_cvt_pk_bf16_f32 v180, v128, v129
    v_mfma_f32_32x32x16_bf16 v[152:167], v[224:227], v[32:35], v[152:167]
    v_exp_f32 v132, v132
    v_exp_f32 v133, v133
    v_cvt_pk_bf16_f32 v181, v130, v131
    v_mfma_f32_32x32x16_bf16 v[152:167], v[228:231], v[36:39], v[152:167]
    v_exp_f32 v134, v134
    v_exp_f32 v135, v135
    v_cvt_pk_bf16_f32 v182, v132, v133
    v_cvt_pk_bf16_f32 v183, v134, v135
    s_add_u32 s29, s38, 3
    s_cmp_ge_u32 s29, s37
    s_cbranch_scc1 L_attn_kernel_msk_24
    ds_read_b128 v[200:203], v239 offset:33280
    ds_read_b128 v[204:207], v239 offset:33792
    ds_read_b128 v[208:211], v240 offset:0
    ds_read_b128 v[212:215], v240 offset:512
    ds_read_b128 v[216:219], v239 offset:33312
    ds_read_b128 v[220:223], v239 offset:33824
    ds_read_b128 v[224:227], v240 offset:32
    ds_read_b128 v[228:231], v240 offset:544
    s_waitcnt lgkmcnt(4)
    v_mfma_f32_32x32x16_bf16 v[40:55], v[200:203], v[168:171], v[40:55]
    v_add_f32 v232, v232, v104
    v_add_f32 v233, v233, v105
    v_mfma_f32_32x32x16_bf16 v[56:71], v[204:207], v[168:171], v[56:71]
    v_add_f32 v232, v232, v106
    v_add_f32 v233, v233, v107
    v_mfma_f32_32x32x16_bf16 v[72:87], v[208:211], v[168:171], v[72:87]
    v_add_f32 v232, v232, v108
    v_add_f32 v233, v233, v109
    v_mfma_f32_32x32x16_bf16 v[88:103], v[212:215], v[168:171], v[88:103]
    ds_read_b128 v[200:203], v239 offset:33344
    ds_read_b128 v[204:207], v239 offset:33856
    ds_read_b128 v[208:211], v240 offset:64
    ds_read_b128 v[212:215], v240 offset:576
    v_add_f32 v232, v232, v110
    v_add_f32 v233, v233, v111
    s_waitcnt lgkmcnt(4)
    v_mfma_f32_32x32x16_bf16 v[40:55], v[216:219], v[172:175], v[40:55]
    v_add_f32 v232, v232, v112
    v_add_f32 v233, v233, v113
    v_max3_f32 v2, v136, v137, v138
    v_max3_f32 v2, v2, v139, v140
    v_mfma_f32_32x32x16_bf16 v[56:71], v[220:223], v[172:175], v[56:71]
    v_add_f32 v232, v232, v114
    v_add_f32 v233, v233, v115
    v_max3_f32 v2, v2, v141, v142
    v_max3_f32 v2, v2, v143, v144
    v_mfma_f32_32x32x16_bf16 v[72:87], v[224:227], v[172:175], v[72:87]
    v_add_f32 v232, v232, v116
    v_add_f32 v233, v233, v117
    v_max3_f32 v2, v2, v145, v146
    v_max3_f32 v2, v2, v147, v148
    v_mfma_f32_32x32x16_bf16 v[88:103], v[228:231], v[172:175], v[88:103]
    ds_read_b128 v[216:219], v239 offset:33376
    ds_read_b128 v[220:223], v239 offset:33888
    ds_read_b128 v[224:227], v240 offset:96
    ds_read_b128 v[228:231], v240 offset:608
    v_add_f32 v232, v232, v118
    v_add_f32 v233, v233, v119
    v_max3_f32 v2, v2, v149, v150
    v_max3_f32 v2, v2, v151, v152
    s_waitcnt lgkmcnt(4)
    v_mfma_f32_32x32x16_bf16 v[40:55], v[200:203], v[176:179], v[40:55]
    v_add_f32 v232, v232, v120
    v_add_f32 v233, v233, v121
    v_max3_f32 v2, v2, v153, v154
    v_mfma_f32_32x32x16_bf16 v[56:71], v[204:207], v[176:179], v[56:71]
    v_add_f32 v232, v232, v122
    v_add_f32 v233, v233, v123
    v_max3_f32 v2, v2, v155, v156
    v_mfma_f32_32x32x16_bf16 v[72:87], v[208:211], v[176:179], v[72:87]
    v_add_f32 v232, v232, v124
    v_add_f32 v233, v233, v125
    v_max3_f32 v2, v2, v157, v158
    v_mfma_f32_32x32x16_bf16 v[88:103], v[212:215], v[176:179], v[88:103]
    v_add_f32 v232, v232, v126
    v_add_f32 v233, v233, v127
    v_max3_f32 v2, v2, v159, v160
    s_waitcnt lgkmcnt(0)
    v_mfma_f32_32x32x16_bf16 v[40:55], v[216:219], v[180:183], v[40:55]
    v_add_f32 v232, v232, v128
    v_add_f32 v233, v233, v129
    v_max3_f32 v2, v2, v161, v162
    v_mfma_f32_32x32x16_bf16 v[56:71], v[220:223], v[180:183], v[56:71]
    v_add_f32 v232, v232, v130
    v_add_f32 v233, v233, v131
    v_max3_f32 v2, v2, v163, v164
    v_mfma_f32_32x32x16_bf16 v[72:87], v[224:227], v[180:183], v[72:87]
    v_add_f32 v232, v232, v132
    v_add_f32 v233, v233, v133
    v_max3_f32 v2, v2, v165, v166
    v_mfma_f32_32x32x16_bf16 v[88:103], v[228:231], v[180:183], v[88:103]
    v_add_f32 v232, v232, v134
    v_add_f32 v233, v233, v135
    v_max_f32 v2, v2, v167
    s_branch L_attn_kernel_join_25
L_attn_kernel_msk_24:
    s_lshl_b32 s30, s38, 6
    s_add_u32 s30, s30, 64
    ds_read_b128 v[200:203], v239 offset:33280
    ds_read_b128 v[204:207], v239 offset:33792
    ds_read_b128 v[208:211], v240 offset:0
    ds_read_b128 v[212:215], v240 offset:512
    ds_read_b128 v[216:219], v239 offset:33312
    ds_read_b128 v[220:223], v239 offset:33824
    ds_read_b128 v[224:227], v240 offset:32
    ds_read_b128 v[228:231], v240 offset:544
    s_waitcnt lgkmcnt(4)
    v_mfma_f32_32x32x16_bf16 v[40:55], v[200:203], v[168:171], v[40:55]
    v_add_f32 v232, v232, v104
    v_add_f32 v233, v233, v105
    v_mfma_f32_32x32x16_bf16 v[56:71], v[204:207], v[168:171], v[56:71]
    v_add_f32 v232, v232, v106
    v_add_f32 v233, v233, v107
    v_mfma_f32_32x32x16_bf16 v[72:87], v[208:211], v[168:171], v[72:87]
    v_add_f32 v232, v232, v108
    v_add_f32 v233, v233, v109
    v_mfma_f32_32x32x16_bf16 v[88:103], v[212:215], v[168:171], v[88:103]
    ds_read_b128 v[200:203], v239 offset:33344
    ds_read_b128 v[204:207], v239 offset:33856
    ds_read_b128 v[208:211], v240 offset:64
    ds_read_b128 v[212:215], v240 offset:576
    v_add_f32 v232, v232, v110
    v_add_f32 v233, v233, v111
    s_waitcnt lgkmcnt(4)
    v_mfma_f32_32x32x16_bf16 v[40:55], v[216:219], v[172:175], v[40:55]
    v_add_f32 v232, v232, v112
    v_add_f32 v233, v233, v113
    v_mfma_f32_32x32x16_bf16 v[56:71], v[220:223], v[172:175], v[56:71]
    v_add_f32 v232, v232, v114
    v_add_f32 v233, v233, v115
    v_mfma_f32_32x32x16_bf16 v[72:87], v[224:227], v[172:175], v[72:87]
    v_add_f32 v232, v232, v116
    v_add_f32 v233, v233, v117
    v_subrev_u32 v236, s30, v234
    v_sub_u32 v236, v236, v235
    v_mov_b32 v4, 0xff800000
    v_cmp_gt_i32 s[42:43], 0, v236
    v_cmp_gt_i32 s[44:45], 1, v236
    v_cmp_gt_i32 s[46:47], 2, v236
    v_cmp_gt_i32 s[48:49], 3, v236
    v_cndmask_b32 v136, v136, v4, s[42:43]
    v_cndmask_b32 v137, v137, v4, s[44:45]
    v_cndmask_b32 v138, v138, v4, s[46:47]
    v_cndmask_b32 v139, v139, v4, s[48:49]
    v_cmp_gt_i32 s[42:43], 8, v236
    v_cmp_gt_i32 s[44:45], 9, v236
    v_cmp_gt_i32 s[46:47], 10, v236
    v_cmp_gt_i32 s[48:49], 11, v236
    v_cndmask_b32 v140, v140, v4, s[42:43]
    v_cndmask_b32 v141, v141, v4, s[44:45]
    v_cndmask_b32 v142, v142, v4, s[46:47]
    v_cndmask_b32 v143, v143, v4, s[48:49]
    v_cmp_gt_i32 s[42:43], 16, v236
    v_cmp_gt_i32 s[44:45], 17, v236
    v_cmp_gt_i32 s[46:47], 18, v236
    v_cmp_gt_i32 s[48:49], 19, v236
    v_cndmask_b32 v144, v144, v4, s[42:43]
    v_cndmask_b32 v145, v145, v4, s[44:45]
    v_cndmask_b32 v146, v146, v4, s[46:47]
    v_cndmask_b32 v147, v147, v4, s[48:49]
    v_cmp_gt_i32 s[42:43], 24, v236
    v_cmp_gt_i32 s[44:45], 25, v236
    v_cmp_gt_i32 s[46:47], 26, v236
    v_cmp_gt_i32 s[48:49], 27, v236
    v_cndmask_b32 v148, v148, v4, s[42:43]
    v_cndmask_b32 v149, v149, v4, s[44:45]
    v_cndmask_b32 v150, v150, v4, s[46:47]
    v_cndmask_b32 v151, v151, v4, s[48:49]
    v_cmp_gt_i32 s[42:43], 32, v236
    v_cmp_gt_i32 s[44:45], 33, v236
    v_cmp_gt_i32 s[46:47], 34, v236
    v_cmp_gt_i32 s[48:49], 35, v236
    v_cndmask_b32 v152, v152, v4, s[42:43]
    v_cndmask_b32 v153, v153, v4, s[44:45]
    v_cndmask_b32 v154, v154, v4, s[46:47]
    v_cndmask_b32 v155, v155, v4, s[48:49]
    v_cmp_gt_i32 s[42:43], 40, v236
    v_cmp_gt_i32 s[44:45], 41, v236
    v_cmp_gt_i32 s[46:47], 42, v236
    v_cmp_gt_i32 s[48:49], 43, v236
    v_cndmask_b32 v156, v156, v4, s[42:43]
    v_cndmask_b32 v157, v157, v4, s[44:45]
    v_cndmask_b32 v158, v158, v4, s[46:47]
    v_cndmask_b32 v159, v159, v4, s[48:49]
    v_cmp_gt_i32 s[42:43], 48, v236
    v_cmp_gt_i32 s[44:45], 49, v236
    v_cmp_gt_i32 s[46:47], 50, v236
    v_cmp_gt_i32 s[48:49], 51, v236
    v_cndmask_b32 v160, v160, v4, s[42:43]
    v_cndmask_b32 v161, v161, v4, s[44:45]
    v_cndmask_b32 v162, v162, v4, s[46:47]
    v_cndmask_b32 v163, v163, v4, s[48:49]
    v_cmp_gt_i32 s[42:43], 56, v236
    v_cmp_gt_i32 s[44:45], 57, v236
    v_cmp_gt_i32 s[46:47], 58, v236
    v_cmp_gt_i32 s[48:49], 59, v236
    v_cndmask_b32 v164, v164, v4, s[42:43]
    v_cndmask_b32 v165, v165, v4, s[44:45]
    v_cndmask_b32 v166, v166, v4, s[46:47]
    v_cndmask_b32 v167, v167, v4, s[48:49]
    v_mfma_f32_32x32x16_bf16 v[88:103], v[228:231], v[172:175], v[88:103]
    ds_read_b128 v[216:219], v239 offset:33376
    ds_read_b128 v[220:223], v239 offset:33888
    ds_read_b128 v[224:227], v240 offset:96
    ds_read_b128 v[228:231], v240 offset:608
    v_add_f32 v232, v232, v118
    v_add_f32 v233, v233, v119
    v_max3_f32 v2, v136, v137, v138
    v_max3_f32 v2, v2, v139, v140
    s_waitcnt lgkmcnt(4)
    v_mfma_f32_32x32x16_bf16 v[40:55], v[200:203], v[176:179], v[40:55]
    v_add_f32 v232, v232, v120
    v_add_f32 v233, v233, v121
    v_max3_f32 v2, v2, v141, v142
    v_max3_f32 v2, v2, v143, v144
    v_mfma_f32_32x32x16_bf16 v[56:71], v[204:207], v[176:179], v[56:71]
    v_add_f32 v232, v232, v122
    v_add_f32 v233, v233, v123
    v_max3_f32 v2, v2, v145, v146
    v_max3_f32 v2, v2, v147, v148
    v_mfma_f32_32x32x16_bf16 v[72:87], v[208:211], v[176:179], v[72:87]
    v_add_f32 v232, v232, v124
    v_add_f32 v233, v233, v125
    v_max3_f32 v2, v2, v149, v150
    v_max3_f32 v2, v2, v151, v152
    v_mfma_f32_32x32x16_bf16 v[88:103], v[212:215], v[176:179], v[88:103]
    v_add_f32 v232, v232, v126
    v_add_f32 v233, v233, v127
    v_max3_f32 v2, v2, v153, v154
    v_max3_f32 v2, v2, v155, v156
    s_waitcnt lgkmcnt(0)
    v_mfma_f32_32x32x16_bf16 v[40:55], v[216:219], v[180:183], v[40:55]
    v_add_f32 v232, v232, v128
    v_add_f32 v233, v233, v129
    v_max3_f32 v2, v2, v157, v158
    v_max3_f32 v2, v2, v159, v160
    v_mfma_f32_32x32x16_bf16 v[56:71], v[220:223], v[180:183], v[56:71]
    v_add_f32 v232, v232, v130
    v_add_f32 v233, v233, v131
    v_max3_f32 v2, v2, v161, v162
    v_max3_f32 v2, v2, v163, v164
    v_mfma_f32_32x32x16_bf16 v[72:87], v[224:227], v[180:183], v[72:87]
    v_add_f32 v232, v232, v132
    v_add_f32 v233, v233, v133
    v_max3_f32 v2, v2, v165, v166
    v_max_f32 v2, v2, v167
    v_mfma_f32_32x32x16_bf16 v[88:103], v[228:231], v[180:183], v[88:103]
    v_add_f32 v232, v232, v134
    v_add_f32 v233, v233, v135
L_attn_kernel_join_25:
    v_mov_b32 v3, v2
    s_nop 1
    v_permlane32_swap_b32 v2, v3
    s_nop 1
    v_max_f32 v2, v2, v3
    v_cmp_lt_f32 vcc, 0x42000000, v2
    s_cbranch_vccz L_attn_kernel_nors_26
    v_max_f32 v2, 0, v2
    v_sub_f32 v3, 0, v2
    v_exp_f32 v3, v3
    v_sub_f32 v136, v136, v2
    v_sub_f32 v137, v137, v2
    v_sub_f32 v138, v138, v2
    v_sub_f32 v139, v139, v2
    v_sub_f32 v140, v140, v2
    v_sub_f32 v141, v141, v2
    v_sub_f32 v142, v142, v2
    v_sub_f32 v143, v143, v2
    v_sub_f32 v144, v144, v2
    v_sub_f32 v145, v145, v2
    v_sub_f32 v146, v146, v2
    v_sub_f32 v147, v147, v2
    v_sub_f32 v148, v148, v2
    v_sub_f32 v149, v149, v2
    v_sub_f32 v150, v150, v2
    v_sub_f32 v151, v151, v2
    v_sub_f32 v152, v152, v2
    v_sub_f32 v153, v153, v2
    v_sub_f32 v154, v154, v2
    v_sub_f32 v155, v155, v2
    v_sub_f32 v156, v156, v2
    v_sub_f32 v157, v157, v2
    v_sub_f32 v158, v158, v2
    v_sub_f32 v159, v159, v2
    v_sub_f32 v160, v160, v2
    v_sub_f32 v161, v161, v2
    v_sub_f32 v162, v162, v2
    v_sub_f32 v163, v163, v2
    v_sub_f32 v164, v164, v2
    v_sub_f32 v165, v165, v2
    v_sub_f32 v166, v166, v2
    v_sub_f32 v167, v167, v2
    v_sub_f32 v184, v184, v2
    v_sub_f32 v185, v185, v2
    v_sub_f32 v186, v186, v2
    v_sub_f32 v187, v187, v2
    v_sub_f32 v188, v188, v2
    v_sub_f32 v189, v189, v2
    v_sub_f32 v190, v190, v2
    v_sub_f32 v191, v191, v2
    v_sub_f32 v192, v192, v2
    v_sub_f32 v193, v193, v2
    v_sub_f32 v194, v194, v2
    v_sub_f32 v195, v195, v2
    v_sub_f32 v196, v196, v2
    v_sub_f32 v197, v197, v2
    v_sub_f32 v198, v198, v2
    v_sub_f32 v199, v199, v2
    s_nop 7
    v_mul_f32 v232, v232, v3
    v_mul_f32 v233, v233, v3
    v_mul_f32 v40, v40, v3
    v_mul_f32 v41, v41, v3
    v_mul_f32 v42, v42, v3
    v_mul_f32 v43, v43, v3
    v_mul_f32 v44, v44, v3
    v_mul_f32 v45, v45, v3
    v_mul_f32 v46, v46, v3
    v_mul_f32 v47, v47, v3
    v_mul_f32 v48, v48, v3
    v_mul_f32 v49, v49, v3
    v_mul_f32 v50, v50, v3
    v_mul_f32 v51, v51, v3
    v_mul_f32 v52, v52, v3
    v_mul_f32 v53, v53, v3
    v_mul_f32 v54, v54, v3
    v_mul_f32 v55, v55, v3
    v_mul_f32 v56, v56, v3
    v_mul_f32 v57, v57, v3
    v_mul_f32 v58, v58, v3
    v_mul_f32 v59, v59, v3
    v_mul_f32 v60, v60, v3
    v_mul_f32 v61, v61, v3
    v_mul_f32 v62, v62, v3
    v_mul_f32 v63, v63, v3
    v_mul_f32 v64, v64, v3
    v_mul_f32 v65, v65, v3
    v_mul_f32 v66, v66, v3
    v_mul_f32 v67, v67, v3
    v_mul_f32 v68, v68, v3
    v_mul_f32 v69, v69, v3
    v_mul_f32 v70, v70, v3
    v_mul_f32 v71, v71, v3
    v_mul_f32 v72, v72, v3
    v_mul_f32 v73, v73, v3
    v_mul_f32 v74, v74, v3
    v_mul_f32 v75, v75, v3
    v_mul_f32 v76, v76, v3
    v_mul_f32 v77, v77, v3
    v_mul_f32 v78, v78, v3
    v_mul_f32 v79, v79, v3
    v_mul_f32 v80, v80, v3
    v_mul_f32 v81, v81, v3
    v_mul_f32 v82, v82, v3
    v_mul_f32 v83, v83, v3
    v_mul_f32 v84, v84, v3
    v_mul_f32 v85, v85, v3
    v_mul_f32 v86, v86, v3
    v_mul_f32 v87, v87, v3
    v_mul_f32 v88, v88, v3
    v_mul_f32 v89, v89, v3
    v_mul_f32 v90, v90, v3
    v_mul_f32 v91, v91, v3
    v_mul_f32 v92, v92, v3
    v_mul_f32 v93, v93, v3
    v_mul_f32 v94, v94, v3
    v_mul_f32 v95, v95, v3
    v_mul_f32 v96, v96, v3
    v_mul_f32 v97, v97, v3
    v_mul_f32 v98, v98, v3
    v_mul_f32 v99, v99, v3
    v_mul_f32 v100, v100, v3
    v_mul_f32 v101, v101, v3
    v_mul_f32 v102, v102, v3
    v_mul_f32 v103, v103, v3
    s_nop 1
L_attn_kernel_nors_26:
    s_add_u32 s38, s38, 1
    s_waitcnt vmcnt(0)
    s_barrier
    ds_read_b128 v[200:203], v239 offset:0
    ds_read_b128 v[204:207], v239 offset:32
    ds_read_b128 v[208:211], v239 offset:64
    ds_read_b128 v[212:215], v239 offset:96
    ds_read_b128 v[216:219], v239 offset:128
    ds_read_b128 v[220:223], v239 offset:160
    ds_read_b128 v[224:227], v239 offset:192
    ds_read_b128 v[228:231], v239 offset:224
    s_waitcnt lgkmcnt(4)
    v_mfma_f32_32x32x16_bf16 v[104:119], v[200:203], v[8:11], v[184:199]
    s_add_u32 m0, s41, 16640
    s_nop 0
    buffer_load_dwordx4 v237, s[16:19], s39 offen offset:0 lds
    v_exp_f32 v136, v136
    v_exp_f32 v137, v137
    v_mfma_f32_32x32x16_bf16 v[104:119], v[204:207], v[12:15], v[104:119]
    s_add_u32 m0, s41, 17424
    s_nop 0
    buffer_load_dwordx4 v237, s[16:19], s39 offen offset:256 lds
    v_exp_f32 v138, v138
    v_exp_f32 v139, v139
    v_cvt_pk_bf16_f32 v168, v136, v137
    v_mfma_f32_32x32x16_bf16 v[104:119], v[208:211], v[16:19], v[104:119]
    s_add_u32 m0, s41, 18208
    s_nop 0
    buffer_load_dwordx4 v237, s[16:19], s39 offen offset:512 lds
    v_exp_f32 v140, v140
    v_exp_f32 v141, v141
    v_cvt_pk_bf16_f32 v169, v138, v139
    v_mfma_f32_32x32x16_bf16 v[104:119], v[212:215], v[20:23], v[104:119]
    ds_read_b128 v[200:203], v239 offset:512
    ds_read_b128 v[204:207], v239 offset:544
    ds_read_b128 v[208:211], v239 offset:576
    ds_read_b128 v[212:215], v239 offset:608
    v_exp_f32 v142, v142
    v_exp_f32 v143, v143
    v_cvt_pk_bf16_f32 v170, v140, v141
    s_waitcnt lgkmcnt(4)
    v_mfma_f32_32x32x16_bf16 v[104:119], v[216:219], v[24:27], v[104:119]
    s_add_u32 m0, s41, 18992
    s_nop 0
    buffer_load_dwordx4 v237, s[16:19], s39 offen offset:768 lds
    s_add_u32 s39, s39, 16384
    v_exp_f32 v144, v144
    v_exp_f32 v145, v145
    v_cvt_pk_bf16_f32 v171, v142, v143
    v_mfma_f32_32x32x16_bf16 v[104:119], v[220:223], v[28:31], v[104:119]
    s_add_u32 m0, s41, 33280
    s_nop 0
    buffer_load_dwordx4 v238, s[20:23], s40 offen offset:0 lds
    v_exp_f32 v146, v146
    v_exp_f32 v147, v147
    v_cvt_pk_bf16_f32 v172, v144, v145
    v_mfma_f32_32x32x16_bf16 v[104:119], v[224:227], v[32:35], v[104:119]
    s_add_u32 m0, s41, 34192
    s_nop 0
    buffer_load_dwordx4 v238, s[20:23], s40 offen offset:128 lds
    v_exp_f32 v148, v148
    v_exp_f32 v149, v149
    v_cvt_pk_bf16_f32 v173, v146, v147
    v_mfma_f32_32x32x16_bf16 v[104:119], v[228:231], v[36:39], v[104:119]
    ds_read_b128 v[216:219], v239 offset:640
    ds_read_b128 v[220:223], v239 offset:672
    ds_read_b128 v[224:227], v239 offset:704
    ds_read_b128 v[228:231], v239 offset:736
    v_exp_f32 v150, v150
    v_exp_f32 v151, v151
    v_cvt_pk_bf16_f32 v174, v148, v149
    s_waitcnt lgkmcnt(4)
    v_mfma_f32_32x32x16_bf16 v[120:135], v[200:203], v[8:11], v[184:199]
    s_add_u32 m0, s41, 35104
    s_nop 0
    buffer_load_dwordx4 v238, s[20:23], s40 offen offset:256 lds
    v_exp_f32 v152, v152
    v_exp_f32 v153, v153
    v_cvt_pk_bf16_f32 v175, v150, v151
    v_mfma_f32_32x32x16_bf16 v[120:135], v[204:207], v[12:15], v[120:135]
    s_add_u32 m0, s41, 36016
    s_nop 0
    buffer_load_dwordx4 v238, s[20:23], s40 offen offset:384 lds
    s_add_u32 s40, s40, 16384
    v_exp_f32 v154, v154
    v_exp_f32 v155, v155
    v_cvt_pk_bf16_f32 v176, v152, v153
    v_mfma_f32_32x32x16_bf16 v[120:135], v[208:211], v[16:19], v[120:135]
    v_exp_f32 v156, v156
    v_exp_f32 v157, v157
    v_cvt_pk_bf16_f32 v177, v154, v155
    v_mfma_f32_32x32x16_bf16 v[120:135], v[212:215], v[20:23], v[120:135]
    v_exp_f32 v158, v158
    v_exp_f32 v159, v159
    v_cvt_pk_bf16_f32 v178, v156, v157
    s_waitcnt lgkmcnt(0)
    v_mfma_f32_32x32x16_bf16 v[120:135], v[216:219], v[24:27], v[120:135]
    v_exp_f32 v160, v160
    v_exp_f32 v161, v161
    v_cvt_pk_bf16_f32 v179, v158, v159
    v_mfma_f32_32x32x16_bf16 v[120:135], v[220:223], v[28:31], v[120:135]
    v_exp_f32 v162, v162
    v_exp_f32 v163, v163
    v_cvt_pk_bf16_f32 v180, v160, v161
    v_mfma_f32_32x32x16_bf16 v[120:135], v[224:227], v[32:35], v[120:135]
    v_exp_f32 v164, v164
    v_exp_f32 v165, v165
    v_cvt_pk_bf16_f32 v181, v162, v163
    v_mfma_f32_32x32x16_bf16 v[120:135], v[228:231], v[36:39], v[120:135]
    v_exp_f32 v166, v166
    v_exp_f32 v167, v167
    v_cvt_pk_bf16_f32 v182, v164, v165
    v_cvt_pk_bf16_f32 v183, v166, v167
    s_add_u32 s29, s38, 3
    s_cmp_ge_u32 s29, s37
    s_cbranch_scc1 L_attn_kernel_msk_27
    ds_read_b128 v[200:203], v239 offset:49920
    ds_read_b128 v[204:207], v239 offset:50432
    ds_read_b128 v[208:211], v240 offset:16640
    ds_read_b128 v[212:215], v240 offset:17152
    ds_read_b128 v[216:219], v239 offset:49952
    ds_read_b128 v[220:223], v239 offset:50464
    ds_read_b128 v[224:227], v240 offset:16672
    ds_read_b128 v[228:231], v240 offset:17184
    s_waitcnt lgkmcnt(4)
    v_mfma_f32_32x32x16_bf16 v[40:55], v[200:203], v[168:171], v[40:55]
    v_add_f32 v232, v232, v136
    v_add_f32 v233, v233, v137
    v_mfma_f32_32x32x16_bf16 v[56:71], v[204:207], v[168:171], v[56:71]
    v_add_f32 v232, v232, v138
    v_add_f32 v233, v233, v139
    v_mfma_f32_32x32x16_bf16 v[72:87], v[208:211], v[168:171], v[72:87]
    v_add_f32 v232, v232, v140
    v_add_f32 v233, v233, v141
    v_mfma_f32_32x32x16_bf16 v[88:103], v[212:215], v[168:171], v[88:103]
    ds_read_b128 v[200:203], v239 offset:49984
    ds_read_b128 v[204:207], v239 offset:50496
    ds_read_b128 v[208:211], v240 offset:16704
    ds_read_b128 v[212:215], v240 offset:17216
    v_add_f32 v232, v232, v142
    v_add_f32 v233, v233, v143
    s_waitcnt lgkmcnt(4)
    v_mfma_f32_32x32x16_bf16 v[40:55], v[216:219], v[172:175], v[40:55]
    v_add_f32 v232, v232, v144
    v_add_f32 v233, v233, v145
    v_max3_f32 v2, v104, v105, v106
    v_max3_f32 v2, v2, v107, v108
    v_mfma_f32_32x32x16_bf16 v[56:71], v[220:223], v[172:175], v[56:71]
    v_add_f32 v232, v232, v146
    v_add_f32 v233, v233, v147
    v_max3_f32 v2, v2, v109, v110
    v_max3_f32 v2, v2, v111, v112
    v_mfma_f32_32x32x16_bf16 v[72:87], v[224:227], v[172:175], v[72:87]
    v_add_f32 v232, v232, v148
    v_add_f32 v233, v233, v149
    v_max3_f32 v2, v2, v113, v114
    v_max3_f32 v2, v2, v115, v116
    v_mfma_f32_32x32x16_bf16 v[88:103], v[228:231], v[172:175], v[88:103]
    ds_read_b128 v[216:219], v239 offset:50016
    ds_read_b128 v[220:223], v239 offset:50528
    ds_read_b128 v[224:227], v240 offset:16736
    ds_read_b128 v[228:231], v240 offset:17248
    v_add_f32 v232, v232, v150
    v_add_f32 v233, v233, v151
    v_max3_f32 v2, v2, v117, v118
    v_max3_f32 v2, v2, v119, v120
    s_waitcnt lgkmcnt(4)
    v_mfma_f32_32x32x16_bf16 v[40:55], v[200:203], v[176:179], v[40:55]
    v_add_f32 v232, v232, v152
    v_add_f32 v233, v233, v153
    v_max3_f32 v2, v2, v121, v122
    v_mfma_f32_32x32x16_bf16 v[56:71], v[204:207], v[176:179], v[56:71]
    v_add_f32 v232, v232, v154
    v_add_f32 v233, v233, v155
    v_max3_f32 v2, v2, v123, v124
    v_mfma_f32_32x32x16_bf16 v[72:87], v[208:211], v[176:179], v[72:87]
    v_add_f32 v232, v232, v156
    v_add_f32 v233, v233, v157
    v_max3_f32 v2, v2, v125, v126
    v_mfma_f32_32x32x16_bf16 v[88:103], v[212:215], v[176:179], v[88:103]
    v_add_f32 v232, v232, v158
    v_add_f32 v233, v233, v159
    v_max3_f32 v2, v2, v127, v128
    s_waitcnt lgkmcnt(0)
    v_mfma_f32_32x32x16_bf16 v[40:55], v[216:219], v[180:183], v[40:55]
    v_add_f32 v232, v232, v160
    v_add_f32 v233, v233, v161
    v_max3_f32 v2, v2, v129, v130
    v_mfma_f32_32x32x16_bf16 v[56:71], v[220:223], v[180:183], v[56:71]
    v_add_f32 v232, v232, v162
    v_add_f32 v233, v233, v163
    v_max3_f32 v2, v2, v131, v132
    v_mfma_f32_32x32x16_bf16 v[72:87], v[224:227], v[180:183], v[72:87]
    v_add_f32 v232, v232, v164
    v_add_f32 v233, v233, v165
    v_max3_f32 v2, v2, v133, v134
    v_mfma_f32_32x32x16_bf16 v[88:103], v[228:231], v[180:183], v[88:103]
    v_add_f32 v232, v232, v166
    v_add_f32 v233, v233, v167
    v_max_f32 v2, v2, v135
    s_branch L_attn_kernel_join_28
L_attn_kernel_msk_27:
    s_lshl_b32 s30, s38, 6
    s_add_u32 s30, s30, 64
    ds_read_b128 v[200:203], v239 offset:49920
    ds_read_b128 v[204:207], v239 offset:50432
    ds_read_b128 v[208:211], v240 offset:16640
    ds_read_b128 v[212:215], v240 offset:17152
    ds_read_b128 v[216:219], v239 offset:49952
    ds_read_b128 v[220:223], v239 offset:50464
    ds_read_b128 v[224:227], v240 offset:16672
    ds_read_b128 v[228:231], v240 offset:17184
    s_waitcnt lgkmcnt(4)
    v_mfma_f32_32x32x16_bf16 v[40:55], v[200:203], v[168:171], v[40:55]
    v_add_f32 v232, v232, v136
    v_add_f32 v233, v233, v137
    v_mfma_f32_32x32x16_bf16 v[56:71], v[204:207], v[168:171], v[56:71]
    v_add_f32 v232, v232, v138
    v_add_f32 v233, v233, v139
    v_mfma_f32_32x32x16_bf16 v[72:87], v[208:211], v[168:171], v[72:87]
    v_add_f32 v232, v232, v140
    v_add_f32 v233, v233, v141
    v_mfma_f32_32x32x16_bf16 v[88:103], v[212:215], v[168:171], v[88:103]
    ds_read_b128 v[200:203], v239 offset:49984
    ds_read_b128 v[204:207], v239 offset:50496
    ds_read_b128 v[208:211], v240 offset:16704
    ds_read_b128 v[212:215], v240 offset:17216
    v_add_f32 v232, v232, v142
    v_add_f32 v233, v233, v143
    s_waitcnt lgkmcnt(4)
    v_mfma_f32_32x32x16_bf16 v[40:55], v[216:219], v[172:175], v[40:55]
    v_add_f32 v232, v232, v144
    v_add_f32 v233, v233, v145
    v_mfma_f32_32x32x16_bf16 v[56:71], v[220:223], v[172:175], v[56:71]
    v_add_f32 v232, v232, v146
    v_add_f32 v233, v233, v147
    v_mfma_f32_32x32x16_bf16 v[72:87], v[224:227], v[172:175], v[72:87]
    v_add_f32 v232, v232, v148
    v_add_f32 v233, v233, v149
    v_subrev_u32 v236, s30, v234
    v_sub_u32 v236, v236, v235
    v_mov_b32 v4, 0xff800000
    v_cmp_gt_i32 s[42:43], 0, v236
    v_cmp_gt_i32 s[44:45], 1, v236
    v_cmp_gt_i32 s[46:47], 2, v236
    v_cmp_gt_i32 s[48:49], 3, v236
    v_cndmask_b32 v104, v104, v4, s[42:43]
    v_cndmask_b32 v105, v105, v4, s[44:45]
    v_cndmask_b32 v106, v106, v4, s[46:47]
    v_cndmask_b32 v107, v107, v4, s[48:49]
    v_cmp_gt_i32 s[42:43], 8, v236
    v_cmp_gt_i32 s[44:45], 9, v236
    v_cmp_gt_i32 s[46:47], 10, v236
    v_cmp_gt_i32 s[48:49], 11, v236
    v_cndmask_b32 v108, v108, v4, s[42:43]
    v_cndmask_b32 v109, v109, v4, s[44:45]
    v_cndmask_b32 v110, v110, v4, s[46:47]
    v_cndmask_b32 v111, v111, v4, s[48:49]
    v_cmp_gt_i32 s[42:43], 16, v236
    v_cmp_gt_i32 s[44:45], 17, v236
    v_cmp_gt_i32 s[46:47], 18, v236
    v_cmp_gt_i32 s[48:49], 19, v236
    v_cndmask_b32 v112, v112, v4, s[42:43]
    v_cndmask_b32 v113, v113, v4, s[44:45]
    v_cndmask_b32 v114, v114, v4, s[46:47]
    v_cndmask_b32 v115, v115, v4, s[48:49]
    v_cmp_gt_i32 s[42:43], 24, v236
    v_cmp_gt_i32 s[44:45], 25, v236
    v_cmp_gt_i32 s[46:47], 26, v236
    v_cmp_gt_i32 s[48:49], 27, v236
    v_cndmask_b32 v116, v116, v4, s[42:43]
    v_cndmask_b32 v117, v117, v4, s[44:45]
    v_cndmask_b32 v118, v118, v4, s[46:47]
    v_cndmask_b32 v119, v119, v4, s[48:49]
    v_cmp_gt_i32 s[42:43], 32, v236
    v_cmp_gt_i32 s[44:45], 33, v236
    v_cmp_gt_i32 s[46:47], 34, v236
    v_cmp_gt_i32 s[48:49], 35, v236
    v_cndmask_b32 v120, v120, v4, s[42:43]
    v_cndmask_b32 v121, v121, v4, s[44:45]
    v_cndmask_b32 v122, v122, v4, s[46:47]
    v_cndmask_b32 v123, v123, v4, s[48:49]
    v_cmp_gt_i32 s[42:43], 40, v236
    v_cmp_gt_i32 s[44:45], 41, v236
    v_cmp_gt_i32 s[46:47], 42, v236
    v_cmp_gt_i32 s[48:49], 43, v236
    v_cndmask_b32 v124, v124, v4, s[42:43]
    v_cndmask_b32 v125, v125, v4, s[44:45]
    v_cndmask_b32 v126, v126, v4, s[46:47]
    v_cndmask_b32 v127, v127, v4, s[48:49]
    v_cmp_gt_i32 s[42:43], 48, v236
    v_cmp_gt_i32 s[44:45], 49, v236
    v_cmp_gt_i32 s[46:47], 50, v236
    v_cmp_gt_i32 s[48:49], 51, v236
    v_cndmask_b32 v128, v128, v4, s[42:43]
    v_cndmask_b32 v129, v129, v4, s[44:45]
    v_cndmask_b32 v130, v130, v4, s[46:47]
    v_cndmask_b32 v131, v131, v4, s[48:49]
    v_cmp_gt_i32 s[42:43], 56, v236
    v_cmp_gt_i32 s[44:45], 57, v236
    v_cmp_gt_i32 s[46:47], 58, v236
    v_cmp_gt_i32 s[48:49], 59, v236
    v_cndmask_b32 v132, v132, v4, s[42:43]
    v_cndmask_b32 v133, v133, v4, s[44:45]
    v_cndmask_b32 v134, v134, v4, s[46:47]
    v_cndmask_b32 v135, v135, v4, s[48:49]
    v_mfma_f32_32x32x16_bf16 v[88:103], v[228:231], v[172:175], v[88:103]
    ds_read_b128 v[216:219], v239 offset:50016
    ds_read_b128 v[220:223], v239 offset:50528
    ds_read_b128 v[224:227], v240 offset:16736
    ds_read_b128 v[228:231], v240 offset:17248
    v_add_f32 v232, v232, v150
    v_add_f32 v233, v233, v151
    v_max3_f32 v2, v104, v105, v106
    v_max3_f32 v2, v2, v107, v108
    s_waitcnt lgkmcnt(4)
    v_mfma_f32_32x32x16_bf16 v[40:55], v[200:203], v[176:179], v[40:55]
    v_add_f32 v232, v232, v152
    v_add_f32 v233, v233, v153
    v_max3_f32 v2, v2, v109, v110
    v_max3_f32 v2, v2, v111, v112
    v_mfma_f32_32x32x16_bf16 v[56:71], v[204:207], v[176:179], v[56:71]
    v_add_f32 v232, v232, v154
    v_add_f32 v233, v233, v155
    v_max3_f32 v2, v2, v113, v114
    v_max3_f32 v2, v2, v115, v116
    v_mfma_f32_32x32x16_bf16 v[72:87], v[208:211], v[176:179], v[72:87]
    v_add_f32 v232, v232, v156
    v_add_f32 v233, v233, v157
    v_max3_f32 v2, v2, v117, v118
    v_max3_f32 v2, v2, v119, v120
    v_mfma_f32_32x32x16_bf16 v[88:103], v[212:215], v[176:179], v[88:103]
    v_add_f32 v232, v232, v158
    v_add_f32 v233, v233, v159
    v_max3_f32 v2, v2, v121, v122
    v_max3_f32 v2, v2, v123, v124
    s_waitcnt lgkmcnt(0)
    v_mfma_f32_32x32x16_bf16 v[40:55], v[216:219], v[180:183], v[40:55]
    v_add_f32 v232, v232, v160
    v_add_f32 v233, v233, v161
    v_max3_f32 v2, v2, v125, v126
    v_max3_f32 v2, v2, v127, v128
    v_mfma_f32_32x32x16_bf16 v[56:71], v[220:223], v[180:183], v[56:71]
    v_add_f32 v232, v232, v162
    v_add_f32 v233, v233, v163
    v_max3_f32 v2, v2, v129, v130
    v_max3_f32 v2, v2, v131, v132
    v_mfma_f32_32x32x16_bf16 v[72:87], v[224:227], v[180:183], v[72:87]
    v_add_f32 v232, v232, v164
    v_add_f32 v233, v233, v165
    v_max3_f32 v2, v2, v133, v134
    v_max_f32 v2, v2, v135
    v_mfma_f32_32x32x16_bf16 v[88:103], v[228:231], v[180:183], v[88:103]
    v_add_f32 v232, v232, v166
    v_add_f32 v233, v233, v167
L_attn_kernel_join_28:
    v_mov_b32 v3, v2
    s_nop 1
    v_permlane32_swap_b32 v2, v3
    s_nop 1
    v_max_f32 v2, v2, v3
    v_cmp_lt_f32 vcc, 0x42000000, v2
    s_cbranch_vccz L_attn_kernel_nors_29
    v_max_f32 v2, 0, v2
    v_sub_f32 v3, 0, v2
    v_exp_f32 v3, v3
    v_sub_f32 v104, v104, v2
    v_sub_f32 v105, v105, v2
    v_sub_f32 v106, v106, v2
    v_sub_f32 v107, v107, v2
    v_sub_f32 v108, v108, v2
    v_sub_f32 v109, v109, v2
    v_sub_f32 v110, v110, v2
    v_sub_f32 v111, v111, v2
    v_sub_f32 v112, v112, v2
    v_sub_f32 v113, v113, v2
    v_sub_f32 v114, v114, v2
    v_sub_f32 v115, v115, v2
    v_sub_f32 v116, v116, v2
    v_sub_f32 v117, v117, v2
    v_sub_f32 v118, v118, v2
    v_sub_f32 v119, v119, v2
    v_sub_f32 v120, v120, v2
    v_sub_f32 v121, v121, v2
    v_sub_f32 v122, v122, v2
    v_sub_f32 v123, v123, v2
    v_sub_f32 v124, v124, v2
    v_sub_f32 v125, v125, v2
    v_sub_f32 v126, v126, v2
    v_sub_f32 v127, v127, v2
    v_sub_f32 v128, v128, v2
    v_sub_f32 v129, v129, v2
    v_sub_f32 v130, v130, v2
    v_sub_f32 v131, v131, v2
    v_sub_f32 v132, v132, v2
    v_sub_f32 v133, v133, v2
    v_sub_f32 v134, v134, v2
    v_sub_f32 v135, v135, v2
    v_sub_f32 v184, v184, v2
    v_sub_f32 v185, v185, v2
    v_sub_f32 v186, v186, v2
    v_sub_f32 v187, v187, v2
    v_sub_f32 v188, v188, v2
    v_sub_f32 v189, v189, v2
    v_sub_f32 v190, v190, v2
    v_sub_f32 v191, v191, v2
    v_sub_f32 v192, v192, v2
    v_sub_f32 v193, v193, v2
    v_sub_f32 v194, v194, v2
    v_sub_f32 v195, v195, v2
    v_sub_f32 v196, v196, v2
    v_sub_f32 v197, v197, v2
    v_sub_f32 v198, v198, v2
    v_sub_f32 v199, v199, v2
    s_nop 7
    v_mul_f32 v232, v232, v3
    v_mul_f32 v233, v233, v3
    v_mul_f32 v40, v40, v3
    v_mul_f32 v41, v41, v3
    v_mul_f32 v42, v42, v3
    v_mul_f32 v43, v43, v3
    v_mul_f32 v44, v44, v3
    v_mul_f32 v45, v45, v3
    v_mul_f32 v46, v46, v3
    v_mul_f32 v47, v47, v3
    v_mul_f32 v48, v48, v3
    v_mul_f32 v49, v49, v3
    v_mul_f32 v50, v50, v3
    v_mul_f32 v51, v51, v3
    v_mul_f32 v52, v52, v3
    v_mul_f32 v53, v53, v3
    v_mul_f32 v54, v54, v3
    v_mul_f32 v55, v55, v3
    v_mul_f32 v56, v56, v3
    v_mul_f32 v57, v57, v3
    v_mul_f32 v58, v58, v3
    v_mul_f32 v59, v59, v3
    v_mul_f32 v60, v60, v3
    v_mul_f32 v61, v61, v3
    v_mul_f32 v62, v62, v3
    v_mul_f32 v63, v63, v3
    v_mul_f32 v64, v64, v3
    v_mul_f32 v65, v65, v3
    v_mul_f32 v66, v66, v3
    v_mul_f32 v67, v67, v3
    v_mul_f32 v68, v68, v3
    v_mul_f32 v69, v69, v3
    v_mul_f32 v70, v70, v3
    v_mul_f32 v71, v71, v3
    v_mul_f32 v72, v72, v3
    v_mul_f32 v73, v73, v3
    v_mul_f32 v74, v74, v3
    v_mul_f32 v75, v75, v3
    v_mul_f32 v76, v76, v3
    v_mul_f32 v77, v77, v3
    v_mul_f32 v78, v78, v3
    v_mul_f32 v79, v79, v3
    v_mul_f32 v80, v80, v3
    v_mul_f32 v81, v81, v3
    v_mul_f32 v82, v82, v3
    v_mul_f32 v83, v83, v3
    v_mul_f32 v84, v84, v3
    v_mul_f32 v85, v85, v3
    v_mul_f32 v86, v86, v3
    v_mul_f32 v87, v87, v3
    v_mul_f32 v88, v88, v3
    v_mul_f32 v89, v89, v3
    v_mul_f32 v90, v90, v3
    v_mul_f32 v91, v91, v3
    v_mul_f32 v92, v92, v3
    v_mul_f32 v93, v93, v3
    v_mul_f32 v94, v94, v3
    v_mul_f32 v95, v95, v3
    v_mul_f32 v96, v96, v3
    v_mul_f32 v97, v97, v3
    v_mul_f32 v98, v98, v3
    v_mul_f32 v99, v99, v3
    v_mul_f32 v100, v100, v3
    v_mul_f32 v101, v101, v3
    v_mul_f32 v102, v102, v3
    v_mul_f32 v103, v103, v3
    s_nop 1
L_attn_kernel_nors_29:
    s_add_u32 s38, s38, 1
    s_waitcnt vmcnt(0)
    s_barrier
    s_add_u32 s29, s38, 2
    s_cmp_lt_u32 s29, s37
    s_cbranch_scc1 L_attn_kernel_bloop_22
L_attn_kernel_blast_23:
    ds_read_b128 v[200:203], v239 offset:16640
    ds_read_b128 v[204:207], v239 offset:16672
    ds_read_b128 v[208:211], v239 offset:16704
    ds_read_b128 v[212:215], v239 offset:16736
    ds_read_b128 v[216:219], v239 offset:16768
    ds_read_b128 v[220:223], v239 offset:16800
    ds_read_b128 v[224:227], v239 offset:16832
    ds_read_b128 v[228:231], v239 offset:16864
    s_waitcnt lgkmcnt(4)
    v_mfma_f32_32x32x16_bf16 v[136:151], v[200:203], v[8:11], v[184:199]
    s_add_u32 m0, s41, 0
    s_nop 0
    buffer_load_dwordx4 v237, s[16:19], s39 offen offset:0 lds
    v_exp_f32 v104, v104
    v_exp_f32 v105, v105
    v_mfma_f32_32x32x16_bf16 v[136:151], v[204:207], v[12:15], v[136:151]
    s_add_u32 m0, s41, 784
    s_nop 0
    buffer_load_dwordx4 v237, s[16:19], s39 offen offset:256 lds
    v_exp_f32 v106, v106
    v_exp_f32 v107, v107
    v_cvt_pk_bf16_f32 v168, v104, v105
    v_mfma_f32_32x32x16_bf16 v[136:151], v[208:211], v[16:19], v[136:151]
    s_add_u32 m0, s41, 1568
    s_nop 0
    buffer_load_dwordx4 v237, s[16:19], s39 offen offset:512 lds
    v_exp_f32 v108, v108
    v_exp_f32 v109, v109
    v_cvt_pk_bf16_f32 v169, v106, v107
    v_mfma_f32_32x32x16_bf16 v[136:151], v[212:215], v[20:23], v[136:151]
    ds_read_b128 v[200:203], v239 offset:17152
    ds_read_b128 v[204:207], v239 offset:17184
    ds_read_b128 v[208:211], v239 offset:17216
    ds_read_b128 v[212:215], v239 offset:17248
    v_exp_f32 v110, v110
    v_exp_f32 v111, v111
    v_cvt_pk_bf16_f32 v170, v108, v109
    s_waitcnt lgkmcnt(4)
    v_mfma_f32_32x32x16_bf16 v[136:151], v[216:219], v[24:27], v[136:151]
    s_add_u32 m0, s41, 2352
    s_nop 0
    buffer_load_dwordx4 v237, s[16:19], s39 offen offset:768 lds
    s_add_u32 s39, s39, 16384
    v_exp_f32 v112, v112
    v_exp_f32 v113, v113
    v_cvt_pk_bf16_f32 v171, v110, v111
    v_mfma_f32_32x32x16_bf16 v[136:151], v[220:223], v[28:31], v[136:151]
    s_add_u32 m0, s41, 49920
    s_nop 0
    buffer_load_dwordx4 v238, s[20:23], s40 offen offset:0 lds
    v_exp_f32 v114, v114
    v_exp_f32 v115, v115
    v_cvt_pk_bf16_f32 v172, v112, v113
    v_mfma_f32_32x32x16_bf16 v[136:151], v[224:227], v[32:35], v[136:151]
    s_add_u32 m0, s41, 50832
    s_nop 0
    buffer_load_dwordx4 v238, s[20:23], s40 offen offset:128 lds
    v_exp_f32 v116, v116
    v_exp_f32 v117, v117
    v_cvt_pk_bf16_f32 v173, v114, v115
    v_mfma_f32_32x32x16_bf16 v[136:151], v[228:231], v[36:39], v[136:151]
    ds_read_b128 v[216:219], v239 offset:17280
    ds_read_b128 v[220:223], v239 offset:17312
    ds_read_b128 v[224:227], v239 offset:17344
    ds_read_b128 v[228:231], v239 offset:17376
    v_exp_f32 v118, v118
    v_exp_f32 v119, v119
    v_cvt_pk_bf16_f32 v174, v116, v117
    s_waitcnt lgkmcnt(4)
    v_mfma_f32_32x32x16_bf16 v[152:167], v[200:203], v[8:11], v[184:199]
    s_add_u32 m0, s41, 51744
    s_nop 0
    buffer_load_dwordx4 v238, s[20:23], s40 offen offset:256 lds
    v_exp_f32 v120, v120
    v_exp_f32 v121, v121
    v_cvt_pk_bf16_f32 v175, v118, v119
    v_mfma_f32_32x32x16_bf16 v[152:167], v[204:207], v[12:15], v[152:167]
    s_add_u32 m0, s41, 52656
    s_nop 0
    buffer_load_dwordx4 v238, s[20:23], s40 offen offset:384 lds
    s_add_u32 s40, s40, 16384
    v_exp_f32 v122, v122
    v_exp_f32 v123, v123
    v_cvt_pk_bf16_f32 v176, v120, v121
    v_mfma_f32_32x32x16_bf16 v[152:167], v[208:211], v[16:19], v[152:167]
    v_exp_f32 v124, v124
    v_exp_f32 v125, v125
    v_cvt_pk_bf16_f32 v177, v122, v123
    v_mfma_f32_32x32x16_bf16 v[152:167], v[212:215], v[20:23], v[152:167]
    v_exp_f32 v126, v126
    v_exp_f32 v127, v127
    v_cvt_pk_bf16_f32 v178, v124, v125
    s_waitcnt lgkmcnt(0)
    v_mfma_f32_32x32x16_bf16 v[152:167], v[216:219], v[24:27], v[152:167]
    v_exp_f32 v128, v128
    v_exp_f32 v129, v129
    v_cvt_pk_bf16_f32 v179, v126, v127
    v_mfma_f32_32x32x16_bf16 v[152:167], v[220:223], v[28:31], v[152:167]
    v_exp_f32 v130, v130
    v_exp_f32 v131, v131
    v_cvt_pk_bf16_f32 v180, v128, v129
    v_mfma_f32_32x32x16_bf16 v[152:167], v[224:227], v[32:35], v[152:167]
    v_exp_f32 v132, v132
    v_exp_f32 v133, v133
    v_cvt_pk_bf16_f32 v181, v130, v131
    v_mfma_f32_32x32x16_bf16 v[152:167], v[228:231], v[36:39], v[152:167]
    v_exp_f32 v134, v134
    v_exp_f32 v135, v135
    v_cvt_pk_bf16_f32 v182, v132, v133
    v_cvt_pk_bf16_f32 v183, v134, v135
    s_add_u32 s29, s38, 3
    s_cmp_ge_u32 s29, s37
    s_cbranch_scc1 L_attn_kernel_msk_30
    ds_read_b128 v[200:203], v239 offset:33280
    ds_read_b128 v[204:207], v239 offset:33792
    ds_read_b128 v[208:211], v240 offset:0
    ds_read_b128 v[212:215], v240 offset:512
    ds_read_b128 v[216:219], v239 offset:33312
    ds_read_b128 v[220:223], v239 offset:33824
    ds_read_b128 v[224:227], v240 offset:32
    ds_read_b128 v[228:231], v240 offset:544
    s_waitcnt lgkmcnt(4)
    v_mfma_f32_32x32x16_bf16 v[40:55], v[200:203], v[168:171], v[40:55]
    v_add_f32 v232, v232, v104
    v_add_f32 v233, v233, v105
    v_mfma_f32_32x32x16_bf16 v[56:71], v[204:207], v[168:171], v[56:71]
    v_add_f32 v232, v232, v106
    v_add_f32 v233, v233, v107
    v_mfma_f32_32x32x16_bf16 v[72:87], v[208:211], v[168:171], v[72:87]
    v_add_f32 v232, v232, v108
    v_add_f32 v233, v233, v109
    v_mfma_f32_32x32x16_bf16 v[88:103], v[212:215], v[168:171], v[88:103]
    ds_read_b128 v[200:203], v239 offset:33344
    ds_read_b128 v[204:207], v239 offset:33856
    ds_read_b128 v[208:211], v240 offset:64
    ds_read_b128 v[212:215], v240 offset:576
    v_add_f32 v232, v232, v110
    v_add_f32 v233, v233, v111
    s_waitcnt lgkmcnt(4)
    v_mfma_f32_32x32x16_bf16 v[40:55], v[216:219], v[172:175], v[40:55]
    v_add_f32 v232, v232, v112
    v_add_f32 v233, v233, v113
    v_max3_f32 v2, v136, v137, v138
    v_max3_f32 v2, v2, v139, v140
    v_mfma_f32_32x32x16_bf16 v[56:71], v[220:223], v[172:175], v[56:71]
    v_add_f32 v232, v232, v114
    v_add_f32 v233, v233, v115
    v_max3_f32 v2, v2, v141, v142
    v_max3_f32 v2, v2, v143, v144
    v_mfma_f32_32x32x16_bf16 v[72:87], v[224:227], v[172:175], v[72:87]
    v_add_f32 v232, v232, v116
    v_add_f32 v233, v233, v117
    v_max3_f32 v2, v2, v145, v146
    v_max3_f32 v2, v2, v147, v148
    v_mfma_f32_32x32x16_bf16 v[88:103], v[228:231], v[172:175], v[88:103]
    ds_read_b128 v[216:219], v239 offset:33376
    ds_read_b128 v[220:223], v239 offset:33888
    ds_read_b128 v[224:227], v240 offset:96
    ds_read_b128 v[228:231], v240 offset:608
    v_add_f32 v232, v232, v118
    v_add_f32 v233, v233, v119
    v_max3_f32 v2, v2, v149, v150
    v_max3_f32 v2, v2, v151, v152
    s_waitcnt lgkmcnt(4)
    v_mfma_f32_32x32x16_bf16 v[40:55], v[200:203], v[176:179], v[40:55]
    v_add_f32 v232, v232, v120
    v_add_f32 v233, v233, v121
    v_max3_f32 v2, v2, v153, v154
    v_mfma_f32_32x32x16_bf16 v[56:71], v[204:207], v[176:179], v[56:71]
    v_add_f32 v232, v232, v122
    v_add_f32 v233, v233, v123
    v_max3_f32 v2, v2, v155, v156
    v_mfma_f32_32x32x16_bf16 v[72:87], v[208:211], v[176:179], v[72:87]
    v_add_f32 v232, v232, v124
    v_add_f32 v233, v233, v125
    v_max3_f32 v2, v2, v157, v158
    v_mfma_f32_32x32x16_bf16 v[88:103], v[212:215], v[176:179], v[88:103]
    v_add_f32 v232, v232, v126
    v_add_f32 v233, v233, v127
    v_max3_f32 v2, v2, v159, v160
    s_waitcnt lgkmcnt(0)
    v_mfma_f32_32x32x16_bf16 v[40:55], v[216:219], v[180:183], v[40:55]
    v_add_f32 v232, v232, v128
    v_add_f32 v233, v233, v129
    v_max3_f32 v2, v2, v161, v162
    v_mfma_f32_32x32x16_bf16 v[56:71], v[220:223], v[180:183], v[56:71]
    v_add_f32 v232, v232, v130
    v_add_f32 v233, v233, v131
    v_max3_f32 v2, v2, v163, v164
    v_mfma_f32_32x32x16_bf16 v[72:87], v[224:227], v[180:183], v[72:87]
    v_add_f32 v232, v232, v132
    v_add_f32 v233, v233, v133
    v_max3_f32 v2, v2, v165, v166
    v_mfma_f32_32x32x16_bf16 v[88:103], v[228:231], v[180:183], v[88:103]
    v_add_f32 v232, v232, v134
    v_add_f32 v233, v233, v135
    v_max_f32 v2, v2, v167
    s_branch L_attn_kernel_join_31
L_attn_kernel_msk_30:
    s_lshl_b32 s30, s38, 6
    s_add_u32 s30, s30, 64
    ds_read_b128 v[200:203], v239 offset:33280
    ds_read_b128 v[204:207], v239 offset:33792
    ds_read_b128 v[208:211], v240 offset:0
    ds_read_b128 v[212:215], v240 offset:512
    ds_read_b128 v[216:219], v239 offset:33312
    ds_read_b128 v[220:223], v239 offset:33824
    ds_read_b128 v[224:227], v240 offset:32
    ds_read_b128 v[228:231], v240 offset:544
    s_waitcnt lgkmcnt(4)
    v_mfma_f32_32x32x16_bf16 v[40:55], v[200:203], v[168:171], v[40:55]
    v_add_f32 v232, v232, v104
    v_add_f32 v233, v233, v105
    v_mfma_f32_32x32x16_bf16 v[56:71], v[204:207], v[168:171], v[56:71]
    v_add_f32 v232, v232, v106
    v_add_f32 v233, v233, v107
    v_mfma_f32_32x32x16_bf16 v[72:87], v[208:211], v[168:171], v[72:87]
    v_add_f32 v232, v232, v108
    v_add_f32 v233, v233, v109
    v_mfma_f32_32x32x16_bf16 v[88:103], v[212:215], v[168:171], v[88:103]
    ds_read_b128 v[200:203], v239 offset:33344
    ds_read_b128 v[204:207], v239 offset:33856
    ds_read_b128 v[208:211], v240 offset:64
    ds_read_b128 v[212:215], v240 offset:576
    v_add_f32 v232, v232, v110
    v_add_f32 v233, v233, v111
    s_waitcnt lgkmcnt(4)
    v_mfma_f32_32x32x16_bf16 v[40:55], v[216:219], v[172:175], v[40:55]
    v_add_f32 v232, v232, v112
    v_add_f32 v233, v233, v113
    v_mfma_f32_32x32x16_bf16 v[56:71], v[220:223], v[172:175], v[56:71]
    v_add_f32 v232, v232, v114
    v_add_f32 v233, v233, v115
    v_mfma_f32_32x32x16_bf16 v[72:87], v[224:227], v[172:175], v[72:87]
    v_add_f32 v232, v232, v116
    v_add_f32 v233, v233, v117
    v_subrev_u32 v236, s30, v234
    v_sub_u32 v236, v236, v235
    v_mov_b32 v4, 0xff800000
    v_cmp_gt_i32 s[42:43], 0, v236
    v_cmp_gt_i32 s[44:45], 1, v236
    v_cmp_gt_i32 s[46:47], 2, v236
    v_cmp_gt_i32 s[48:49], 3, v236
    v_cndmask_b32 v136, v136, v4, s[42:43]
    v_cndmask_b32 v137, v137, v4, s[44:45]
    v_cndmask_b32 v138, v138, v4, s[46:47]
    v_cndmask_b32 v139, v139, v4, s[48:49]
    v_cmp_gt_i32 s[42:43], 8, v236
    v_cmp_gt_i32 s[44:45], 9, v236
    v_cmp_gt_i32 s[46:47], 10, v236
    v_cmp_gt_i32 s[48:49], 11, v236
    v_cndmask_b32 v140, v140, v4, s[42:43]
    v_cndmask_b32 v141, v141, v4, s[44:45]
    v_cndmask_b32 v142, v142, v4, s[46:47]
    v_cndmask_b32 v143, v143, v4, s[48:49]
    v_cmp_gt_i32 s[42:43], 16, v236
    v_cmp_gt_i32 s[44:45], 17, v236
    v_cmp_gt_i32 s[46:47], 18, v236
    v_cmp_gt_i32 s[48:49], 19, v236
    v_cndmask_b32 v144, v144, v4, s[42:43]
    v_cndmask_b32 v145, v145, v4, s[44:45]
    v_cndmask_b32 v146, v146, v4, s[46:47]
    v_cndmask_b32 v147, v147, v4, s[48:49]
    v_cmp_gt_i32 s[42:43], 24, v236
    v_cmp_gt_i32 s[44:45], 25, v236
    v_cmp_gt_i32 s[46:47], 26, v236
    v_cmp_gt_i32 s[48:49], 27, v236
    v_cndmask_b32 v148, v148, v4, s[42:43]
    v_cndmask_b32 v149, v149, v4, s[44:45]
    v_cndmask_b32 v150, v150, v4, s[46:47]
    v_cndmask_b32 v151, v151, v4, s[48:49]
    v_cmp_gt_i32 s[42:43], 32, v236
    v_cmp_gt_i32 s[44:45], 33, v236
    v_cmp_gt_i32 s[46:47], 34, v236
    v_cmp_gt_i32 s[48:49], 35, v236
    v_cndmask_b32 v152, v152, v4, s[42:43]
    v_cndmask_b32 v153, v153, v4, s[44:45]
    v_cndmask_b32 v154, v154, v4, s[46:47]
    v_cndmask_b32 v155, v155, v4, s[48:49]
    v_cmp_gt_i32 s[42:43], 40, v236
    v_cmp_gt_i32 s[44:45], 41, v236
    v_cmp_gt_i32 s[46:47], 42, v236
    v_cmp_gt_i32 s[48:49], 43, v236
    v_cndmask_b32 v156, v156, v4, s[42:43]
    v_cndmask_b32 v157, v157, v4, s[44:45]
    v_cndmask_b32 v158, v158, v4, s[46:47]
    v_cndmask_b32 v159, v159, v4, s[48:49]
    v_cmp_gt_i32 s[42:43], 48, v236
    v_cmp_gt_i32 s[44:45], 49, v236
    v_cmp_gt_i32 s[46:47], 50, v236
    v_cmp_gt_i32 s[48:49], 51, v236
    v_cndmask_b32 v160, v160, v4, s[42:43]
    v_cndmask_b32 v161, v161, v4, s[44:45]
    v_cndmask_b32 v162, v162, v4, s[46:47]
    v_cndmask_b32 v163, v163, v4, s[48:49]
    v_cmp_gt_i32 s[42:43], 56, v236
    v_cmp_gt_i32 s[44:45], 57, v236
    v_cmp_gt_i32 s[46:47], 58, v236
    v_cmp_gt_i32 s[48:49], 59, v236
    v_cndmask_b32 v164, v164, v4, s[42:43]
    v_cndmask_b32 v165, v165, v4, s[44:45]
    v_cndmask_b32 v166, v166, v4, s[46:47]
    v_cndmask_b32 v167, v167, v4, s[48:49]
    v_mfma_f32_32x32x16_bf16 v[88:103], v[228:231], v[172:175], v[88:103]
    ds_read_b128 v[216:219], v239 offset:33376
    ds_read_b128 v[220:223], v239 offset:33888
    ds_read_b128 v[224:227], v240 offset:96
    ds_read_b128 v[228:231], v240 offset:608
    v_add_f32 v232, v232, v118
    v_add_f32 v233, v233, v119
    v_max3_f32 v2, v136, v137, v138
    v_max3_f32 v2, v2, v139, v140
    s_waitcnt lgkmcnt(4)
    v_mfma_f32_32x32x16_bf16 v[40:55], v[200:203], v[176:179], v[40:55]
    v_add_f32 v232, v232, v120
    v_add_f32 v233, v233, v121
    v_max3_f32 v2, v2, v141, v142
    v_max3_f32 v2, v2, v143, v144
    v_mfma_f32_32x32x16_bf16 v[56:71], v[204:207], v[176:179], v[56:71]
    v_add_f32 v232, v232, v122
    v_add_f32 v233, v233, v123
    v_max3_f32 v2, v2, v145, v146
    v_max3_f32 v2, v2, v147, v148
    v_mfma_f32_32x32x16_bf16 v[72:87], v[208:211], v[176:179], v[72:87]
    v_add_f32 v232, v232, v124
    v_add_f32 v233, v233, v125
    v_max3_f32 v2, v2, v149, v150
    v_max3_f32 v2, v2, v151, v152
    v_mfma_f32_32x32x16_bf16 v[88:103], v[212:215], v[176:179], v[88:103]
    v_add_f32 v232, v232, v126
    v_add_f32 v233, v233, v127
    v_max3_f32 v2, v2, v153, v154
    v_max3_f32 v2, v2, v155, v156
    s_waitcnt lgkmcnt(0)
    v_mfma_f32_32x32x16_bf16 v[40:55], v[216:219], v[180:183], v[40:55]
    v_add_f32 v232, v232, v128
    v_add_f32 v233, v233, v129
    v_max3_f32 v2, v2, v157, v158
    v_max3_f32 v2, v2, v159, v160
    v_mfma_f32_32x32x16_bf16 v[56:71], v[220:223], v[180:183], v[56:71]
    v_add_f32 v232, v232, v130
    v_add_f32 v233, v233, v131
    v_max3_f32 v2, v2, v161, v162
    v_max3_f32 v2, v2, v163, v164
    v_mfma_f32_32x32x16_bf16 v[72:87], v[224:227], v[180:183], v[72:87]
    v_add_f32 v232, v232, v132
    v_add_f32 v233, v233, v133
    v_max3_f32 v2, v2, v165, v166
    v_max_f32 v2, v2, v167
    v_mfma_f32_32x32x16_bf16 v[88:103], v[228:231], v[180:183], v[88:103]
    v_add_f32 v232, v232, v134
    v_add_f32 v233, v233, v135
L_attn_kernel_join_31:
    v_mov_b32 v3, v2
    s_nop 1
    v_permlane32_swap_b32 v2, v3
    s_nop 1
    v_max_f32 v2, v2, v3
    v_cmp_lt_f32 vcc, 0x42000000, v2
    s_cbranch_vccz L_attn_kernel_nors_32
    v_max_f32 v2, 0, v2
    v_sub_f32 v3, 0, v2
    v_exp_f32 v3, v3
    v_sub_f32 v136, v136, v2
    v_sub_f32 v137, v137, v2
    v_sub_f32 v138, v138, v2
    v_sub_f32 v139, v139, v2
    v_sub_f32 v140, v140, v2
    v_sub_f32 v141, v141, v2
    v_sub_f32 v142, v142, v2
    v_sub_f32 v143, v143, v2
    v_sub_f32 v144, v144, v2
    v_sub_f32 v145, v145, v2
    v_sub_f32 v146, v146, v2
    v_sub_f32 v147, v147, v2
    v_sub_f32 v148, v148, v2
    v_sub_f32 v149, v149, v2
    v_sub_f32 v150, v150, v2
    v_sub_f32 v151, v151, v2
    v_sub_f32 v152, v152, v2
    v_sub_f32 v153, v153, v2
    v_sub_f32 v154, v154, v2
    v_sub_f32 v155, v155, v2
    v_sub_f32 v156, v156, v2
    v_sub_f32 v157, v157, v2
    v_sub_f32 v158, v158, v2
    v_sub_f32 v159, v159, v2
    v_sub_f32 v160, v160, v2
    v_sub_f32 v161, v161, v2
    v_sub_f32 v162, v162, v2
    v_sub_f32 v163, v163, v2
    v_sub_f32 v164, v164, v2
    v_sub_f32 v165, v165, v2
    v_sub_f32 v166, v166, v2
    v_sub_f32 v167, v167, v2
    v_sub_f32 v184, v184, v2
    v_sub_f32 v185, v185, v2
    v_sub_f32 v186, v186, v2
    v_sub_f32 v187, v187, v2
    v_sub_f32 v188, v188, v2
    v_sub_f32 v189, v189, v2
    v_sub_f32 v190, v190, v2
    v_sub_f32 v191, v191, v2
    v_sub_f32 v192, v192, v2
    v_sub_f32 v193, v193, v2
    v_sub_f32 v194, v194, v2
    v_sub_f32 v195, v195, v2
    v_sub_f32 v196, v196, v2
    v_sub_f32 v197, v197, v2
    v_sub_f32 v198, v198, v2
    v_sub_f32 v199, v199, v2
    s_nop 7
    v_mul_f32 v232, v232, v3
    v_mul_f32 v233, v233, v3
    v_mul_f32 v40, v40, v3
    v_mul_f32 v41, v41, v3
    v_mul_f32 v42, v42, v3
    v_mul_f32 v43, v43, v3
    v_mul_f32 v44, v44, v3
    v_mul_f32 v45, v45, v3
    v_mul_f32 v46, v46, v3
    v_mul_f32 v47, v47, v3
    v_mul_f32 v48, v48, v3
    v_mul_f32 v49, v49, v3
    v_mul_f32 v50, v50, v3
    v_mul_f32 v51, v51, v3
    v_mul_f32 v52, v52, v3
    v_mul_f32 v53, v53, v3
    v_mul_f32 v54, v54, v3
    v_mul_f32 v55, v55, v3
    v_mul_f32 v56, v56, v3
    v_mul_f32 v57, v57, v3
    v_mul_f32 v58, v58, v3
    v_mul_f32 v59, v59, v3
    v_mul_f32 v60, v60, v3
    v_mul_f32 v61, v61, v3
    v_mul_f32 v62, v62, v3
    v_mul_f32 v63, v63, v3
    v_mul_f32 v64, v64, v3
    v_mul_f32 v65, v65, v3
    v_mul_f32 v66, v66, v3
    v_mul_f32 v67, v67, v3
    v_mul_f32 v68, v68, v3
    v_mul_f32 v69, v69, v3
    v_mul_f32 v70, v70, v3
    v_mul_f32 v71, v71, v3
    v_mul_f32 v72, v72, v3
    v_mul_f32 v73, v73, v3
    v_mul_f32 v74, v74, v3
    v_mul_f32 v75, v75, v3
    v_mul_f32 v76, v76, v3
    v_mul_f32 v77, v77, v3
    v_mul_f32 v78, v78, v3
    v_mul_f32 v79, v79, v3
    v_mul_f32 v80, v80, v3
    v_mul_f32 v81, v81, v3
    v_mul_f32 v82, v82, v3
    v_mul_f32 v83, v83, v3
    v_mul_f32 v84, v84, v3
    v_mul_f32 v85, v85, v3
    v_mul_f32 v86, v86, v3
    v_mul_f32 v87, v87, v3
    v_mul_f32 v88, v88, v3
    v_mul_f32 v89, v89, v3
    v_mul_f32 v90, v90, v3
    v_mul_f32 v91, v91, v3
    v_mul_f32 v92, v92, v3
    v_mul_f32 v93, v93, v3
    v_mul_f32 v94, v94, v3
    v_mul_f32 v95, v95, v3
    v_mul_f32 v96, v96, v3
    v_mul_f32 v97, v97, v3
    v_mul_f32 v98, v98, v3
    v_mul_f32 v99, v99, v3
    v_mul_f32 v100, v100, v3
    v_mul_f32 v101, v101, v3
    v_mul_f32 v102, v102, v3
    v_mul_f32 v103, v103, v3
    s_nop 1
L_attn_kernel_nors_32:
    s_add_u32 s38, s38, 1
    s_waitcnt vmcnt(0)
    s_barrier
    s_sub_u32 s35, 15, s35
    s_cmp_lg_u32 s31, 0
    s_cbranch_scc1 L_attn_kernel_nopf_33
    s_lshl_b32 s36, s35, 7
    s_lshl_b32 s29, s28, 5
    s_add_u32 s36, s36, s29
    s_lshl_b32 s39, s34, 19
    s_mov_b32 s40, s39
    v_and_b32 v2, 31, v1
    v_add_u32 v2, s36, v2
    v_lshlrev_b32 v3, 8, v2
    v_lshl_add_u32 v3, v235, 2, v3
    buffer_load_dwordx4 v[8:11], v3, s[12:15], s39 offen offset:0
    buffer_load_dwordx4 v[12:15], v3, s[12:15], s39 offen offset:32
    buffer_load_dwordx4 v[16:19], v3, s[12:15], s39 offen offset:64
    buffer_load_dwordx4 v[20:23], v3, s[12:15], s39 offen offset:96
    buffer_load_dwordx4 v[24:27], v3, s[12:15], s39 offen offset:128
    buffer_load_dwordx4 v[28:31], v3, s[12:15], s39 offen offset:160
    buffer_load_dwordx4 v[32:35], v3, s[12:15], s39 offen offset:192
    buffer_load_dwordx4 v[36:39], v3, s[12:15], s39 offen offset:224
    s_add_u32 m0, s41, 0
    s_nop 0
    buffer_load_dwordx4 v237, s[16:19], s39 offen offset:0 lds
    s_add_u32 m0, s41, 784
    s_nop 0
    buffer_load_dwordx4 v237, s[16:19], s39 offen offset:256 lds
    s_add_u32 m0, s41, 1568
    s_nop 0
    buffer_load_dwordx4 v237, s[16:19], s39 offen offset:512 lds
    s_add_u32 m0, s41, 2352
    s_nop 0
    buffer_load_dwordx4 v237, s[16:19], s39 offen offset:768 lds
    s_add_u32 s39, s39, 16384
    s_add_u32 m0, s41, 16640
    s_nop 0
    buffer_load_dwordx4 v237, s[16:19], s39 offen offset:0 lds
    s_add_u32 m0, s41, 17424
    s_nop 0
    buffer_load_dwordx4 v237, s[16:19], s39 offen offset:256 lds
    s_add_u32 m0, s41, 18208
    s_nop 0
    buffer_load_dwordx4 v237, s[16:19], s39 offen offset:512 lds
    s_add_u32 m0, s41, 18992
    s_nop 0
    buffer_load_dwordx4 v237, s[16:19], s39 offen offset:768 lds
    s_add_u32 s39, s39, 16384
    s_add_u32 m0, s41, 33280
    s_nop 0
    buffer_load_dwordx4 v238, s[20:23], s40 offen offset:0 lds
    s_add_u32 m0, s41, 34192
    s_nop 0
    buffer_load_dwordx4 v238, s[20:23], s40 offen offset:128 lds
    s_add_u32 m0, s41, 35104
    s_nop 0
    buffer_load_dwordx4 v238, s[20:23], s40 offen offset:256 lds
    s_add_u32 m0, s41, 36016
    s_nop 0
    buffer_load_dwordx4 v238, s[20:23], s40 offen offset:384 lds
    s_add_u32 s40, s40, 16384
L_attn_kernel_nopf_33:
    v_exp_f32 v136, v136
    v_exp_f32 v137, v137
    v_exp_f32 v138, v138
    v_exp_f32 v139, v139
    v_cvt_pk_bf16_f32 v168, v136, v137
    v_exp_f32 v140, v140
    v_exp_f32 v141, v141
    v_cvt_pk_bf16_f32 v169, v138, v139
    v_exp_f32 v142, v142
    v_exp_f32 v143, v143
    v_cvt_pk_bf16_f32 v170, v140, v141
    v_exp_f32 v144, v144
    v_exp_f32 v145, v145
    v_cvt_pk_bf16_f32 v171, v142, v143
    v_exp_f32 v146, v146
    v_exp_f32 v147, v147
    v_cvt_pk_bf16_f32 v172, v144, v145
    v_exp_f32 v148, v148
    v_exp_f32 v149, v149
    v_cvt_pk_bf16_f32 v173, v146, v147
    v_exp_f32 v150, v150
    v_exp_f32 v151, v151
    v_cvt_pk_bf16_f32 v174, v148, v149
    v_exp_f32 v152, v152
    v_exp_f32 v153, v153
    v_cvt_pk_bf16_f32 v175, v150, v151
    v_exp_f32 v154, v154
    v_exp_f32 v155, v155
    v_cvt_pk_bf16_f32 v176, v152, v153
    v_exp_f32 v156, v156
    v_exp_f32 v157, v157
    v_cvt_pk_bf16_f32 v177, v154, v155
    v_exp_f32 v158, v158
    v_exp_f32 v159, v159
    v_cvt_pk_bf16_f32 v178, v156, v157
    v_exp_f32 v160, v160
    v_exp_f32 v161, v161
    v_cvt_pk_bf16_f32 v179, v158, v159
    v_exp_f32 v162, v162
    v_exp_f32 v163, v163
    v_cvt_pk_bf16_f32 v180, v160, v161
    v_exp_f32 v164, v164
    v_exp_f32 v165, v165
    v_cvt_pk_bf16_f32 v181, v162, v163
    v_exp_f32 v166, v166
    v_exp_f32 v167, v167
    v_cvt_pk_bf16_f32 v182, v164, v165
    s_nop 0
    v_cvt_pk_bf16_f32 v183, v166, v167
    ds_read_b128 v[200:203], v239 offset:49920
    ds_read_b128 v[204:207], v239 offset:50432
    ds_read_b128 v[208:211], v240 offset:16640
    ds_read_b128 v[212:215], v240 offset:17152
    ds_read_b128 v[216:219], v239 offset:49952
    ds_read_b128 v[220:223], v239 offset:50464
    ds_read_b128 v[224:227], v240 offset:16672
    ds_read_b128 v[228:231], v240 offset:17184
    s_waitcnt lgkmcnt(4)
    v_mfma_f32_32x32x16_bf16 v[40:55], v[200:203], v[168:171], v[40:55]
    v_add_f32 v232, v232, v136
    v_add_f32 v233, v233, v137
    v_mfma_f32_32x32x16_bf16 v[56:71], v[204:207], v[168:171], v[56:71]
    v_add_f32 v232, v232, v138
    v_add_f32 v233, v233, v139
    v_mfma_f32_32x32x16_bf16 v[72:87], v[208:211], v[168:171], v[72:87]
    v_add_f32 v232, v232, v140
    v_add_f32 v233, v233, v141
    v_mfma_f32_32x32x16_bf16 v[88:103], v[212:215], v[168:171], v[88:103]
    ds_read_b128 v[200:203], v239 offset:49984
    ds_read_b128 v[204:207], v239 offset:50496
    ds_read_b128 v[208:211], v240 offset:16704
    ds_read_b128 v[212:215], v240 offset:17216
    v_add_f32 v232, v232, v142
    v_add_f32 v233, v233, v143
    s_waitcnt lgkmcnt(4)
    v_mfma_f32_32x32x16_bf16 v[40:55], v[216:219], v[172:175], v[40:55]
    v_add_f32 v232, v232, v144
    v_add_f32 v233, v233, v145
    v_mfma_f32_32x32x16_bf16 v[56:71], v[220:223], v[172:175], v[56:71]
    v_add_f32 v232, v232, v146
    v_add_f32 v233, v233, v147
    v_mfma_f32_32x32x16_bf16 v[72:87], v[224:227], v[172:175], v[72:87]
    v_add_f32 v232, v232, v148
    v_add_f32 v233, v233, v149
    v_mfma_f32_32x32x16_bf16 v[88:103], v[228:231], v[172:175], v[88:103]
    ds_read_b128 v[216:219], v239 offset:50016
    ds_read_b128 v[220:223], v239 offset:50528
    ds_read_b128 v[224:227], v240 offset:16736
    ds_read_b128 v[228:231], v240 offset:17248
    v_add_f32 v232, v232, v150
    v_add_f32 v233, v233, v151
    s_waitcnt lgkmcnt(4)
    v_mfma_f32_32x32x16_bf16 v[40:55], v[200:203], v[176:179], v[40:55]
    v_add_f32 v232, v232, v152
    v_add_f32 v233, v233, v153
    v_mfma_f32_32x32x16_bf16 v[56:71], v[204:207], v[176:179], v[56:71]
    v_add_f32 v232, v232, v154
    v_add_f32 v233, v233, v155
    v_mfma_f32_32x32x16_bf16 v[72:87], v[208:211], v[176:179], v[72:87]
    v_add_f32 v232, v232, v156
    v_add_f32 v233, v233, v157
    v_mfma_f32_32x32x16_bf16 v[88:103], v[212:215], v[176:179], v[88:103]
    v_add_f32 v232, v232, v158
    v_add_f32 v233, v233, v159
    s_waitcnt lgkmcnt(0)
    v_mfma_f32_32x32x16_bf16 v[40:55], v[216:219], v[180:183], v[40:55]
    v_add_f32 v232, v232, v160
    v_add_f32 v233, v233, v161
    v_mfma_f32_32x32x16_bf16 v[56:71], v[220:223], v[180:183], v[56:71]
    v_add_f32 v232, v232, v162
    v_add_f32 v233, v233, v163
    v_mfma_f32_32x32x16_bf16 v[72:87], v[224:227], v[180:183], v[72:87]
    v_add_f32 v232, v232, v164
    v_add_f32 v233, v233, v165
    v_mfma_f32_32x32x16_bf16 v[88:103], v[228:231], v[180:183], v[88:103]
    v_add_f32 v232, v232, v166
    v_add_f32 v233, v233, v167
    s_nop 15
    v_lshrrev_b32 v2, 7, v234
    v_lshlrev_b32 v236, 20, v2
    v_and_b32 v2, 127, v234
    v_lshl_add_u32 v236, v2, 7, v236
    v_lshl_add_u32 v236, v235, 2, v236
    s_lshl_b32 s29, s34, 15
    s_add_u32 s30, s29, 16384
    v_add_f32 v2, v232, v233
    v_mov_b32 v3, v2
    s_nop 1
    v_permlane32_swap_b32 v2, v3
    s_nop 1
    v_add_f32 v2, v2, v3
    v_rcp_f32 v2, v2
    s_nop 0
    v_mul_f32 v40, v40, v2
    v_mul_f32 v41, v41, v2
    v_mul_f32 v42, v42, v2
    v_mul_f32 v43, v43, v2
    v_mul_f32 v44, v44, v2
    v_mul_f32 v45, v45, v2
    v_mul_f32 v46, v46, v2
    v_mul_f32 v47, v47, v2
    v_mul_f32 v48, v48, v2
    v_mul_f32 v49, v49, v2
    v_mul_f32 v50, v50, v2
    v_mul_f32 v51, v51, v2
    v_mul_f32 v52, v52, v2
    v_mul_f32 v53, v53, v2
    v_mul_f32 v54, v54, v2
    v_mul_f32 v55, v55, v2
    v_cvt_pk_bf16_f32 v40, v40, v41
    v_cvt_pk_bf16_f32 v41, v42, v43
    v_cvt_pk_bf16_f32 v42, v44, v45
    v_cvt_pk_bf16_f32 v43, v46, v47
    v_cvt_pk_bf16_f32 v44, v48, v49
    v_cvt_pk_bf16_f32 v45, v50, v51
    v_cvt_pk_bf16_f32 v46, v52, v53
    v_cvt_pk_bf16_f32 v47, v54, v55
    s_nop 1
    v_permlane32_swap_b32 v40, v42
    v_permlane32_swap_b32 v41, v43
    v_permlane32_swap_b32 v44, v46
    v_permlane32_swap_b32 v45, v47
    s_nop 1
    buffer_store_dwordx4 v[40:43], v236, s[24:27], s29 offen offset:0
    buffer_store_dwordx4 v[44:47], v236, s[24:27], s29 offen offset:32
    v_mul_f32 v56, v56, v2
    v_mul_f32 v57, v57, v2
    v_mul_f32 v58, v58, v2
    v_mul_f32 v59, v59, v2
    v_mul_f32 v60, v60, v2
    v_mul_f32 v61, v61, v2
    v_mul_f32 v62, v62, v2
    v_mul_f32 v63, v63, v2
    v_mul_f32 v64, v64, v2
    v_mul_f32 v65, v65, v2
    v_mul_f32 v66, v66, v2
    v_mul_f32 v67, v67, v2
    v_mul_f32 v68, v68, v2
    v_mul_f32 v69, v69, v2
    v_mul_f32 v70, v70, v2
    v_mul_f32 v71, v71, v2
    v_cvt_pk_bf16_f32 v56, v56, v57
    v_cvt_pk_bf16_f32 v57, v58, v59
    v_cvt_pk_bf16_f32 v58, v60, v61
    v_cvt_pk_bf16_f32 v59, v62, v63
    v_cvt_pk_bf16_f32 v60, v64, v65
    v_cvt_pk_bf16_f32 v61, v66, v67
    v_cvt_pk_bf16_f32 v62, v68, v69
    v_cvt_pk_bf16_f32 v63, v70, v71
    s_nop 1
    v_permlane32_swap_b32 v56, v58
    v_permlane32_swap_b32 v57, v59
    v_permlane32_swap_b32 v60, v62
    v_permlane32_swap_b32 v61, v63
    s_nop 1
    buffer_store_dwordx4 v[56:59], v236, s[24:27], s29 offen offset:64
    buffer_store_dwordx4 v[60:63], v236, s[24:27], s29 offen offset:96
    v_mul_f32 v72, v72, v2
    v_mul_f32 v73, v73, v2
    v_mul_f32 v74, v74, v2
    v_mul_f32 v75, v75, v2
    v_mul_f32 v76, v76, v2
    v_mul_f32 v77, v77, v2
    v_mul_f32 v78, v78, v2
    v_mul_f32 v79, v79, v2
    v_mul_f32 v80, v80, v2
    v_mul_f32 v81, v81, v2
    v_mul_f32 v82, v82, v2
    v_mul_f32 v83, v83, v2
    v_mul_f32 v84, v84, v2
    v_mul_f32 v85, v85, v2
    v_mul_f32 v86, v86, v2
    v_mul_f32 v87, v87, v2
    v_cvt_pk_bf16_f32 v72, v72, v73
    v_cvt_pk_bf16_f32 v73, v74, v75
    v_cvt_pk_bf16_f32 v74, v76, v77
    v_cvt_pk_bf16_f32 v75, v78, v79
    v_cvt_pk_bf16_f32 v76, v80, v81
    v_cvt_pk_bf16_f32 v77, v82, v83
    v_cvt_pk_bf16_f32 v78, v84, v85
    v_cvt_pk_bf16_f32 v79, v86, v87
    s_nop 1
    v_permlane32_swap_b32 v72, v74
    v_permlane32_swap_b32 v73, v75
    v_permlane32_swap_b32 v76, v78
    v_permlane32_swap_b32 v77, v79
    s_nop 1
    buffer_store_dwordx4 v[72:75], v236, s[24:27], s30 offen offset:0
    buffer_store_dwordx4 v[76:79], v236, s[24:27], s30 offen offset:32
    v_mul_f32 v88, v88, v2
    v_mul_f32 v89, v89, v2
    v_mul_f32 v90, v90, v2
    v_mul_f32 v91, v91, v2
    v_mul_f32 v92, v92, v2
    v_mul_f32 v93, v93, v2
    v_mul_f32 v94, v94, v2
    v_mul_f32 v95, v95, v2
    v_mul_f32 v96, v96, v2
    v_mul_f32 v97, v97, v2
    v_mul_f32 v98, v98, v2
    v_mul_f32 v99, v99, v2
    v_mul_f32 v100, v100, v2
    v_mul_f32 v101, v101, v2
    v_mul_f32 v102, v102, v2
    v_mul_f32 v103, v103, v2
    v_cvt_pk_bf16_f32 v88, v88, v89
    v_cvt_pk_bf16_f32 v89, v90, v91
    v_cvt_pk_bf16_f32 v90, v92, v93
    v_cvt_pk_bf16_f32 v91, v94, v95
    v_cvt_pk_bf16_f32 v92, v96, v97
    v_cvt_pk_bf16_f32 v93, v98, v99
    v_cvt_pk_bf16_f32 v94, v100, v101
    v_cvt_pk_bf16_f32 v95, v102, v103
    s_nop 1
    v_permlane32_swap_b32 v88, v90
    v_permlane32_swap_b32 v89, v91
    v_permlane32_swap_b32 v92, v94
    v_permlane32_swap_b32 v93, v95
    s_nop 1
    buffer_store_dwordx4 v[88:91], v236, s[24:27], s30 offen offset:64
    buffer_store_dwordx4 v[92:95], v236, s[24:27], s30 offen offset:96
    s_nop 1
    s_add_u32 s31, s31, 1
    s_cmp_lt_u32 s31, 2
    s_cbranch_scc1 L_attn_kernel_btop_20
    s_branch L_attn_kernel_end_1
L_attn_kernel_attnA_19:
    s_sub_u32 s28, s32, 4
    s_add_u32 s12, s4, 0x4000000
    s_addc_u32 s13, s5, 0
    s_and_b32 s13, s13, 0xffff
    s_mov_b32 s14, 0x400000
    s_mov_b32 s15, 0x20000
    s_add_u32 s16, s4, 0x4800000
    s_addc_u32 s17, s5, 0
    s_and_b32 s17, s17, 0xffff
    s_mov_b32 s18, 0x20000
    s_mov_b32 s19, 0x20000
    s_add_u32 s20, s4, 0x4900000
    s_addc_u32 s21, s5, 0
    s_and_b32 s21, s21, 0xffff
    s_mov_b32 s22, 0x20000
    s_mov_b32 s23, 0x20000
    s_add_u32 s24, s4, 0x4400000
    s_addc_u32 s25, s5, 0
    s_and_b32 s25, s25, 0xffff
    s_mov_b32 s26, 0x400000
    s_mov_b32 s27, 0x20000
L_attn_kernel_atop_34:
    s_and_b32 s35, s2, 15
    s_lshr_b32 s34, s2, 4
    s_lshl_b32 s34, s34, 1
    s_add_u32 s34, s34, s31
    s_lshl_b32 s35, s35, 7
    s_lshl_b32 s29, s28, 5
    s_add_u32 s35, s35, s29
    s_lshl_b32 s38, s34, 6
    v_and_b32 v2, 31, v1
    v_lshrrev_b32 v4, 5, v1
    v_add_u32 v3, s35, v2
    v_lshlrev_b32 v3, 11, v3
    v_lshl_add_u32 v180, v4, 4, v3
    buffer_load_dwordx4 v[8:11], v180, s[12:15], s38 offen offset:0
    buffer_load_dwordx4 v[12:15], v180, s[12:15], s38 offen offset:32
    v_bfe_u32 v3, v1, 2, 2
    v_xor_b32 v3, v3, v4
    v_lshlrev_b32 v2, 6, v2
    v_xor_b32 v4, 0, v3
    v_lshl_add_u32 v182, v4, 4, v2
    v_xor_b32 v4, 2, v3
    v_lshl_add_u32 v183, v4, 4, v2
    v_lshrrev_b32 v2, 2, v1
    v_lshrrev_b32 v3, 4, v1
    v_xor_b32 v3, v3, v1
    v_and_b32 v3, 3, v3
    v_lshlrev_b32 v2, 6, v2
    v_lshl_add_u32 v2, v3, 4, v2
    s_lshl_b32 s42, s28, 11
    v_add_u32 v181, s42, v2
    s_mov_b32 s36, 0
    s_mov_b32 s37, 0
    s_mov_b32 s39, 66560
    s_mov_b32 s40, 66560
    s_mov_b32 s41, 82944
    s_add_u32 s29, s39, s42
    s_mov_b32 m0, s29
    s_nop 0
    buffer_load_dwordx4 v181, s[16:19], s37 offen offset:0 lds
    s_mov_b32 m0, s29
    s_nop 0
    buffer_load_dwordx4 v181, s[16:19], s37 offen offset:1024 lds
    s_add_u32 m0, s29, 8192
    s_nop 0
    buffer_load_dwordx4 v181, s[20:23], s37 offen offset:0 lds
    s_add_u32 m0, s29, 8192
    s_nop 0
    buffer_load_dwordx4 v181, s[20:23], s37 offen offset:1024 lds
    s_add_u32 s37, s37, 8192
    s_add_u32 s39, s39, 16384
    s_cmp_eq_u32 s39, 115712
    s_cselect_b32 s39, 66560, s39
    s_add_u32 s29, s39, s42
    s_mov_b32 m0, s29
    s_nop 0
    buffer_load_dwordx4 v181, s[16:19], s37 offen offset:0 lds
    s_mov_b32 m0, s29
    s_nop 0
    buffer_load_dwordx4 v181, s[16:19], s37 offen offset:1024 lds
    s_add_u32 m0, s29, 8192
    s_nop 0
    buffer_load_dwordx4 v181, s[20:23], s37 offen offset:0 lds
    s_add_u32 m0, s29, 8192
    s_nop 0
    buffer_load_dwordx4 v181, s[20:23], s37 offen offset:1024 lds
    s_add_u32 s37, s37, 8192
    s_add_u32 s39, s39, 16384
    s_cmp_eq_u32 s39, 115712
    s_cselect_b32 s39, 66560, s39
    v_mov_b32 v16, 0
    v_mov_b32 v32, 0
    v_mov_b32 v17, 0
    v_mov_b32 v33, 0
    v_mov_b32 v18, 0
    v_mov_b32 v34, 0
    v_mov_b32 v19, 0
    v_mov_b32 v35, 0
    v_mov_b32 v20, 0
    v_mov_b32 v36, 0
    v_mov_b32 v21, 0
    v_mov_b32 v37, 0
    v_mov_b32 v22, 0
    v_mov_b32 v38, 0
    v_mov_b32 v23, 0
    v_mov_b32 v39, 0
    v_mov_b32 v24, 0
    v_mov_b32 v40, 0
    v_mov_b32 v25, 0
    v_mov_b32 v41, 0
    v_mov_b32 v26, 0
    v_mov_b32 v42, 0
    v_mov_b32 v27, 0
    v_mov_b32 v43, 0
    v_mov_b32 v28, 0
    v_mov_b32 v44, 0
    v_mov_b32 v29, 0
    v_mov_b32 v45, 0
    v_mov_b32 v30, 0
    v_mov_b32 v46, 0
    v_mov_b32 v31, 0
    v_mov_b32 v47, 0
    v_mov_b32 v176, 0x3f803f80
    v_mov_b32 v177, 0x3f803f80
    v_mov_b32 v178, 0x3f803f80
    v_mov_b32 v179, 0x3f803f80
    s_waitcnt vmcnt(0)
    s_barrier
    v_add_u32 v184, s40, v182
    v_add_u32 v186, s41, v182
    v_add_u32 v185, s40, v183
    v_add_u32 v187, s41, v183
    ds_read_b128 v[144:147], v184 offset:0
    ds_read_b128 v[148:151], v185 offset:0
    ds_read_b128 v[152:155], v184 offset:2048
    ds_read_b128 v[156:159], v185 offset:2048
    s_waitcnt lgkmcnt(0)
    v_mfma_f32_32x32x16_bf16 v[48:63], v[144:147], v[8:11], 0
    v_mfma_f32_32x32x16_bf16 v[48:63], v[148:151], v[12:15], v[48:63]
    v_mfma_f32_32x32x16_bf16 v[64:79], v[152:155], v[8:11], 0
    v_mfma_f32_32x32x16_bf16 v[64:79], v[156:159], v[12:15], v[64:79]
    s_nop 15
    v_max3_f32 v2, v48, v49, v50
    v_max3_f32 v2, v2, v51, v52
    v_max3_f32 v2, v2, v53, v54
    v_max3_f32 v2, v2, v55, v56
    v_max3_f32 v2, v2, v57, v58
    v_max3_f32 v2, v2, v59, v60
    v_max3_f32 v2, v2, v61, v62
    v_max3_f32 v2, v2, v63, v64
    v_max3_f32 v2, v2, v65, v66
    v_max3_f32 v2, v2, v67, v68
    v_max3_f32 v2, v2, v69, v70
    v_max3_f32 v2, v2, v71, v72
    v_max3_f32 v2, v2, v73, v74
    v_max3_f32 v2, v2, v75, v76
    v_max3_f32 v2, v2, v77, v78
    v_max_f32 v2, v2, v79
    v_mov_b32 v3, v2
    s_nop 1
    v_permlane32_swap_b32 v2, v3
    s_nop 1
    v_max_f32 v2, v2, v3
    v_sub_f32 v48, v48, v2
    v_sub_f32 v49, v49, v2
    v_sub_f32 v50, v50, v2
    v_sub_f32 v51, v51, v2
    v_sub_f32 v52, v52, v2
    v_sub_f32 v53, v53, v2
    v_sub_f32 v54, v54, v2
    v_sub_f32 v55, v55, v2
    v_sub_f32 v56, v56, v2
    v_sub_f32 v57, v57, v2
    v_sub_f32 v58, v58, v2
    v_sub_f32 v59, v59, v2
    v_sub_f32 v60, v60, v2
    v_sub_f32 v61, v61, v2
    v_sub_f32 v62, v62, v2
    v_sub_f32 v63, v63, v2
    v_sub_f32 v64, v64, v2
    v_sub_f32 v65, v65, v2
    v_sub_f32 v66, v66, v2
    v_sub_f32 v67, v67, v2
    v_sub_f32 v68, v68, v2
    v_sub_f32 v69, v69, v2
    v_sub_f32 v70, v70, v2
    v_sub_f32 v71, v71, v2
    v_sub_f32 v72, v72, v2
    v_sub_f32 v73, v73, v2
    v_sub_f32 v74, v74, v2
    v_sub_f32 v75, v75, v2
    v_sub_f32 v76, v76, v2
    v_sub_f32 v77, v77, v2
    v_sub_f32 v78, v78, v2
    v_sub_f32 v79, v79, v2
    v_sub_f32 v3, 0, v2
    v_mov_b32 v128, v3
    v_mov_b32 v129, v3
    v_mov_b32 v130, v3
    v_mov_b32 v131, v3
    v_mov_b32 v132, v3
    v_mov_b32 v133, v3
    v_mov_b32 v134, v3
    v_mov_b32 v135, v3
    v_mov_b32 v136, v3
    v_mov_b32 v137, v3
    v_mov_b32 v138, v3
    v_mov_b32 v139, v3
    v_mov_b32 v140, v3
    v_mov_b32 v141, v3
    v_mov_b32 v142, v3
    v_mov_b32 v143, v3
    s_barrier
L_attn_kernel_aloop_35:
    ds_read_b128 v[144:147], v184 offset:4096
    ds_read_b128 v[148:151], v185 offset:4096
    ds_read_b128 v[152:155], v184 offset:6144
    ds_read_b128 v[156:159], v185 offset:6144
    ds_read_b128 v[160:163], v184 offset:8192
    ds_read_b128 v[164:167], v185 offset:8192
    ds_read_b128 v[168:171], v184 offset:10240
    ds_read_b128 v[172:175], v185 offset:10240
    s_waitcnt lgkmcnt(4)
    v_mfma_f32_32x32x16_bf16 v[80:95], v[144:147], v[8:11], v[128:143]
    v_mfma_f32_32x32x16_bf16 v[80:95], v[148:151], v[12:15], v[80:95]
    v_mfma_f32_32x32x16_bf16 v[96:111], v[152:155], v[8:11], v[128:143]
    v_mfma_f32_32x32x16_bf16 v[96:111], v[156:159], v[12:15], v[96:111]
    v_exp_f32 v48, v48
    v_exp_f32 v49, v49
    v_exp_f32 v50, v50
    v_exp_f32 v51, v51
    v_cvt_pk_bf16_f32 v112, v48, v49
    v_exp_f32 v52, v52
    v_exp_f32 v53, v53
    v_cvt_pk_bf16_f32 v113, v50, v51
    v_exp_f32 v54, v54
    v_exp_f32 v55, v55
    v_cvt_pk_bf16_f32 v114, v52, v53
    v_exp_f32 v56, v56
    v_exp_f32 v57, v57
    v_cvt_pk_bf16_f32 v115, v54, v55
    v_exp_f32 v58, v58
    v_exp_f32 v59, v59
    v_cvt_pk_bf16_f32 v116, v56, v57
    v_exp_f32 v60, v60
    v_exp_f32 v61, v61
    v_cvt_pk_bf16_f32 v117, v58, v59
    v_exp_f32 v62, v62
    v_exp_f32 v63, v63
    v_cvt_pk_bf16_f32 v118, v60, v61
    v_exp_f32 v64, v64
    v_exp_f32 v65, v65
    v_cvt_pk_bf16_f32 v119, v62, v63
    v_exp_f32 v66, v66
    v_exp_f32 v67, v67
    v_cvt_pk_bf16_f32 v120, v64, v65
    v_exp_f32 v68, v68
    v_exp_f32 v69, v69
    v_cvt_pk_bf16_f32 v121, v66, v67
    v_exp_f32 v70, v70
    v_exp_f32 v71, v71
    v_cvt_pk_bf16_f32 v122, v68, v69
    v_exp_f32 v72, v72
    v_exp_f32 v73, v73
    v_cvt_pk_bf16_f32 v123, v70, v71
    s_add_u32 s29, s39, s42
    v_exp_f32 v74, v74
    v_exp_f32 v75, v75
    v_cvt_pk_bf16_f32 v124, v72, v73
    s_mov_b32 m0, s29
    s_nop 0
    buffer_load_dwordx4 v181, s[16:19], s37 offen offset:0 lds
    v_exp_f32 v76, v76
    v_exp_f32 v77, v77
    v_cvt_pk_bf16_f32 v125, v74, v75
    s_mov_b32 m0, s29
    s_nop 0
    buffer_load_dwordx4 v181, s[16:19], s37 offen offset:1024 lds
    v_exp_f32 v78, v78
    v_exp_f32 v79, v79
    v_cvt_pk_bf16_f32 v126, v76, v77
    s_add_u32 m0, s29, 8192
    s_nop 0
    buffer_load_dwordx4 v181, s[20:23], s37 offen offset:0 lds
    s_add_u32 m0, s29, 8192
    s_nop 0
    buffer_load_dwordx4 v181, s[20:23], s37 offen offset:1024 lds
    s_add_u32 s37, s37, 8192
    s_add_u32 s39, s39, 16384
    s_cmp_eq_u32 s39, 115712
    s_cselect_b32 s39, 66560, s39
    s_nop 0
    v_cvt_pk_bf16_f32 v127, v78, v79
    s_waitcnt lgkmcnt(0)
    s_nop 0
    v_mfma_f32_32x32x16_bf16 v[16:31], v[160:163], v[112:115], v[16:31]
    v_mfma_f32_32x32x16_bf16 v[32:47], v[176:179], v[112:115], v[32:47]
    v_mfma_f32_32x32x16_bf16 v[16:31], v[164:167], v[116:119], v[16:31]
    v_mfma_f32_32x32x16_bf16 v[32:47], v[176:179], v[116:119], v[32:47]
    v_mfma_f32_32x32x16_bf16 v[16:31], v[168:171], v[120:123], v[16:31]
    v_mfma_f32_32x32x16_bf16 v[32:47], v[176:179], v[120:123], v[32:47]
    v_mfma_f32_32x32x16_bf16 v[16:31], v[172:175], v[124:127], v[16:31]
    v_mfma_f32_32x32x16_bf16 v[32:47], v[176:179], v[124:127], v[32:47]
    v_max3_f32 v2, v80, v81, v82
    v_max3_f32 v2, v2, v83, v84
    v_max3_f32 v2, v2, v85, v86
    v_max3_f32 v2, v2, v87, v88
    v_max3_f32 v2, v2, v89, v90
    v_max3_f32 v2, v2, v91, v92
    v_max3_f32 v2, v2, v93, v94
    v_max3_f32 v2, v2, v95, v96
    v_max3_f32 v2, v2, v97, v98
    v_max3_f32 v2, v2, v99, v100
    v_max3_f32 v2, v2, v101, v102
    v_max3_f32 v2, v2, v103, v104
    v_max3_f32 v2, v2, v105, v106
    v_max3_f32 v2, v2, v107, v108
    v_max3_f32 v2, v2, v109, v110
    v_max_f32 v2, v2, v111
    v_mov_b32 v3, v2
    s_nop 1
    v_permlane32_swap_b32 v2, v3
    s_nop 1
    v_max_f32 v2, v2, v3
    v_cmp_lt_f32 vcc, 0x42000000, v2
    s_cbranch_vccz L_attn_kernel_nors_36
    v_max_f32 v2, 0, v2
    v_sub_f32 v3, 0, v2
    v_exp_f32 v3, v3
    v_sub_f32 v80, v80, v2
    v_sub_f32 v81, v81, v2
    v_sub_f32 v82, v82, v2
    v_sub_f32 v83, v83, v2
    v_sub_f32 v84, v84, v2
    v_sub_f32 v85, v85, v2
    v_sub_f32 v86, v86, v2
    v_sub_f32 v87, v87, v2
    v_sub_f32 v88, v88, v2
    v_sub_f32 v89, v89, v2
    v_sub_f32 v90, v90, v2
    v_sub_f32 v91, v91, v2
    v_sub_f32 v92, v92, v2
    v_sub_f32 v93, v93, v2
    v_sub_f32 v94, v94, v2
    v_sub_f32 v95, v95, v2
    v_sub_f32 v96, v96, v2
    v_sub_f32 v97, v97, v2
    v_sub_f32 v98, v98, v2
    v_sub_f32 v99, v99, v2
    v_sub_f32 v100, v100, v2
    v_sub_f32 v101, v101, v2
    v_sub_f32 v102, v102, v2
    v_sub_f32 v103, v103, v2
    v_sub_f32 v104, v104, v2
    v_sub_f32 v105, v105, v2
    v_sub_f32 v106, v106, v2
    v_sub_f32 v107, v107, v2
    v_sub_f32 v108, v108, v2
    v_sub_f32 v109, v109, v2
    v_sub_f32 v110, v110, v2
    v_sub_f32 v111, v111, v2
    v_sub_f32 v128, v128, v2
    v_sub_f32 v129, v129, v2
    v_sub_f32 v130, v130, v2
    v_sub_f32 v131, v131, v2
    v_sub_f32 v132, v132, v2
    v_sub_f32 v133, v133, v2
    v_sub_f32 v134, v134, v2
    v_sub_f32 v135, v135, v2
    v_sub_f32 v136, v136, v2
    v_sub_f32 v137, v137, v2
    v_sub_f32 v138, v138, v2
    v_sub_f32 v139, v139, v2
    v_sub_f32 v140, v140, v2
    v_sub_f32 v141, v141, v2
    v_sub_f32 v142, v142, v2
    v_sub_f32 v143, v143, v2
    s_nop 7
    v_mul_f32 v32, v32, v3
    v_mul_f32 v16, v16, v3
    v_mul_f32 v17, v17, v3
    v_mul_f32 v18, v18, v3
    v_mul_f32 v19, v19, v3
    v_mul_f32 v20, v20, v3
    v_mul_f32 v21, v21, v3
    v_mul_f32 v22, v22, v3
    v_mul_f32 v23, v23, v3
    v_mul_f32 v24, v24, v3
    v_mul_f32 v25, v25, v3
    v_mul_f32 v26, v26, v3
    v_mul_f32 v27, v27, v3
    v_mul_f32 v28, v28, v3
    v_mul_f32 v29, v29, v3
    v_mul_f32 v30, v30, v3
    v_mul_f32 v31, v31, v3
    s_nop 1
L_attn_kernel_nors_36:
    ds_read_b128 v[144:147], v186 offset:0
    ds_read_b128 v[148:151], v187 offset:0
    ds_read_b128 v[152:155], v186 offset:2048
    ds_read_b128 v[156:159], v187 offset:2048
    ds_read_b128 v[160:163], v184 offset:12288
    ds_read_b128 v[164:167], v185 offset:12288
    ds_read_b128 v[168:171], v184 offset:14336
    ds_read_b128 v[172:175], v185 offset:14336
    s_waitcnt lgkmcnt(4)
    v_mfma_f32_32x32x16_bf16 v[48:63], v[144:147], v[8:11], v[128:143]
    v_mfma_f32_32x32x16_bf16 v[48:63], v[148:151], v[12:15], v[48:63]
    v_mfma_f32_32x32x16_bf16 v[64:79], v[152:155], v[8:11], v[128:143]
    v_mfma_f32_32x32x16_bf16 v[64:79], v[156:159], v[12:15], v[64:79]
    v_exp_f32 v80, v80
    v_exp_f32 v81, v81
    v_exp_f32 v82, v82
    v_exp_f32 v83, v83
    v_cvt_pk_bf16_f32 v112, v80, v81
    v_exp_f32 v84, v84
    v_exp_f32 v85, v85
    v_cvt_pk_bf16_f32 v113, v82, v83
    v_exp_f32 v86, v86
    v_exp_f32 v87, v87
    v_cvt_pk_bf16_f32 v114, v84, v85
    v_exp_f32 v88, v88
    v_exp_f32 v89, v89
    v_cvt_pk_bf16_f32 v115, v86, v87
    v_exp_f32 v90, v90
    v_exp_f32 v91, v91
    v_cvt_pk_bf16_f32 v116, v88, v89
    v_exp_f32 v92, v92
    v_exp_f32 v93, v93
    v_cvt_pk_bf16_f32 v117, v90, v91
    v_exp_f32 v94, v94
    v_exp_f32 v95, v95
    v_cvt_pk_bf16_f32 v118, v92, v93
    v_exp_f32 v96, v96
    v_exp_f32 v97, v97
    v_cvt_pk_bf16_f32 v119, v94, v95
    v_exp_f32 v98, v98
    v_exp_f32 v99, v99
    v_cvt_pk_bf16_f32 v120, v96, v97
    v_exp_f32 v100, v100
    v_exp_f32 v101, v101
    v_cvt_pk_bf16_f32 v121, v98, v99
    v_exp_f32 v102, v102
    v_exp_f32 v103, v103
    v_cvt_pk_bf16_f32 v122, v100, v101
    v_exp_f32 v104, v104
    v_exp_f32 v105, v105
    v_cvt_pk_bf16_f32 v123, v102, v103
    v_exp_f32 v106, v106
    v_exp_f32 v107, v107
    v_cvt_pk_bf16_f32 v124, v104, v105
    v_exp_f32 v108, v108
    v_exp_f32 v109, v109
    v_cvt_pk_bf16_f32 v125, v106, v107
    v_exp_f32 v110, v110
    v_exp_f32 v111, v111
    v_cvt_pk_bf16_f32 v126, v108, v109
    s_nop 0
    v_cvt_pk_bf16_f32 v127, v110, v111
    s_waitcnt lgkmcnt(0)
    s_nop 0
    v_mfma_f32_32x32x16_bf16 v[16:31], v[160:163], v[112:115], v[16:31]
    v_mfma_f32_32x32x16_bf16 v[32:47], v[176:179], v[112:115], v[32:47]
    v_mfma_f32_32x32x16_bf16 v[16:31], v[164:167], v[116:119], v[16:31]
    v_mfma_f32_32x32x16_bf16 v[32:47], v[176:179], v[116:119], v[32:47]
    v_mfma_f32_32x32x16_bf16 v[16:31], v[168:171], v[120:123], v[16:31]
    v_mfma_f32_32x32x16_bf16 v[32:47], v[176:179], v[120:123], v[32:47]
    v_mfma_f32_32x32x16_bf16 v[16:31], v[172:175], v[124:127], v[16:31]
    v_mfma_f32_32x32x16_bf16 v[32:47], v[176:179], v[124:127], v[32:47]
    v_max3_f32 v2, v48, v49, v50
    v_max3_f32 v2, v2, v51, v52
    v_max3_f32 v2, v2, v53, v54
    v_max3_f32 v2, v2, v55, v56
    v_max3_f32 v2, v2, v57, v58
    v_max3_f32 v2, v2, v59, v60
    v_max3_f32 v2, v2, v61, v62
    v_max3_f32 v2, v2, v63, v64
    v_max3_f32 v2, v2, v65, v66
    v_max3_f32 v2, v2, v67, v68
    v_max3_f32 v2, v2, v69, v70
    v_max3_f32 v2, v2, v71, v72
    v_max3_f32 v2, v2, v73, v74
    v_max3_f32 v2, v2, v75, v76
    v_max3_f32 v2, v2, v77, v78
    v_max_f32 v2, v2, v79
    v_mov_b32 v3, v2
    s_nop 1
    v_permlane32_swap_b32 v2, v3
    s_nop 1
    v_max_f32 v2, v2, v3
    v_cmp_lt_f32 vcc, 0x42000000, v2
    s_cbranch_vccz L_attn_kernel_nors_37
    v_max_f32 v2, 0, v2
    v_sub_f32 v3, 0, v2
    v_exp_f32 v3, v3
    v_sub_f32 v48, v48, v2
    v_sub_f32 v49, v49, v2
    v_sub_f32 v50, v50, v2
    v_sub_f32 v51, v51, v2
    v_sub_f32 v52, v52, v2
    v_sub_f32 v53, v53, v2
    v_sub_f32 v54, v54, v2
    v_sub_f32 v55, v55, v2
    v_sub_f32 v56, v56, v2
    v_sub_f32 v57, v57, v2
    v_sub_f32 v58, v58, v2
    v_sub_f32 v59, v59, v2
    v_sub_f32 v60, v60, v2
    v_sub_f32 v61, v61, v2
    v_sub_f32 v62, v62, v2
    v_sub_f32 v63, v63, v2
    v_sub_f32 v64, v64, v2
    v_sub_f32 v65, v65, v2
    v_sub_f32 v66, v66, v2
    v_sub_f32 v67, v67, v2
    v_sub_f32 v68, v68, v2
    v_sub_f32 v69, v69, v2
    v_sub_f32 v70, v70, v2
    v_sub_f32 v71, v71, v2
    v_sub_f32 v72, v72, v2
    v_sub_f32 v73, v73, v2
    v_sub_f32 v74, v74, v2
    v_sub_f32 v75, v75, v2
    v_sub_f32 v76, v76, v2
    v_sub_f32 v77, v77, v2
    v_sub_f32 v78, v78, v2
    v_sub_f32 v79, v79, v2
    v_sub_f32 v128, v128, v2
    v_sub_f32 v129, v129, v2
    v_sub_f32 v130, v130, v2
    v_sub_f32 v131, v131, v2
    v_sub_f32 v132, v132, v2
    v_sub_f32 v133, v133, v2
    v_sub_f32 v134, v134, v2
    v_sub_f32 v135, v135, v2
    v_sub_f32 v136, v136, v2
    v_sub_f32 v137, v137, v2
    v_sub_f32 v138, v138, v2
    v_sub_f32 v139, v139, v2
    v_sub_f32 v140, v140, v2
    v_sub_f32 v141, v141, v2
    v_sub_f32 v142, v142, v2
    v_sub_f32 v143, v143, v2
    s_nop 7
    v_mul_f32 v32, v32, v3
    v_mul_f32 v16, v16, v3
    v_mul_f32 v17, v17, v3
    v_mul_f32 v18, v18, v3
    v_mul_f32 v19, v19, v3
    v_mul_f32 v20, v20, v3
    v_mul_f32 v21, v21, v3
    v_mul_f32 v22, v22, v3
    v_mul_f32 v23, v23, v3
    v_mul_f32 v24, v24, v3
    v_mul_f32 v25, v25, v3
    v_mul_f32 v26, v26, v3
    v_mul_f32 v27, v27, v3
    v_mul_f32 v28, v28, v3
    v_mul_f32 v29, v29, v3
    v_mul_f32 v30, v30, v3
    v_mul_f32 v31, v31, v3
    s_nop 1
L_attn_kernel_nors_37:
    s_mov_b32 s40, s41
    s_add_u32 s41, s41, 16384
    s_cmp_eq_u32 s41, 115712
    s_cselect_b32 s41, 66560, s41
    v_add_u32 v184, s40, v182
    v_add_u32 v186, s41, v182
    v_add_u32 v185, s40, v183
    v_add_u32 v187, s41, v183
    s_add_u32 s36, s36, 1
    s_waitcnt vmcnt(0) lgkmcnt(0)
    s_barrier
    s_cmp_lt_u32 s36, 15
    s_cbranch_scc1 L_attn_kernel_aloop_35
    ds_read_b128 v[144:147], v184 offset:4096
    ds_read_b128 v[148:151], v185 offset:4096
    ds_read_b128 v[152:155], v184 offset:6144
    ds_read_b128 v[156:159], v185 offset:6144
    ds_read_b128 v[160:163], v184 offset:8192
    ds_read_b128 v[164:167], v185 offset:8192
    ds_read_b128 v[168:171], v184 offset:10240
    ds_read_b128 v[172:175], v185 offset:10240
    s_waitcnt lgkmcnt(4)
    v_mfma_f32_32x32x16_bf16 v[80:95], v[144:147], v[8:11], v[128:143]
    v_mfma_f32_32x32x16_bf16 v[80:95], v[148:151], v[12:15], v[80:95]
    v_mfma_f32_32x32x16_bf16 v[96:111], v[152:155], v[8:11], v[128:143]
    v_mfma_f32_32x32x16_bf16 v[96:111], v[156:159], v[12:15], v[96:111]
    v_exp_f32 v48, v48
    v_exp_f32 v49, v49
    v_exp_f32 v50, v50
    v_exp_f32 v51, v51
    v_cvt_pk_bf16_f32 v112, v48, v49
    v_exp_f32 v52, v52
    v_exp_f32 v53, v53
    v_cvt_pk_bf16_f32 v113, v50, v51
    v_exp_f32 v54, v54
    v_exp_f32 v55, v55
    v_cvt_pk_bf16_f32 v114, v52, v53
    v_exp_f32 v56, v56
    v_exp_f32 v57, v57
    v_cvt_pk_bf16_f32 v115, v54, v55
    v_exp_f32 v58, v58
    v_exp_f32 v59, v59
    v_cvt_pk_bf16_f32 v116, v56, v57
    v_exp_f32 v60, v60
    v_exp_f32 v61, v61
    v_cvt_pk_bf16_f32 v117, v58, v59
    v_exp_f32 v62, v62
    v_exp_f32 v63, v63
    v_cvt_pk_bf16_f32 v118, v60, v61
    v_exp_f32 v64, v64
    v_exp_f32 v65, v65
    v_cvt_pk_bf16_f32 v119, v62, v63
    v_exp_f32 v66, v66
    v_exp_f32 v67, v67
    v_cvt_pk_bf16_f32 v120, v64, v65
    v_exp_f32 v68, v68
    v_exp_f32 v69, v69
    v_cvt_pk_bf16_f32 v121, v66, v67
    v_exp_f32 v70, v70
    v_exp_f32 v71, v71
    v_cvt_pk_bf16_f32 v122, v68, v69
    v_exp_f32 v72, v72
    v_exp_f32 v73, v73
    v_cvt_pk_bf16_f32 v123, v70, v71
    v_exp_f32 v74, v74
    v_exp_f32 v75, v75
    v_cvt_pk_bf16_f32 v124, v72, v73
    v_exp_f32 v76, v76
    v_exp_f32 v77, v77
    v_cvt_pk_bf16_f32 v125, v74, v75
    v_exp_f32 v78, v78
    v_exp_f32 v79, v79
    v_cvt_pk_bf16_f32 v126, v76, v77
    s_nop 0
    v_cvt_pk_bf16_f32 v127, v78, v79
    s_waitcnt lgkmcnt(0)
    s_nop 0
    v_mfma_f32_32x32x16_bf16 v[16:31], v[160:163], v[112:115], v[16:31]
    v_mfma_f32_32x32x16_bf16 v[32:47], v[176:179], v[112:115], v[32:47]
    v_mfma_f32_32x32x16_bf16 v[16:31], v[164:167], v[116:119], v[16:31]
    v_mfma_f32_32x32x16_bf16 v[32:47], v[176:179], v[116:119], v[32:47]
    v_mfma_f32_32x32x16_bf16 v[16:31], v[168:171], v[120:123], v[16:31]
    v_mfma_f32_32x32x16_bf16 v[32:47], v[176:179], v[120:123], v[32:47]
    v_mfma_f32_32x32x16_bf16 v[16:31], v[172:175], v[124:127], v[16:31]
    v_mfma_f32_32x32x16_bf16 v[32:47], v[176:179], v[124:127], v[32:47]
    v_max3_f32 v2, v80, v81, v82
    v_max3_f32 v2, v2, v83, v84
    v_max3_f32 v2, v2, v85, v86
    v_max3_f32 v2, v2, v87, v88
    v_max3_f32 v2, v2, v89, v90
    v_max3_f32 v2, v2, v91, v92
    v_max3_f32 v2, v2, v93, v94
    v_max3_f32 v2, v2, v95, v96
    v_max3_f32 v2, v2, v97, v98
    v_max3_f32 v2, v2, v99, v100
    v_max3_f32 v2, v2, v101, v102
    v_max3_f32 v2, v2, v103, v104
    v_max3_f32 v2, v2, v105, v106
    v_max3_f32 v2, v2, v107, v108
    v_max3_f32 v2, v2, v109, v110
    v_max_f32 v2, v2, v111
    v_mov_b32 v3, v2
    s_nop 1
    v_permlane32_swap_b32 v2, v3
    s_nop 1
    v_max_f32 v2, v2, v3
    v_cmp_lt_f32 vcc, 0x42000000, v2
    s_cbranch_vccz L_attn_kernel_nors_38
    v_max_f32 v2, 0, v2
    v_sub_f32 v3, 0, v2
    v_exp_f32 v3, v3
    v_sub_f32 v80, v80, v2
    v_sub_f32 v81, v81, v2
    v_sub_f32 v82, v82, v2
    v_sub_f32 v83, v83, v2
    v_sub_f32 v84, v84, v2
    v_sub_f32 v85, v85, v2
    v_sub_f32 v86, v86, v2
    v_sub_f32 v87, v87, v2
    v_sub_f32 v88, v88, v2
    v_sub_f32 v89, v89, v2
    v_sub_f32 v90, v90, v2
    v_sub_f32 v91, v91, v2
    v_sub_f32 v92, v92, v2
    v_sub_f32 v93, v93, v2
    v_sub_f32 v94, v94, v2
    v_sub_f32 v95, v95, v2
    v_sub_f32 v96, v96, v2
    v_sub_f32 v97, v97, v2
    v_sub_f32 v98, v98, v2
    v_sub_f32 v99, v99, v2
    v_sub_f32 v100, v100, v2
    v_sub_f32 v101, v101, v2
    v_sub_f32 v102, v102, v2
    v_sub_f32 v103, v103, v2
    v_sub_f32 v104, v104, v2
    v_sub_f32 v105, v105, v2
    v_sub_f32 v106, v106, v2
    v_sub_f32 v107, v107, v2
    v_sub_f32 v108, v108, v2
    v_sub_f32 v109, v109, v2
    v_sub_f32 v110, v110, v2
    v_sub_f32 v111, v111, v2
    v_sub_f32 v128, v128, v2
    v_sub_f32 v129, v129, v2
    v_sub_f32 v130, v130, v2
    v_sub_f32 v131, v131, v2
    v_sub_f32 v132, v132, v2
    v_sub_f32 v133, v133, v2
    v_sub_f32 v134, v134, v2
    v_sub_f32 v135, v135, v2
    v_sub_f32 v136, v136, v2
    v_sub_f32 v137, v137, v2
    v_sub_f32 v138, v138, v2
    v_sub_f32 v139, v139, v2
    v_sub_f32 v140, v140, v2
    v_sub_f32 v141, v141, v2
    v_sub_f32 v142, v142, v2
    v_sub_f32 v143, v143, v2
    s_nop 7
    v_mul_f32 v32, v32, v3
    v_mul_f32 v16, v16, v3
    v_mul_f32 v17, v17, v3
    v_mul_f32 v18, v18, v3
    v_mul_f32 v19, v19, v3
    v_mul_f32 v20, v20, v3
    v_mul_f32 v21, v21, v3
    v_mul_f32 v22, v22, v3
    v_mul_f32 v23, v23, v3
    v_mul_f32 v24, v24, v3
    v_mul_f32 v25, v25, v3
    v_mul_f32 v26, v26, v3
    v_mul_f32 v27, v27, v3
    v_mul_f32 v28, v28, v3
    v_mul_f32 v29, v29, v3
    v_mul_f32 v30, v30, v3
    v_mul_f32 v31, v31, v3
    s_nop 1
L_attn_kernel_nors_38:
    ds_read_b128 v[160:163], v184 offset:12288
    ds_read_b128 v[164:167], v185 offset:12288
    ds_read_b128 v[168:171], v184 offset:14336
    ds_read_b128 v[172:175], v185 offset:14336
    v_exp_f32 v80, v80
    v_exp_f32 v81, v81
    v_exp_f32 v82, v82
    v_exp_f32 v83, v83
    v_cvt_pk_bf16_f32 v112, v80, v81
    v_exp_f32 v84, v84
    v_exp_f32 v85, v85
    v_cvt_pk_bf16_f32 v113, v82, v83
    v_exp_f32 v86, v86
    v_exp_f32 v87, v87
    v_cvt_pk_bf16_f32 v114, v84, v85
    v_exp_f32 v88, v88
    v_exp_f32 v89, v89
    v_cvt_pk_bf16_f32 v115, v86, v87
    v_exp_f32 v90, v90
    v_exp_f32 v91, v91
    v_cvt_pk_bf16_f32 v116, v88, v89
    v_exp_f32 v92, v92
    v_exp_f32 v93, v93
    v_cvt_pk_bf16_f32 v117, v90, v91
    v_exp_f32 v94, v94
    v_exp_f32 v95, v95
    v_cvt_pk_bf16_f32 v118, v92, v93
    v_exp_f32 v96, v96
    v_exp_f32 v97, v97
    v_cvt_pk_bf16_f32 v119, v94, v95
    v_exp_f32 v98, v98
    v_exp_f32 v99, v99
    v_cvt_pk_bf16_f32 v120, v96, v97
    v_exp_f32 v100, v100
    v_exp_f32 v101, v101
    v_cvt_pk_bf16_f32 v121, v98, v99
    v_exp_f32 v102, v102
    v_exp_f32 v103, v103
    v_cvt_pk_bf16_f32 v122, v100, v101
    v_exp_f32 v104, v104
    v_exp_f32 v105, v105
    v_cvt_pk_bf16_f32 v123, v102, v103
    v_exp_f32 v106, v106
    v_exp_f32 v107, v107
    v_cvt_pk_bf16_f32 v124, v104, v105
    v_exp_f32 v108, v108
    v_exp_f32 v109, v109
    v_cvt_pk_bf16_f32 v125, v106, v107
    v_exp_f32 v110, v110
    v_exp_f32 v111, v111
    v_cvt_pk_bf16_f32 v126, v108, v109
    s_nop 0
    v_cvt_pk_bf16_f32 v127, v110, v111
    s_waitcnt lgkmcnt(0)
    s_nop 0
    v_mfma_f32_32x32x16_bf16 v[16:31], v[160:163], v[112:115], v[16:31]
    v_mfma_f32_32x32x16_bf16 v[32:47], v[176:179], v[112:115], v[32:47]
    v_mfma_f32_32x32x16_bf16 v[16:31], v[164:167], v[116:119], v[16:31]
    v_mfma_f32_32x32x16_bf16 v[32:47], v[176:179], v[116:119], v[32:47]
    v_mfma_f32_32x32x16_bf16 v[16:31], v[168:171], v[120:123], v[16:31]
    v_mfma_f32_32x32x16_bf16 v[32:47], v[176:179], v[120:123], v[32:47]
    v_mfma_f32_32x32x16_bf16 v[16:31], v[172:175], v[124:127], v[16:31]
    v_mfma_f32_32x32x16_bf16 v[32:47], v[176:179], v[124:127], v[32:47]
    s_nop 15
    v_and_b32 v2, 31, v1
    v_add_u32 v2, s35, v2
    v_lshrrev_b32 v3, 7, v2
    v_lshlrev_b32 v181, 18, v3
    v_and_b32 v2, 127, v2
    v_lshl_add_u32 v181, v2, 7, v181
    v_lshrrev_b32 v3, 5, v1
    v_lshl_add_u32 v181, v3, 4, v181
    s_lshr_b32 s30, s34, 1
    s_lshl_b32 s30, s30, 14
    s_and_b32 s29, s34, 1
    s_lshl_b32 s29, s29, 6
    s_add_u32 s30, s30, s29
    v_rcp_f32 v2, v32
    s_nop 0
    v_mul_f32 v16, v16, v2
    v_mul_f32 v17, v17, v2
    v_mul_f32 v18, v18, v2
    v_mul_f32 v19, v19, v2
    v_mul_f32 v20, v20, v2
    v_mul_f32 v21, v21, v2
    v_mul_f32 v22, v22, v2
    v_mul_f32 v23, v23, v2
    v_mul_f32 v24, v24, v2
    v_mul_f32 v25, v25, v2
    v_mul_f32 v26, v26, v2
    v_mul_f32 v27, v27, v2
    v_mul_f32 v28, v28, v2
    v_mul_f32 v29, v29, v2
    v_mul_f32 v30, v30, v2
    v_mul_f32 v31, v31, v2
    v_cvt_pk_bf16_f32 v16, v16, v17
    v_cvt_pk_bf16_f32 v17, v18, v19
    v_cvt_pk_bf16_f32 v18, v20, v21
    v_cvt_pk_bf16_f32 v19, v22, v23
    v_cvt_pk_bf16_f32 v20, v24, v25
    v_cvt_pk_bf16_f32 v21, v26, v27
    v_cvt_pk_bf16_f32 v22, v28, v29
    v_cvt_pk_bf16_f32 v23, v30, v31
    s_nop 1
    v_permlane32_swap_b32 v16, v18
    v_permlane32_swap_b32 v17, v19
    v_permlane32_swap_b32 v20, v22
    v_permlane32_swap_b32 v21, v23
    s_nop 1
    buffer_store_dwordx4 v[16:19], v181, s[24:27], s30 offen offset:0
    buffer_store_dwordx4 v[20:23], v181, s[24:27], s30 offen offset:32
    s_nop 1
    s_barrier
    s_add_u32 s31, s31, 1
    s_cmp_lt_u32 s31, 2
    s_cbranch_scc1 L_attn_kernel_atop_34
    s_branch L_attn_kernel_end_1
L_attn_kernel_end_1:
    s_endpgm
.globl outp_kernel
.p2align 8
.type outp_kernel,@function
outp_kernel:
    s_cmp_ge_u32 s2, 256
    s_cbranch_scc1 L_outp_kernel_end_1
    s_load_dwordx2 s[56:57], s[0:1], 104
    s_load_dwordx2 s[58:59], s[0:1], 88
    s_load_dwordx2 s[60:61], s[0:1], 80
    s_load_dwordx2 s[62:63], s[0:1], 32
    s_load_dwordx2 s[64:65], s[0:1], 96
    v_and_b32 v1, 63, v0
    v_lshrrev_b32 v2, 6, v0
    s_nop 0
    v_readfirstlane_b32 s24, v2
    s_nop 3
    s_and_b32 s69, s2, 127
    s_and_b32 s66, s69, 3
    s_lshl_b32 s66, s66, 2
    s_bfe_u32 s68, s69, 0x20003
    s_add_u32 s66, s66, s68
    s_bfe_u32 s67, s69, 0x10002
    s_lshl_b32 s67, s67, 2
    s_lshr_b32 s68, s69, 5
    s_add_u32 s67, s67, s68
    s_waitcnt lgkmcnt(0)
    s_add_u32 s72, s56, 0x6000000
    s_addc_u32 s73, s57, 0
    s_and_b32 s73, s73, 0xffff
    s_mov_b32 s74, 0x800000
    s_mov_b32 s75, 0x20000
    s_mov_b32 s76, s64
    s_and_b32 s77, s65, 0xffff
    s_mov_b32 s78, 0x100
    s_mov_b32 s79, 0x20000
    s_cmp_ge_u32 s2, 128
    s_cbranch_scc1 L_outp_kernel_cons_2
    s_add_u32 s4, s56, 0x3000000
    s_addc_u32 s5, s57, 0
    s_and_b32 s5, s5, 0xffff
    s_mov_b32 s6, 0x1000000
    s_mov_b32 s7, 0x20000
    s_mov_b32 s8, s60
    s_and_b32 s9, s61, 0xffff
    s_mov_b32 s10, 0x800000
    s_mov_b32 s11, 0x20000
    s_mov_b32 s16, 128
    s_mov_b32 s17, 2048
    s_mov_b32 s18, 20
    s_lshl_b32 s19, s66, 20
    s_lshl_b32 s20, s67, 8
    s_mul_i32 s25, s24, 32
    s_add_u32 s25, s25, 0
    v_lshrrev_b32 v2, 3, v1
    v_add_u32 v2, s25, v2
    v_lshrrev_b32 v3, 1, v2
    v_and_b32 v3, 7, v3
    v_and_b32 v4, 7, v1
    v_xor_b32 v3, v3, v4
    v_mul_lo_u32 v2, v2, s16
    v_lshl_add_u32 v2, v3, 4, v2
    v_add_u32 v6, s19, v2
    s_mul_i32 s25, s24, 32
    s_add_u32 s25, s25, 8
    v_lshrrev_b32 v2, 3, v1
    v_add_u32 v2, s25, v2
    v_lshrrev_b32 v3, 1, v2
    v_and_b32 v3, 7, v3
    v_and_b32 v4, 7, v1
    v_xor_b32 v3, v3, v4
    v_mul_lo_u32 v2, v2, s16
    v_lshl_add_u32 v2, v3, 4, v2
    v_add_u32 v7, s19, v2
    s_mul_i32 s25, s24, 32
    s_add_u32 s25, s25, 16
    v_lshrrev_b32 v2, 3, v1
    v_add_u32 v2, s25, v2
    v_lshrrev_b32 v3, 1, v2
    v_and_b32 v3, 7, v3
    v_and_b32 v4, 7, v1
    v_xor_b32 v3, v3, v4
    v_mul_lo_u32 v2, v2, s16
    v_lshl_add_u32 v2, v3, 4, v2
    v_add_u32 v8, s19, v2
    s_mul_i32 s25, s24, 32
    s_add_u32 s25, s25, 24
    v_lshrrev_b32 v2, 3, v1
    v_add_u32 v2, s25, v2
    v_lshrrev_b32 v3, 1, v2
    v_and_b32 v3, 7, v3
    v_and_b32 v4, 7, v1
    v_xor_b32 v3, v3, v4
    v_mul_lo_u32 v2, v2, s16
    v_lshl_add_u32 v2, v3, 4, v2
    v_add_u32 v9, s19, v2
    s_mul_i32 s25, s24, 16
    s_add_u32 s25, s25, 0
    v_lshrrev_b32 v2, 4, v1
    v_add_u32 v2, s25, v2
    v_and_b32 v3, 3, v2
    v_lshlrev_b32 v3, 2, v3
    v_and_b32 v4, 15, v1
    v_xor_b32 v3, v3, v4
    v_mul_lo_u32 v2, v2, s17
    v_lshl_add_u32 v2, v3, 4, v2
    v_add_u32 v10, s20, v2
    s_mul_i32 s25, s24, 16
    s_add_u32 s25, s25, 4
    v_lshrrev_b32 v2, 4, v1
    v_add_u32 v2, s25, v2
    v_and_b32 v3, 3, v2
    v_lshlrev_b32 v3, 2, v3
    v_and_b32 v4, 15, v1
    v_xor_b32 v3, v3, v4
    v_mul_lo_u32 v2, v2, s17
    v_lshl_add_u32 v2, v3, 4, v2
    v_add_u32 v11, s20, v2
    s_mul_i32 s25, s24, 16
    s_add_u32 s25, s25, 8
    v_lshrrev_b32 v2, 4, v1
    v_add_u32 v2, s25, v2
    v_and_b32 v3, 3, v2
    v_lshlrev_b32 v3, 2, v3
    v_and_b32 v4, 15, v1
    v_xor_b32 v3, v3, v4
    v_mul_lo_u32 v2, v2, s17
    v_lshl_add_u32 v2, v3, 4, v2
    v_add_u32 v12, s20, v2
    s_mul_i32 s25, s24, 16
    s_add_u32 s25, s25, 12
    v_lshrrev_b32 v2, 4, v1
    v_add_u32 v2, s25, v2
    v_and_b32 v3, 3, v2
    v_lshlrev_b32 v3, 2, v3
    v_and_b32 v4, 15, v1
    v_xor_b32 v3, v3, v4
    v_mul_lo_u32 v2, v2, s17
    v_lshl_add_u32 v2, v3, 4, v2
    v_add_u32 v13, s20, v2
    s_mov_b32 s27, 720896
    s_mov_b32 s28, 5767168
    s_mov_b32 s29, 0
    s_mov_b32 s30, 0
    s_mov_b32 s31, 32768
    s_mul_i32 s33, s24, 4096
    s_mul_i32 s34, s24, 4096
    s_add_u32 s34, s34, 16384
    s_mul_i32 s35, s17, 64
    s_mov_b32 s38, s18
    s_add_u32 s36, s29, s33
    s_add_u32 m0, s36, 0
    s_nop 0
    buffer_load_dwordx4 v6, s[4:7], s27 offen lds
    s_add_u32 m0, s36, 1024
    s_nop 0
    buffer_load_dwordx4 v7, s[4:7], s27 offen lds
    s_add_u32 m0, s36, 2048
    s_nop 0
    buffer_load_dwordx4 v8, s[4:7], s27 offen lds
    s_add_u32 m0, s36, 3072
    s_nop 0
    buffer_load_dwordx4 v9, s[4:7], s27 offen lds
    s_add_u32 s37, s29, s34
    s_add_u32 m0, s37, 0
    s_nop 0
    buffer_load_dwordx4 v10, s[8:11], s28 offen lds
    s_add_u32 m0, s37, 1024
    s_nop 0
    buffer_load_dwordx4 v11, s[8:11], s28 offen lds
    s_add_u32 m0, s37, 2048
    s_nop 0
    buffer_load_dwordx4 v12, s[8:11], s28 offen lds
    s_add_u32 m0, s37, 3072
    s_nop 0
    buffer_load_dwordx4 v13, s[8:11], s28 offen lds
    s_add_u32 s27, s27, 16384
    s_add_u32 s28, s28, s35
    s_add_u32 s29, s29, 32768
    s_cmp_eq_u32 s29, 163840
    s_cselect_b32 s29, 0, s29
    s_add_u32 s36, s29, s33
    s_add_u32 m0, s36, 0
    s_nop 0
    buffer_load_dwordx4 v6, s[4:7], s27 offen lds
    s_add_u32 m0, s36, 1024
    s_nop 0
    buffer_load_dwordx4 v7, s[4:7], s27 offen lds
    s_add_u32 m0, s36, 2048
    s_nop 0
    buffer_load_dwordx4 v8, s[4:7], s27 offen lds
    s_add_u32 m0, s36, 3072
    s_nop 0
    buffer_load_dwordx4 v9, s[4:7], s27 offen lds
    s_add_u32 s37, s29, s34
    s_add_u32 m0, s37, 0
    s_nop 0
    buffer_load_dwordx4 v10, s[8:11], s28 offen lds
    s_add_u32 m0, s37, 1024
    s_nop 0
    buffer_load_dwordx4 v11, s[8:11], s28 offen lds
    s_add_u32 m0, s37, 2048
    s_nop 0
    buffer_load_dwordx4 v12, s[8:11], s28 offen lds
    s_add_u32 m0, s37, 3072
    s_nop 0
    buffer_load_dwordx4 v13, s[8:11], s28 offen lds
    s_add_u32 s27, s27, 16384
    s_add_u32 s28, s28, s35
    s_add_u32 s29, s29, 32768
    s_cmp_eq_u32 s29, 163840
    s_cselect_b32 s29, 0, s29
    s_add_u32 s36, s29, s33
    s_add_u32 m0, s36, 0
    s_nop 0
    buffer_load_dwordx4 v6, s[4:7], s27 offen lds
    s_add_u32 m0, s36, 1024
    s_nop 0
    buffer_load_dwordx4 v7, s[4:7], s27 offen lds
    s_add_u32 m0, s36, 2048
    s_nop 0
    buffer_load_dwordx4 v8, s[4:7], s27 offen lds
    s_add_u32 m0, s36, 3072
    s_nop 0
    buffer_load_dwordx4 v9, s[4:7], s27 offen lds
    s_add_u32 s37, s29, s34
    s_add_u32 m0, s37, 0
    s_nop 0
    buffer_load_dwordx4 v10, s[8:11], s28 offen lds
    s_add_u32 m0, s37, 1024
    s_nop 0
    buffer_load_dwordx4 v11, s[8:11], s28 offen lds
    s_add_u32 m0, s37, 2048
    s_nop 0
    buffer_load_dwordx4 v12, s[8:11], s28 offen lds
    s_add_u32 m0, s37, 3072
    s_nop 0
    buffer_load_dwordx4 v13, s[8:11], s28 offen lds
    s_add_u32 s27, s27, 16384
    s_add_u32 s28, s28, s35
    s_add_u32 s29, s29, 32768
    s_cmp_eq_u32 s29, 163840
    s_cselect_b32 s29, 0, s29
    s_add_u32 s36, s29, s33
    s_add_u32 m0, s36, 0
    s_nop 0
    buffer_load_dwordx4 v6, s[4:7], s27 offen lds
    s_add_u32 m0, s36, 1024
    s_nop 0
    buffer_load_dwordx4 v7, s[4:7], s27 offen lds
    s_add_u32 m0, s36, 2048
    s_nop 0
    buffer_load_dwordx4 v8, s[4:7], s27 offen lds
    s_add_u32 m0, s36, 3072
    s_nop 0
    buffer_load_dwordx4 v9, s[4:7], s27 offen lds
    s_add_u32 s37, s29, s34
    s_add_u32 m0, s37, 0
    s_nop 0
    buffer_load_dwordx4 v10, s[8:11], s28 offen lds
    s_add_u32 m0, s37, 1024
    s_nop 0
    buffer_load_dwordx4 v11, s[8:11], s28 offen lds
    s_add_u32 m0, s37, 2048
    s_nop 0
    buffer_load_dwordx4 v12, s[8:11], s28 offen lds
    s_add_u32 m0, s37, 3072
    s_nop 0
    buffer_load_dwordx4 v13, s[8:11], s28 offen lds
    s_add_u32 s27, s27, 16384
    s_add_u32 s28, s28, s35
    s_add_u32 s29, s29, 32768
    s_cmp_eq_u32 s29, 163840
    s_cselect_b32 s29, 0, s29
    s_and_b32 s39, s24, 1
    s_lshr_b32 s40, s24, 1
    s_mul_i32 s25, s39, 64
    v_and_b32 v2, 31, v1
    v_add_u32 v2, s25, v2
    v_lshrrev_b32 v3, 1, v2
    v_and_b32 v3, 7, v3
    v_lshrrev_b32 v4, 5, v1
    v_xor_b32 v3, v3, v4
    v_lshlrev_b32 v2, 7, v2
    v_xor_b32 v4, 0, v3
    v_lshl_add_u32 v31, v4, 4, v2
    v_xor_b32 v4, 2, v3
    v_lshl_add_u32 v32, v4, 4, v2
    v_xor_b32 v4, 4, v3
    v_lshl_add_u32 v33, v4, 4, v2
    v_xor_b32 v4, 6, v3
    v_lshl_add_u32 v34, v4, 4, v2
    v_lshrrev_b32 v2, 5, v1
    v_lshlrev_b32 v2, 3, v2
    v_bfe_u32 v3, v1, 2, 2
    v_add_u32 v2, v2, v3
    v_and_b32 v3, 3, v2
    v_lshlrev_b32 v3, 2, v3
    v_lshlrev_b32 v2, 8, v2
    s_mul_i32 s25, s40, 8
    s_add_u32 s25, s25, 0
    v_bfe_u32 v4, v1, 4, 1
    v_lshlrev_b32 v4, 1, v4
    v_bfe_u32 v5, v1, 1, 1
    v_add3_u32 v4, v4, v5, s25
    v_xor_b32 v4, v4, v3
    v_lshl_add_u32 v4, v4, 4, v2
    v_and_b32 v5, 1, v1
    v_lshl_add_u32 v4, v5, 3, v4
    v_add_u32 v35, 16384, v4
    s_mul_i32 s25, s40, 8
    s_add_u32 s25, s25, 4
    v_bfe_u32 v4, v1, 4, 1
    v_lshlrev_b32 v4, 1, v4
    v_bfe_u32 v5, v1, 1, 1
    v_add3_u32 v4, v4, v5, s25
    v_xor_b32 v4, v4, v3
    v_lshl_add_u32 v4, v4, 4, v2
    v_and_b32 v5, 1, v1
    v_lshl_add_u32 v4, v5, 3, v4
    v_add_u32 v36, 16384, v4
    v_mov_b32 v40, 0
    v_mov_b32 v41, 0
    v_mov_b32 v42, 0
    v_mov_b32 v43, 0
    v_mov_b32 v44, 0
    v_mov_b32 v45, 0
    v_mov_b32 v46, 0
    v_mov_b32 v47, 0
    v_mov_b32 v48, 0
    v_mov_b32 v49, 0
    v_mov_b32 v50, 0
    v_mov_b32 v51, 0
    v_mov_b32 v52, 0
    v_mov_b32 v53, 0
    v_mov_b32 v54, 0
    v_mov_b32 v55, 0
    v_mov_b32 v56, 0
    v_mov_b32 v57, 0
    v_mov_b32 v58, 0
    v_mov_b32 v59, 0
    v_mov_b32 v60, 0
    v_mov_b32 v61, 0
    v_mov_b32 v62, 0
    v_mov_b32 v63, 0
    v_mov_b32 v64, 0
    v_mov_b32 v65, 0
    v_mov_b32 v66, 0
    v_mov_b32 v67, 0
    v_mov_b32 v68, 0
    v_mov_b32 v69, 0
    v_mov_b32 v70, 0
    v_mov_b32 v71, 0
    v_mov_b32 v72, 0
    v_mov_b32 v73, 0
    v_mov_b32 v74, 0
    v_mov_b32 v75, 0
    v_mov_b32 v76, 0
    v_mov_b32 v77, 0
    v_mov_b32 v78, 0
    v_mov_b32 v79, 0
    v_mov_b32 v80, 0
    v_mov_b32 v81, 0
    v_mov_b32 v82, 0
    v_mov_b32 v83, 0
    v_mov_b32 v84, 0
    v_mov_b32 v85, 0
    v_mov_b32 v86, 0
    v_mov_b32 v87, 0
    v_mov_b32 v88, 0
    v_mov_b32 v89, 0
    v_mov_b32 v90, 0
    v_mov_b32 v91, 0
    v_mov_b32 v92, 0
    v_mov_b32 v93, 0
    v_mov_b32 v94, 0
    v_mov_b32 v95, 0
    v_mov_b32 v96, 0
    v_mov_b32 v97, 0
    v_mov_b32 v98, 0
    v_mov_b32 v99, 0
    v_mov_b32 v100, 0
    v_mov_b32 v101, 0
    v_mov_b32 v102, 0
    v_mov_b32 v103, 0
    s_waitcnt vmcnt(16)
    s_barrier
    ds_read_b128 v[104:107], v31 offset:0
    ds_read_b128 v[108:111], v31 offset:4096
    ds_read_b64_tr_b16 v[168:169], v35 offset:0
    ds_read_b64_tr_b16 v[170:171], v35 offset:1024
    ds_read_b64_tr_b16 v[172:173], v36 offset:0
    ds_read_b64_tr_b16 v[174:175], v36 offset:1024
    ds_read_b128 v[112:115], v32 offset:0
    ds_read_b128 v[116:119], v32 offset:4096
    ds_read_b64_tr_b16 v[176:177], v35 offset:4096
    ds_read_b64_tr_b16 v[178:179], v35 offset:5120
    ds_read_b64_tr_b16 v[180:181], v36 offset:4096
    ds_read_b64_tr_b16 v[182:183], v36 offset:5120
    ds_read_b128 v[120:123], v33 offset:0
    ds_read_b128 v[124:127], v33 offset:4096
    ds_read_b64_tr_b16 v[184:185], v35 offset:8192
    ds_read_b64_tr_b16 v[186:187], v35 offset:9216
    ds_read_b64_tr_b16 v[188:189], v36 offset:8192
    ds_read_b64_tr_b16 v[190:191], v36 offset:9216
    ds_read_b128 v[128:131], v34 offset:0
    ds_read_b128 v[132:135], v34 offset:4096
    ds_read_b64_tr_b16 v[192:193], v35 offset:12288
    ds_read_b64_tr_b16 v[194:195], v35 offset:13312
    ds_read_b64_tr_b16 v[196:197], v36 offset:12288
    ds_read_b64_tr_b16 v[198:199], v36 offset:13312
    s_sub_u32 s32, s38, 4
L_outp_kernel_main_3:
    v_add_u32 v232, s31, v31
    v_add_u32 v233, s31, v32
    v_add_u32 v234, s31, v33
    v_add_u32 v235, s31, v34
    v_add_u32 v236, s31, v35
    v_add_u32 v237, s31, v36
    s_waitcnt lgkmcnt(0)
    v_mfma_f32_32x32x16_bf16 v[40:55], v[168:171], v[104:107], v[40:55]
    ds_read_b128 v[136:139], v232 offset:0
    ds_read_b128 v[140:143], v232 offset:4096
    ds_read_b64_tr_b16 v[200:201], v236 offset:0
    v_mfma_f32_32x32x16_bf16 v[56:71], v[172:175], v[104:107], v[56:71]
    s_add_u32 s36, s29, s33
    s_add_u32 m0, s36, 0
    s_nop 0
    buffer_load_dwordx4 v6, s[4:7], s27 offen lds
    ds_read_b64_tr_b16 v[202:203], v236 offset:1024
    ds_read_b64_tr_b16 v[204:205], v237 offset:0
    v_mfma_f32_32x32x16_bf16 v[72:87], v[168:171], v[108:111], v[72:87]
    ds_read_b64_tr_b16 v[206:207], v237 offset:1024
    s_add_u32 m0, s36, 1024
    s_nop 0
    buffer_load_dwordx4 v7, s[4:7], s27 offen lds
    ds_read_b128 v[144:147], v233 offset:0
    v_mfma_f32_32x32x16_bf16 v[88:103], v[172:175], v[108:111], v[88:103]
    ds_read_b128 v[148:151], v233 offset:4096
    s_add_u32 m0, s36, 2048
    s_nop 0
    buffer_load_dwordx4 v8, s[4:7], s27 offen lds
    ds_read_b64_tr_b16 v[208:209], v236 offset:4096
    v_mfma_f32_32x32x16_bf16 v[40:55], v[176:179], v[112:115], v[40:55]
    ds_read_b64_tr_b16 v[210:211], v236 offset:5120
    ds_read_b64_tr_b16 v[212:213], v237 offset:4096
    s_add_u32 m0, s36, 3072
    s_nop 0
    buffer_load_dwordx4 v9, s[4:7], s27 offen lds
    v_mfma_f32_32x32x16_bf16 v[56:71], v[180:183], v[112:115], v[56:71]
    ds_read_b64_tr_b16 v[214:215], v237 offset:5120
    ds_read_b128 v[152:155], v234 offset:0
    ds_read_b128 v[156:159], v234 offset:4096
    v_mfma_f32_32x32x16_bf16 v[72:87], v[176:179], v[116:119], v[72:87]
    s_add_u32 s37, s29, s34
    s_add_u32 m0, s37, 0
    s_nop 0
    buffer_load_dwordx4 v10, s[8:11], s28 offen lds
    ds_read_b64_tr_b16 v[216:217], v236 offset:8192
    ds_read_b64_tr_b16 v[218:219], v236 offset:9216
    v_mfma_f32_32x32x16_bf16 v[88:103], v[180:183], v[116:119], v[88:103]
    s_add_u32 m0, s37, 1024
    s_nop 0
    buffer_load_dwordx4 v11, s[8:11], s28 offen lds
    ds_read_b64_tr_b16 v[220:221], v237 offset:8192
    ds_read_b64_tr_b16 v[222:223], v237 offset:9216
    v_mfma_f32_32x32x16_bf16 v[40:55], v[184:187], v[120:123], v[40:55]
    ds_read_b128 v[160:163], v235 offset:0
    s_add_u32 m0, s37, 2048
    s_nop 0
    buffer_load_dwordx4 v12, s[8:11], s28 offen lds
    ds_read_b128 v[164:167], v235 offset:4096
    v_mfma_f32_32x32x16_bf16 v[56:71], v[188:191], v[120:123], v[56:71]
    ds_read_b64_tr_b16 v[224:225], v236 offset:12288
    ds_read_b64_tr_b16 v[226:227], v236 offset:13312
    s_add_u32 m0, s37, 3072
    s_nop 0
    buffer_load_dwordx4 v13, s[8:11], s28 offen lds
    v_mfma_f32_32x32x16_bf16 v[72:87], v[184:187], v[124:127], v[72:87]
    ds_read_b64_tr_b16 v[228:229], v237 offset:12288
    ds_read_b64_tr_b16 v[230:231], v237 offset:13312
    s_add_u32 s27, s27, 16384
    s_add_u32 s28, s28, s35
    s_add_u32 s29, s29, 32768
    s_cmp_eq_u32 s29, 163840
    s_cselect_b32 s29, 0, s29
    v_mfma_f32_32x32x16_bf16 v[88:103], v[188:191], v[124:127], v[88:103]
    v_mfma_f32_32x32x16_bf16 v[40:55], v[192:195], v[128:131], v[40:55]
    v_mfma_f32_32x32x16_bf16 v[56:71], v[196:199], v[128:131], v[56:71]
    v_mfma_f32_32x32x16_bf16 v[72:87], v[192:195], v[132:135], v[72:87]
    v_mfma_f32_32x32x16_bf16 v[88:103], v[196:199], v[132:135], v[88:103]
    s_add_u32 s31, s31, 32768
    s_cmp_eq_u32 s31, 163840
    s_cselect_b32 s31, 0, s31
    s_waitcnt vmcnt(16)
    s_barrier
    v_add_u32 v232, s31, v31
    v_add_u32 v233, s31, v32
    v_add_u32 v234, s31, v33
    v_add_u32 v235, s31, v34
    v_add_u32 v236, s31, v35
    v_add_u32 v237, s31, v36
    s_waitcnt lgkmcnt(0)
    v_mfma_f32_32x32x16_bf16 v[40:55], v[200:203], v[136:139], v[40:55]
    ds_read_b128 v[104:107], v232 offset:0
    ds_read_b128 v[108:111], v232 offset:4096
    ds_read_b64_tr_b16 v[168:169], v236 offset:0
    v_mfma_f32_32x32x16_bf16 v[56:71], v[204:207], v[136:139], v[56:71]
    s_add_u32 s36, s29, s33
    s_add_u32 m0, s36, 0
    s_nop 0
    buffer_load_dwordx4 v6, s[4:7], s27 offen lds
    ds_read_b64_tr_b16 v[170:171], v236 offset:1024
    ds_read_b64_tr_b16 v[172:173], v237 offset:0
    v_mfma_f32_32x32x16_bf16 v[72:87], v[200:203], v[140:143], v[72:87]
    ds_read_b64_tr_b16 v[174:175], v237 offset:1024
    s_add_u32 m0, s36, 1024
    s_nop 0
    buffer_load_dwordx4 v7, s[4:7], s27 offen lds
    ds_read_b128 v[112:115], v233 offset:0
    v_mfma_f32_32x32x16_bf16 v[88:103], v[204:207], v[140:143], v[88:103]
    ds_read_b128 v[116:119], v233 offset:4096
    s_add_u32 m0, s36, 2048
    s_nop 0
    buffer_load_dwordx4 v8, s[4:7], s27 offen lds
    ds_read_b64_tr_b16 v[176:177], v236 offset:4096
    v_mfma_f32_32x32x16_bf16 v[40:55], v[208:211], v[144:147], v[40:55]
    ds_read_b64_tr_b16 v[178:179], v236 offset:5120
    ds_read_b64_tr_b16 v[180:181], v237 offset:4096
    s_add_u32 m0, s36, 3072
    s_nop 0
    buffer_load_dwordx4 v9, s[4:7], s27 offen lds
    v_mfma_f32_32x32x16_bf16 v[56:71], v[212:215], v[144:147], v[56:71]
    ds_read_b64_tr_b16 v[182:183], v237 offset:5120
    ds_read_b128 v[120:123], v234 offset:0
    ds_read_b128 v[124:127], v234 offset:4096
    v_mfma_f32_32x32x16_bf16 v[72:87], v[208:211], v[148:151], v[72:87]
    s_add_u32 s37, s29, s34
    s_add_u32 m0, s37, 0
    s_nop 0
    buffer_load_dwordx4 v10, s[8:11], s28 offen lds
    ds_read_b64_tr_b16 v[184:185], v236 offset:8192
    ds_read_b64_tr_b16 v[186:187], v236 offset:9216
    v_mfma_f32_32x32x16_bf16 v[88:103], v[212:215], v[148:151], v[88:103]
    s_add_u32 m0, s37, 1024
    s_nop 0
    buffer_load_dwordx4 v11, s[8:11], s28 offen lds
    ds_read_b64_tr_b16 v[188:189], v237 offset:8192
    ds_read_b64_tr_b16 v[190:191], v237 offset:9216
    v_mfma_f32_32x32x16_bf16 v[40:55], v[216:219], v[152:155], v[40:55]
    ds_read_b128 v[128:131], v235 offset:0
    s_add_u32 m0, s37, 2048
    s_nop 0
    buffer_load_dwordx4 v12, s[8:11], s28 offen lds
    ds_read_b128 v[132:135], v235 offset:4096
    v_mfma_f32_32x32x16_bf16 v[56:71], v[220:223], v[152:155], v[56:71]
    ds_read_b64_tr_b16 v[192:193], v236 offset:12288
    ds_read_b64_tr_b16 v[194:195], v236 offset:13312
    s_add_u32 m0, s37, 3072
    s_nop 0
    buffer_load_dwordx4 v13, s[8:11], s28 offen lds
    v_mfma_f32_32x32x16_bf16 v[72:87], v[216:219], v[156:159], v[72:87]
    ds_read_b64_tr_b16 v[196:197], v237 offset:12288
    ds_read_b64_tr_b16 v[198:199], v237 offset:13312
    s_add_u32 s27, s27, 16384
    s_add_u32 s28, s28, s35
    s_add_u32 s29, s29, 32768
    s_cmp_eq_u32 s29, 163840
    s_cselect_b32 s29, 0, s29
    v_mfma_f32_32x32x16_bf16 v[88:103], v[220:223], v[156:159], v[88:103]
    v_mfma_f32_32x32x16_bf16 v[40:55], v[224:227], v[160:163], v[40:55]
    v_mfma_f32_32x32x16_bf16 v[56:71], v[228:231], v[160:163], v[56:71]
    v_mfma_f32_32x32x16_bf16 v[72:87], v[224:227], v[164:167], v[72:87]
    v_mfma_f32_32x32x16_bf16 v[88:103], v[228:231], v[164:167], v[88:103]
    s_add_u32 s31, s31, 32768
    s_cmp_eq_u32 s31, 163840
    s_cselect_b32 s31, 0, s31
    s_waitcnt vmcnt(16)
    s_barrier
    s_sub_u32 s32, s32, 2
    s_cmp_lg_u32 s32, 0
    s_cbranch_scc1 L_outp_kernel_main_3
    s_mov_b32 s32, 4
L_outp_kernel_tail_4:
    v_add_u32 v232, s31, v31
    v_add_u32 v233, s31, v32
    v_add_u32 v234, s31, v33
    v_add_u32 v235, s31, v34
    v_add_u32 v236, s31, v35
    v_add_u32 v237, s31, v36
    s_waitcnt lgkmcnt(0)
    v_mfma_f32_32x32x16_bf16 v[40:55], v[168:171], v[104:107], v[40:55]
    ds_read_b128 v[136:139], v232 offset:0
    ds_read_b128 v[140:143], v232 offset:4096
    v_mfma_f32_32x32x16_bf16 v[56:71], v[172:175], v[104:107], v[56:71]
    ds_read_b64_tr_b16 v[200:201], v236 offset:0
    ds_read_b64_tr_b16 v[202:203], v236 offset:1024
    v_mfma_f32_32x32x16_bf16 v[72:87], v[168:171], v[108:111], v[72:87]
    ds_read_b64_tr_b16 v[204:205], v237 offset:0
    ds_read_b64_tr_b16 v[206:207], v237 offset:1024
    v_mfma_f32_32x32x16_bf16 v[88:103], v[172:175], v[108:111], v[88:103]
    ds_read_b128 v[144:147], v233 offset:0
    ds_read_b128 v[148:151], v233 offset:4096
    v_mfma_f32_32x32x16_bf16 v[40:55], v[176:179], v[112:115], v[40:55]
    ds_read_b64_tr_b16 v[208:209], v236 offset:4096
    ds_read_b64_tr_b16 v[210:211], v236 offset:5120
    v_mfma_f32_32x32x16_bf16 v[56:71], v[180:183], v[112:115], v[56:71]
    ds_read_b64_tr_b16 v[212:213], v237 offset:4096
    ds_read_b64_tr_b16 v[214:215], v237 offset:5120
    v_mfma_f32_32x32x16_bf16 v[72:87], v[176:179], v[116:119], v[72:87]
    ds_read_b128 v[152:155], v234 offset:0
    ds_read_b128 v[156:159], v234 offset:4096
    v_mfma_f32_32x32x16_bf16 v[88:103], v[180:183], v[116:119], v[88:103]
    ds_read_b64_tr_b16 v[216:217], v236 offset:8192
    ds_read_b64_tr_b16 v[218:219], v236 offset:9216
    v_mfma_f32_32x32x16_bf16 v[40:55], v[184:187], v[120:123], v[40:55]
    ds_read_b64_tr_b16 v[220:221], v237 offset:8192
    ds_read_b64_tr_b16 v[222:223], v237 offset:9216
    v_mfma_f32_32x32x16_bf16 v[56:71], v[188:191], v[120:123], v[56:71]
    ds_read_b128 v[160:163], v235 offset:0
    ds_read_b128 v[164:167], v235 offset:4096
    v_mfma_f32_32x32x16_bf16 v[72:87], v[184:187], v[124:127], v[72:87]
    ds_read_b64_tr_b16 v[224:225], v236 offset:12288
    ds_read_b64_tr_b16 v[226:227], v236 offset:13312
    v_mfma_f32_32x32x16_bf16 v[88:103], v[188:191], v[124:127], v[88:103]
    ds_read_b64_tr_b16 v[228:229], v237 offset:12288
    ds_read_b64_tr_b16 v[230:231], v237 offset:13312
    v_mfma_f32_32x32x16_bf16 v[40:55], v[192:195], v[128:131], v[40:55]
    v_mfma_f32_32x32x16_bf16 v[56:71], v[196:199], v[128:131], v[56:71]
    v_mfma_f32_32x32x16_bf16 v[72:87], v[192:195], v[132:135], v[72:87]
    v_mfma_f32_32x32x16_bf16 v[88:103], v[196:199], v[132:135], v[88:103]
    s_add_u32 s31, s31, 32768
    s_cmp_eq_u32 s31, 163840
    s_cselect_b32 s31, 0, s31
    s_waitcnt vmcnt(0)
    s_barrier
    v_add_u32 v232, s31, v31
    v_add_u32 v233, s31, v32
    v_add_u32 v234, s31, v33
    v_add_u32 v235, s31, v34
    v_add_u32 v236, s31, v35
    v_add_u32 v237, s31, v36
    s_waitcnt lgkmcnt(0)
    v_mfma_f32_32x32x16_bf16 v[40:55], v[200:203], v[136:139], v[40:55]
    ds_read_b128 v[104:107], v232 offset:0
    ds_read_b128 v[108:111], v232 offset:4096
    v_mfma_f32_32x32x16_bf16 v[56:71], v[204:207], v[136:139], v[56:71]
    ds_read_b64_tr_b16 v[168:169], v236 offset:0
    ds_read_b64_tr_b16 v[170:171], v236 offset:1024
    v_mfma_f32_32x32x16_bf16 v[72:87], v[200:203], v[140:143], v[72:87]
    ds_read_b64_tr_b16 v[172:173], v237 offset:0
    ds_read_b64_tr_b16 v[174:175], v237 offset:1024
    v_mfma_f32_32x32x16_bf16 v[88:103], v[204:207], v[140:143], v[88:103]
    ds_read_b128 v[112:115], v233 offset:0
    ds_read_b128 v[116:119], v233 offset:4096
    v_mfma_f32_32x32x16_bf16 v[40:55], v[208:211], v[144:147], v[40:55]
    ds_read_b64_tr_b16 v[176:177], v236 offset:4096
    ds_read_b64_tr_b16 v[178:179], v236 offset:5120
    v_mfma_f32_32x32x16_bf16 v[56:71], v[212:215], v[144:147], v[56:71]
    ds_read_b64_tr_b16 v[180:181], v237 offset:4096
    ds_read_b64_tr_b16 v[182:183], v237 offset:5120
    v_mfma_f32_32x32x16_bf16 v[72:87], v[208:211], v[148:151], v[72:87]
    ds_read_b128 v[120:123], v234 offset:0
    ds_read_b128 v[124:127], v234 offset:4096
    v_mfma_f32_32x32x16_bf16 v[88:103], v[212:215], v[148:151], v[88:103]
    ds_read_b64_tr_b16 v[184:185], v236 offset:8192
    ds_read_b64_tr_b16 v[186:187], v236 offset:9216
    v_mfma_f32_32x32x16_bf16 v[40:55], v[216:219], v[152:155], v[40:55]
    ds_read_b64_tr_b16 v[188:189], v237 offset:8192
    ds_read_b64_tr_b16 v[190:191], v237 offset:9216
    v_mfma_f32_32x32x16_bf16 v[56:71], v[220:223], v[152:155], v[56:71]
    ds_read_b128 v[128:131], v235 offset:0
    ds_read_b128 v[132:135], v235 offset:4096
    v_mfma_f32_32x32x16_bf16 v[72:87], v[216:219], v[156:159], v[72:87]
    ds_read_b64_tr_b16 v[192:193], v236 offset:12288
    ds_read_b64_tr_b16 v[194:195], v236 offset:13312
    v_mfma_f32_32x32x16_bf16 v[88:103], v[220:223], v[156:159], v[88:103]
    ds_read_b64_tr_b16 v[196:197], v237 offset:12288
    ds_read_b64_tr_b16 v[198:199], v237 offset:13312
    v_mfma_f32_32x32x16_bf16 v[40:55], v[224:227], v[160:163], v[40:55]
    v_mfma_f32_32x32x16_bf16 v[56:71], v[228:231], v[160:163], v[56:71]
    v_mfma_f32_32x32x16_bf16 v[72:87], v[224:227], v[164:167], v[72:87]
    v_mfma_f32_32x32x16_bf16 v[88:103], v[228:231], v[164:167], v[88:103]
    s_add_u32 s31, s31, 32768
    s_cmp_eq_u32 s31, 163840
    s_cselect_b32 s31, 0, s31
    s_waitcnt vmcnt(0)
    s_barrier
    s_sub_u32 s32, s32, 2
    s_cmp_lg_u32 s32, 0
    s_cbranch_scc1 L_outp_kernel_tail_4
    s_waitcnt lgkmcnt(0)
    s_nop 15
    s_add_u32 s4, s56, 0x4400000
    s_addc_u32 s5, s57, 0
    s_and_b32 s5, s5, 0xffff
    s_mov_b32 s6, 0x400000
    s_mov_b32 s7, 0x20000
    s_mov_b32 s8, s62
    s_and_b32 s9, s63, 0xffff
    s_mov_b32 s10, 0x200000
    s_mov_b32 s11, 0x20000
    s_mov_b32 s16, 128
    s_mov_b32 s17, 2048
    s_mov_b32 s18, 16
    s_lshl_b32 s19, s66, 18
    s_lshl_b32 s20, s67, 8
    s_mul_i32 s25, s24, 32
    s_add_u32 s25, s25, 0
    v_lshrrev_b32 v2, 3, v1
    v_add_u32 v2, s25, v2
    v_lshrrev_b32 v3, 1, v2
    v_and_b32 v3, 7, v3
    v_and_b32 v4, 7, v1
    v_xor_b32 v3, v3, v4
    v_mul_lo_u32 v2, v2, s16
    v_lshl_add_u32 v2, v3, 4, v2
    v_add_u32 v14, s19, v2
    s_mul_i32 s25, s24, 32
    s_add_u32 s25, s25, 8
    v_lshrrev_b32 v2, 3, v1
    v_add_u32 v2, s25, v2
    v_lshrrev_b32 v3, 1, v2
    v_and_b32 v3, 7, v3
    v_and_b32 v4, 7, v1
    v_xor_b32 v3, v3, v4
    v_mul_lo_u32 v2, v2, s16
    v_lshl_add_u32 v2, v3, 4, v2
    v_add_u32 v15, s19, v2
    s_mul_i32 s25, s24, 32
    s_add_u32 s25, s25, 16
    v_lshrrev_b32 v2, 3, v1
    v_add_u32 v2, s25, v2
    v_lshrrev_b32 v3, 1, v2
    v_and_b32 v3, 7, v3
    v_and_b32 v4, 7, v1
    v_xor_b32 v3, v3, v4
    v_mul_lo_u32 v2, v2, s16
    v_lshl_add_u32 v2, v3, 4, v2
    v_add_u32 v16, s19, v2
    s_mul_i32 s25, s24, 32
    s_add_u32 s25, s25, 24
    v_lshrrev_b32 v2, 3, v1
    v_add_u32 v2, s25, v2
    v_lshrrev_b32 v3, 1, v2
    v_and_b32 v3, 7, v3
    v_and_b32 v4, 7, v1
    v_xor_b32 v3, v3, v4
    v_mul_lo_u32 v2, v2, s16
    v_lshl_add_u32 v2, v3, 4, v2
    v_add_u32 v17, s19, v2
    s_mul_i32 s25, s24, 16
    s_add_u32 s25, s25, 0
    v_lshrrev_b32 v2, 4, v1
    v_add_u32 v2, s25, v2
    v_and_b32 v3, 3, v2
    v_lshlrev_b32 v3, 2, v3
    v_and_b32 v4, 15, v1
    v_xor_b32 v3, v3, v4
    v_mul_lo_u32 v2, v2, s17
    v_lshl_add_u32 v2, v3, 4, v2
    v_add_u32 v18, s20, v2
    s_mul_i32 s25, s24, 16
    s_add_u32 s25, s25, 4
    v_lshrrev_b32 v2, 4, v1
    v_add_u32 v2, s25, v2
    v_and_b32 v3, 3, v2
    v_lshlrev_b32 v3, 2, v3
    v_and_b32 v4, 15, v1
    v_xor_b32 v3, v3, v4
    v_mul_lo_u32 v2, v2, s17
    v_lshl_add_u32 v2, v3, 4, v2
    v_add_u32 v19, s20, v2
    s_mul_i32 s25, s24, 16
    s_add_u32 s25, s25, 8
    v_lshrrev_b32 v2, 4, v1
    v_add_u32 v2, s25, v2
    v_and_b32 v3, 3, v2
    v_lshlrev_b32 v3, 2, v3
    v_and_b32 v4, 15, v1
    v_xor_b32 v3, v3, v4
    v_mul_lo_u32 v2, v2, s17
    v_lshl_add_u32 v2, v3, 4, v2
    v_add_u32 v20, s20, v2
    s_mul_i32 s25, s24, 16
    s_add_u32 s25, s25, 12
    v_lshrrev_b32 v2, 4, v1
    v_add_u32 v2, s25, v2
    v_and_b32 v3, 3, v2
    v_lshlrev_b32 v3, 2, v3
    v_and_b32 v4, 15, v1
    v_xor_b32 v3, v3, v4
    v_mul_lo_u32 v2, v2, s17
    v_lshl_add_u32 v2, v3, 4, v2
    v_add_u32 v21, s20, v2
    s_mov_b32 s41, 0
    s_mov_b32 s42, 0
    s_mov_b32 s43, 0
    s_mov_b32 s44, 0
    s_mov_b32 s45, 32768
    s_mul_i32 s47, s24, 4096
    s_mul_i32 s48, s24, 4096
    s_add_u32 s48, s48, 16384
    s_mul_i32 s49, s17, 64
    s_mov_b32 s52, s18
    s_add_u32 s50, s43, s47
    s_add_u32 m0, s50, 0
    s_nop 0
    buffer_load_dwordx4 v14, s[4:7], s41 offen lds
    s_add_u32 m0, s50, 1024
    s_nop 0
    buffer_load_dwordx4 v15, s[4:7], s41 offen lds
    s_add_u32 m0, s50, 2048
    s_nop 0
    buffer_load_dwordx4 v16, s[4:7], s41 offen lds
    s_add_u32 m0, s50, 3072
    s_nop 0
    buffer_load_dwordx4 v17, s[4:7], s41 offen lds
    s_add_u32 s51, s43, s48
    s_add_u32 m0, s51, 0
    s_nop 0
    buffer_load_dwordx4 v18, s[8:11], s42 offen lds
    s_add_u32 m0, s51, 1024
    s_nop 0
    buffer_load_dwordx4 v19, s[8:11], s42 offen lds
    s_add_u32 m0, s51, 2048
    s_nop 0
    buffer_load_dwordx4 v20, s[8:11], s42 offen lds
    s_add_u32 m0, s51, 3072
    s_nop 0
    buffer_load_dwordx4 v21, s[8:11], s42 offen lds
    s_add_u32 s41, s41, 16384
    s_add_u32 s42, s42, s49
    s_add_u32 s43, s43, 32768
    s_cmp_eq_u32 s43, 163840
    s_cselect_b32 s43, 0, s43
    s_add_u32 s50, s43, s47
    s_add_u32 m0, s50, 0
    s_nop 0
    buffer_load_dwordx4 v14, s[4:7], s41 offen lds
    s_add_u32 m0, s50, 1024
    s_nop 0
    buffer_load_dwordx4 v15, s[4:7], s41 offen lds
    s_add_u32 m0, s50, 2048
    s_nop 0
    buffer_load_dwordx4 v16, s[4:7], s41 offen lds
    s_add_u32 m0, s50, 3072
    s_nop 0
    buffer_load_dwordx4 v17, s[4:7], s41 offen lds
    s_add_u32 s51, s43, s48
    s_add_u32 m0, s51, 0
    s_nop 0
    buffer_load_dwordx4 v18, s[8:11], s42 offen lds
    s_add_u32 m0, s51, 1024
    s_nop 0
    buffer_load_dwordx4 v19, s[8:11], s42 offen lds
    s_add_u32 m0, s51, 2048
    s_nop 0
    buffer_load_dwordx4 v20, s[8:11], s42 offen lds
    s_add_u32 m0, s51, 3072
    s_nop 0
    buffer_load_dwordx4 v21, s[8:11], s42 offen lds
    s_add_u32 s41, s41, 16384
    s_add_u32 s42, s42, s49
    s_add_u32 s43, s43, 32768
    s_cmp_eq_u32 s43, 163840
    s_cselect_b32 s43, 0, s43
    s_add_u32 s50, s43, s47
    s_add_u32 m0, s50, 0
    s_nop 0
    buffer_load_dwordx4 v14, s[4:7], s41 offen lds
    s_add_u32 m0, s50, 1024
    s_nop 0
    buffer_load_dwordx4 v15, s[4:7], s41 offen lds
    s_add_u32 m0, s50, 2048
    s_nop 0
    buffer_load_dwordx4 v16, s[4:7], s41 offen lds
    s_add_u32 m0, s50, 3072
    s_nop 0
    buffer_load_dwordx4 v17, s[4:7], s41 offen lds
    s_add_u32 s51, s43, s48
    s_add_u32 m0, s51, 0
    s_nop 0
    buffer_load_dwordx4 v18, s[8:11], s42 offen lds
    s_add_u32 m0, s51, 1024
    s_nop 0
    buffer_load_dwordx4 v19, s[8:11], s42 offen lds
    s_add_u32 m0, s51, 2048
    s_nop 0
    buffer_load_dwordx4 v20, s[8:11], s42 offen lds
    s_add_u32 m0, s51, 3072
    s_nop 0
    buffer_load_dwordx4 v21, s[8:11], s42 offen lds
    s_add_u32 s41, s41, 16384
    s_add_u32 s42, s42, s49
    s_add_u32 s43, s43, 32768
    s_cmp_eq_u32 s43, 163840
    s_cselect_b32 s43, 0, s43
    s_add_u32 s50, s43, s47
    s_add_u32 m0, s50, 0
    s_nop 0
    buffer_load_dwordx4 v14, s[4:7], s41 offen lds
    s_add_u32 m0, s50, 1024
    s_nop 0
    buffer_load_dwordx4 v15, s[4:7], s41 offen lds
    s_add_u32 m0, s50, 2048
    s_nop 0
    buffer_load_dwordx4 v16, s[4:7], s41 offen lds
    s_add_u32 m0, s50, 3072
    s_nop 0
    buffer_load_dwordx4 v17, s[4:7], s41 offen lds
    s_add_u32 s51, s43, s48
    s_add_u32 m0, s51, 0
    s_nop 0
    buffer_load_dwordx4 v18, s[8:11], s42 offen lds
    s_add_u32 m0, s51, 1024
    s_nop 0
    buffer_load_dwordx4 v19, s[8:11], s42 offen lds
    s_add_u32 m0, s51, 2048
    s_nop 0
    buffer_load_dwordx4 v20, s[8:11], s42 offen lds
    s_add_u32 m0, s51, 3072
    s_nop 0
    buffer_load_dwordx4 v21, s[8:11], s42 offen lds
    s_add_u32 s41, s41, 16384
    s_add_u32 s42, s42, s49
    s_add_u32 s43, s43, 32768
    s_cmp_eq_u32 s43, 163840
    s_cselect_b32 s43, 0, s43
    v_lshlrev_b32 v240, 4, v1
    s_lshl_b32 s25, s69, 16
    s_lshl_b32 s26, s24, 14
    s_add_u32 s25, s25, s26
    buffer_store_dwordx4 v[40:43], v240, s[72:75], s25 offen offset:0 sc1
    buffer_store_dwordx4 v[44:47], v240, s[72:75], s25 offen offset:1024 sc1
    buffer_store_dwordx4 v[48:51], v240, s[72:75], s25 offen offset:2048 sc1
    buffer_store_dwordx4 v[52:55], v240, s[72:75], s25 offen offset:3072 sc1
    s_add_u32 s25, s25, 4096
    buffer_store_dwordx4 v[56:59], v240, s[72:75], s25 offen offset:0 sc1
    buffer_store_dwordx4 v[60:63], v240, s[72:75], s25 offen offset:1024 sc1
    buffer_store_dwordx4 v[64:67], v240, s[72:75], s25 offen offset:2048 sc1
    buffer_store_dwordx4 v[68:71], v240, s[72:75], s25 offen offset:3072 sc1
    s_add_u32 s25, s25, 4096
    buffer_store_dwordx4 v[72:75], v240, s[72:75], s25 offen offset:0 sc1
    buffer_store_dwordx4 v[76:79], v240, s[72:75], s25 offen offset:1024 sc1
    buffer_store_dwordx4 v[80:83], v240, s[72:75], s25 offen offset:2048 sc1
    buffer_store_dwordx4 v[84:87], v240, s[72:75], s25 offen offset:3072 sc1
    s_add_u32 s25, s25, 4096
    buffer_store_dwordx4 v[88:91], v240, s[72:75], s25 offen offset:0 sc1
    buffer_store_dwordx4 v[92:95], v240, s[72:75], s25 offen offset:1024 sc1
    buffer_store_dwordx4 v[96:99], v240, s[72:75], s25 offen offset:2048 sc1
    buffer_store_dwordx4 v[100:103], v240, s[72:75], s25 offen offset:3072 sc1
    s_add_u32 s25, s25, 4096
    s_waitcnt vmcnt(0)
    s_barrier
    s_lshr_b32 s26, s69, 1
    s_lshl_b32 s26, s26, 2
    v_mov_b32 v241, s26
    s_and_b32 s26, s69, 1
    s_lshl_b32 s26, s26, 4
    s_lshl_b32 s26, 1, s26
    v_mov_b32 v242, s26
    s_cmp_lg_u32 s24, 0
    s_cbranch_scc1 L_outp_kernel_noflag_5
    s_mov_b64 exec, 1
    buffer_atomic_or v242, v241, s[76:79], 0 offen
    s_mov_b64 exec, -1
L_outp_kernel_noflag_5:
    s_mov_b32 s12, s58
    s_and_b32 s13, s59, 0xffff
    s_mov_b32 s14, 0x800000
    s_mov_b32 s15, 0x20000
    s_mov_b32 s23, 1.0
    s_mov_b32 s22, 4096
    s_lshl_b32 s21, s66, 19
    s_lshl_b32 s68, s67, 8
    s_add_u32 s21, s21, s68
    s_and_b32 s53, s24, 1
    s_lshr_b32 s54, s24, 1
    s_mul_i32 s25, s53, 64
    v_and_b32 v2, 31, v1
    v_add_u32 v2, s25, v2
    v_lshrrev_b32 v3, 1, v2
    v_and_b32 v3, 7, v3
    v_lshrrev_b32 v4, 5, v1
    v_xor_b32 v3, v3, v4
    v_lshlrev_b32 v2, 7, v2
    v_xor_b32 v4, 0, v3
    v_lshl_add_u32 v31, v4, 4, v2
    v_xor_b32 v4, 2, v3
    v_lshl_add_u32 v32, v4, 4, v2
    v_xor_b32 v4, 4, v3
    v_lshl_add_u32 v33, v4, 4, v2
    v_xor_b32 v4, 6, v3
    v_lshl_add_u32 v34, v4, 4, v2
    v_lshrrev_b32 v2, 5, v1
    v_lshlrev_b32 v2, 3, v2
    v_bfe_u32 v3, v1, 2, 2
    v_add_u32 v2, v2, v3
    v_and_b32 v3, 3, v2
    v_lshlrev_b32 v3, 2, v3
    v_lshlrev_b32 v2, 8, v2
    s_mul_i32 s25, s54, 8
    s_add_u32 s25, s25, 0
    v_bfe_u32 v4, v1, 4, 1
    v_lshlrev_b32 v4, 1, v4
    v_bfe_u32 v5, v1, 1, 1
    v_add3_u32 v4, v4, v5, s25
    v_xor_b32 v4, v4, v3
    v_lshl_add_u32 v4, v4, 4, v2
    v_and_b32 v5, 1, v1
    v_lshl_add_u32 v4, v5, 3, v4
    v_add_u32 v35, 16384, v4
    s_mul_i32 s25, s54, 8
    s_add_u32 s25, s25, 4
    v_bfe_u32 v4, v1, 4, 1
    v_lshlrev_b32 v4, 1, v4
    v_bfe_u32 v5, v1, 1, 1
    v_add3_u32 v4, v4, v5, s25
    v_xor_b32 v4, v4, v3
    v_lshl_add_u32 v4, v4, 4, v2
    v_and_b32 v5, 1, v1
    v_lshl_add_u32 v4, v5, 3, v4
    v_add_u32 v36, 16384, v4
    v_mov_b32 v40, 0
    v_mov_b32 v41, 0
    v_mov_b32 v42, 0
    v_mov_b32 v43, 0
    v_mov_b32 v44, 0
    v_mov_b32 v45, 0
    v_mov_b32 v46, 0
    v_mov_b32 v47, 0
    v_mov_b32 v48, 0
    v_mov_b32 v49, 0
    v_mov_b32 v50, 0
    v_mov_b32 v51, 0
    v_mov_b32 v52, 0
    v_mov_b32 v53, 0
    v_mov_b32 v54, 0
    v_mov_b32 v55, 0
    v_mov_b32 v56, 0
    v_mov_b32 v57, 0
    v_mov_b32 v58, 0
    v_mov_b32 v59, 0
    v_mov_b32 v60, 0
    v_mov_b32 v61, 0
    v_mov_b32 v62, 0
    v_mov_b32 v63, 0
    v_mov_b32 v64, 0
    v_mov_b32 v65, 0
    v_mov_b32 v66, 0
    v_mov_b32 v67, 0
    v_mov_b32 v68, 0
    v_mov_b32 v69, 0
    v_mov_b32 v70, 0
    v_mov_b32 v71, 0
    v_mov_b32 v72, 0
    v_mov_b32 v73, 0
    v_mov_b32 v74, 0
    v_mov_b32 v75, 0
    v_mov_b32 v76, 0
    v_mov_b32 v77, 0
    v_mov_b32 v78, 0
    v_mov_b32 v79, 0
    v_mov_b32 v80, 0
    v_mov_b32 v81, 0
    v_mov_b32 v82, 0
    v_mov_b32 v83, 0
    v_mov_b32 v84, 0
    v_mov_b32 v85, 0
    v_mov_b32 v86, 0
    v_mov_b32 v87, 0
    v_mov_b32 v88, 0
    v_mov_b32 v89, 0
    v_mov_b32 v90, 0
    v_mov_b32 v91, 0
    v_mov_b32 v92, 0
    v_mov_b32 v93, 0
    v_mov_b32 v94, 0
    v_mov_b32 v95, 0
    v_mov_b32 v96, 0
    v_mov_b32 v97, 0
    v_mov_b32 v98, 0
    v_mov_b32 v99, 0
    v_mov_b32 v100, 0
    v_mov_b32 v101, 0
    v_mov_b32 v102, 0
    v_mov_b32 v103, 0
    s_waitcnt vmcnt(16)
    s_barrier
    ds_read_b128 v[104:107], v31 offset:0
    ds_read_b128 v[108:111], v31 offset:4096
    ds_read_b64_tr_b16 v[168:169], v35 offset:0
    ds_read_b64_tr_b16 v[170:171], v35 offset:1024
    ds_read_b64_tr_b16 v[172:173], v36 offset:0
    ds_read_b64_tr_b16 v[174:175], v36 offset:1024
    ds_read_b128 v[112:115], v32 offset:0
    ds_read_b128 v[116:119], v32 offset:4096
    ds_read_b64_tr_b16 v[176:177], v35 offset:4096
    ds_read_b64_tr_b16 v[178:179], v35 offset:5120
    ds_read_b64_tr_b16 v[180:181], v36 offset:4096
    ds_read_b64_tr_b16 v[182:183], v36 offset:5120
    ds_read_b128 v[120:123], v33 offset:0
    ds_read_b128 v[124:127], v33 offset:4096
    ds_read_b64_tr_b16 v[184:185], v35 offset:8192
    ds_read_b64_tr_b16 v[186:187], v35 offset:9216
    ds_read_b64_tr_b16 v[188:189], v36 offset:8192
    ds_read_b64_tr_b16 v[190:191], v36 offset:9216
    ds_read_b128 v[128:131], v34 offset:0
    ds_read_b128 v[132:135], v34 offset:4096
    ds_read_b64_tr_b16 v[192:193], v35 offset:12288
    ds_read_b64_tr_b16 v[194:195], v35 offset:13312
    ds_read_b64_tr_b16 v[196:197], v36 offset:12288
    ds_read_b64_tr_b16 v[198:199], v36 offset:13312
    s_sub_u32 s46, s52, 4
L_outp_kernel_main_6:
    v_add_u32 v232, s45, v31
    v_add_u32 v233, s45, v32
    v_add_u32 v234, s45, v33
    v_add_u32 v235, s45, v34
    v_add_u32 v236, s45, v35
    v_add_u32 v237, s45, v36
    s_waitcnt lgkmcnt(0)
    v_mfma_f32_32x32x16_bf16 v[40:55], v[168:171], v[104:107], v[40:55]
    ds_read_b128 v[136:139], v232 offset:0
    ds_read_b128 v[140:143], v232 offset:4096
    ds_read_b64_tr_b16 v[200:201], v236 offset:0
    v_mfma_f32_32x32x16_bf16 v[56:71], v[172:175], v[104:107], v[56:71]
    s_add_u32 s50, s43, s47
    s_add_u32 m0, s50, 0
    s_nop 0
    buffer_load_dwordx4 v14, s[4:7], s41 offen lds
    ds_read_b64_tr_b16 v[202:203], v236 offset:1024
    ds_read_b64_tr_b16 v[204:205], v237 offset:0
    v_mfma_f32_32x32x16_bf16 v[72:87], v[168:171], v[108:111], v[72:87]
    ds_read_b64_tr_b16 v[206:207], v237 offset:1024
    s_add_u32 m0, s50, 1024
    s_nop 0
    buffer_load_dwordx4 v15, s[4:7], s41 offen lds
    ds_read_b128 v[144:147], v233 offset:0
    v_mfma_f32_32x32x16_bf16 v[88:103], v[172:175], v[108:111], v[88:103]
    ds_read_b128 v[148:151], v233 offset:4096
    s_add_u32 m0, s50, 2048
    s_nop 0
    buffer_load_dwordx4 v16, s[4:7], s41 offen lds
    ds_read_b64_tr_b16 v[208:209], v236 offset:4096
    v_mfma_f32_32x32x16_bf16 v[40:55], v[176:179], v[112:115], v[40:55]
    ds_read_b64_tr_b16 v[210:211], v236 offset:5120
    ds_read_b64_tr_b16 v[212:213], v237 offset:4096
    s_add_u32 m0, s50, 3072
    s_nop 0
    buffer_load_dwordx4 v17, s[4:7], s41 offen lds
    v_mfma_f32_32x32x16_bf16 v[56:71], v[180:183], v[112:115], v[56:71]
    ds_read_b64_tr_b16 v[214:215], v237 offset:5120
    ds_read_b128 v[152:155], v234 offset:0
    ds_read_b128 v[156:159], v234 offset:4096
    v_mfma_f32_32x32x16_bf16 v[72:87], v[176:179], v[116:119], v[72:87]
    s_add_u32 s51, s43, s48
    s_add_u32 m0, s51, 0
    s_nop 0
    buffer_load_dwordx4 v18, s[8:11], s42 offen lds
    ds_read_b64_tr_b16 v[216:217], v236 offset:8192
    ds_read_b64_tr_b16 v[218:219], v236 offset:9216
    v_mfma_f32_32x32x16_bf16 v[88:103], v[180:183], v[116:119], v[88:103]
    s_add_u32 m0, s51, 1024
    s_nop 0
    buffer_load_dwordx4 v19, s[8:11], s42 offen lds
    ds_read_b64_tr_b16 v[220:221], v237 offset:8192
    ds_read_b64_tr_b16 v[222:223], v237 offset:9216
    v_mfma_f32_32x32x16_bf16 v[40:55], v[184:187], v[120:123], v[40:55]
    ds_read_b128 v[160:163], v235 offset:0
    s_add_u32 m0, s51, 2048
    s_nop 0
    buffer_load_dwordx4 v20, s[8:11], s42 offen lds
    ds_read_b128 v[164:167], v235 offset:4096
    v_mfma_f32_32x32x16_bf16 v[56:71], v[188:191], v[120:123], v[56:71]
    ds_read_b64_tr_b16 v[224:225], v236 offset:12288
    ds_read_b64_tr_b16 v[226:227], v236 offset:13312
    s_add_u32 m0, s51, 3072
    s_nop 0
    buffer_load_dwordx4 v21, s[8:11], s42 offen lds
    v_mfma_f32_32x32x16_bf16 v[72:87], v[184:187], v[124:127], v[72:87]
    ds_read_b64_tr_b16 v[228:229], v237 offset:12288
    ds_read_b64_tr_b16 v[230:231], v237 offset:13312
    s_add_u32 s41, s41, 16384
    s_add_u32 s42, s42, s49
    s_add_u32 s43, s43, 32768
    s_cmp_eq_u32 s43, 163840
    s_cselect_b32 s43, 0, s43
    v_mfma_f32_32x32x16_bf16 v[88:103], v[188:191], v[124:127], v[88:103]
    v_mfma_f32_32x32x16_bf16 v[40:55], v[192:195], v[128:131], v[40:55]
    v_mfma_f32_32x32x16_bf16 v[56:71], v[196:199], v[128:131], v[56:71]
    v_mfma_f32_32x32x16_bf16 v[72:87], v[192:195], v[132:135], v[72:87]
    v_mfma_f32_32x32x16_bf16 v[88:103], v[196:199], v[132:135], v[88:103]
    s_add_u32 s45, s45, 32768
    s_cmp_eq_u32 s45, 163840
    s_cselect_b32 s45, 0, s45
    s_waitcnt vmcnt(16)
    s_barrier
    v_add_u32 v232, s45, v31
    v_add_u32 v233, s45, v32
    v_add_u32 v234, s45, v33
    v_add_u32 v235, s45, v34
    v_add_u32 v236, s45, v35
    v_add_u32 v237, s45, v36
    s_waitcnt lgkmcnt(0)
    v_mfma_f32_32x32x16_bf16 v[40:55], v[200:203], v[136:139], v[40:55]
    ds_read_b128 v[104:107], v232 offset:0
    ds_read_b128 v[108:111], v232 offset:4096
    ds_read_b64_tr_b16 v[168:169], v236 offset:0
    v_mfma_f32_32x32x16_bf16 v[56:71], v[204:207], v[136:139], v[56:71]
    s_add_u32 s50, s43, s47
    s_add_u32 m0, s50, 0
    s_nop 0
    buffer_load_dwordx4 v14, s[4:7], s41 offen lds
    ds_read_b64_tr_b16 v[170:171], v236 offset:1024
    ds_read_b64_tr_b16 v[172:173], v237 offset:0
    v_mfma_f32_32x32x16_bf16 v[72:87], v[200:203], v[140:143], v[72:87]
    ds_read_b64_tr_b16 v[174:175], v237 offset:1024
    s_add_u32 m0, s50, 1024
    s_nop 0
    buffer_load_dwordx4 v15, s[4:7], s41 offen lds
    ds_read_b128 v[112:115], v233 offset:0
    v_mfma_f32_32x32x16_bf16 v[88:103], v[204:207], v[140:143], v[88:103]
    ds_read_b128 v[116:119], v233 offset:4096
    s_add_u32 m0, s50, 2048
    s_nop 0
    buffer_load_dwordx4 v16, s[4:7], s41 offen lds
    ds_read_b64_tr_b16 v[176:177], v236 offset:4096
    v_mfma_f32_32x32x16_bf16 v[40:55], v[208:211], v[144:147], v[40:55]
    ds_read_b64_tr_b16 v[178:179], v236 offset:5120
    ds_read_b64_tr_b16 v[180:181], v237 offset:4096
    s_add_u32 m0, s50, 3072
    s_nop 0
    buffer_load_dwordx4 v17, s[4:7], s41 offen lds
    v_mfma_f32_32x32x16_bf16 v[56:71], v[212:215], v[144:147], v[56:71]
    ds_read_b64_tr_b16 v[182:183], v237 offset:5120
    ds_read_b128 v[120:123], v234 offset:0
    ds_read_b128 v[124:127], v234 offset:4096
    v_mfma_f32_32x32x16_bf16 v[72:87], v[208:211], v[148:151], v[72:87]
    s_add_u32 s51, s43, s48
    s_add_u32 m0, s51, 0
    s_nop 0
    buffer_load_dwordx4 v18, s[8:11], s42 offen lds
    ds_read_b64_tr_b16 v[184:185], v236 offset:8192
    ds_read_b64_tr_b16 v[186:187], v236 offset:9216
    v_mfma_f32_32x32x16_bf16 v[88:103], v[212:215], v[148:151], v[88:103]
    s_add_u32 m0, s51, 1024
    s_nop 0
    buffer_load_dwordx4 v19, s[8:11], s42 offen lds
    ds_read_b64_tr_b16 v[188:189], v237 offset:8192
    ds_read_b64_tr_b16 v[190:191], v237 offset:9216
    v_mfma_f32_32x32x16_bf16 v[40:55], v[216:219], v[152:155], v[40:55]
    ds_read_b128 v[128:131], v235 offset:0
    s_add_u32 m0, s51, 2048
    s_nop 0
    buffer_load_dwordx4 v20, s[8:11], s42 offen lds
    ds_read_b128 v[132:135], v235 offset:4096
    v_mfma_f32_32x32x16_bf16 v[56:71], v[220:223], v[152:155], v[56:71]
    ds_read_b64_tr_b16 v[192:193], v236 offset:12288
    ds_read_b64_tr_b16 v[194:195], v236 offset:13312
    s_add_u32 m0, s51, 3072
    s_nop 0
    buffer_load_dwordx4 v21, s[8:11], s42 offen lds
    v_mfma_f32_32x32x16_bf16 v[72:87], v[216:219], v[156:159], v[72:87]
    ds_read_b64_tr_b16 v[196:197], v237 offset:12288
    ds_read_b64_tr_b16 v[198:199], v237 offset:13312
    s_add_u32 s41, s41, 16384
    s_add_u32 s42, s42, s49
    s_add_u32 s43, s43, 32768
    s_cmp_eq_u32 s43, 163840
    s_cselect_b32 s43, 0, s43
    v_mfma_f32_32x32x16_bf16 v[88:103], v[220:223], v[156:159], v[88:103]
    v_mfma_f32_32x32x16_bf16 v[40:55], v[224:227], v[160:163], v[40:55]
    v_mfma_f32_32x32x16_bf16 v[56:71], v[228:231], v[160:163], v[56:71]
    v_mfma_f32_32x32x16_bf16 v[72:87], v[224:227], v[164:167], v[72:87]
    v_mfma_f32_32x32x16_bf16 v[88:103], v[228:231], v[164:167], v[88:103]
    s_add_u32 s45, s45, 32768
    s_cmp_eq_u32 s45, 163840
    s_cselect_b32 s45, 0, s45
    s_waitcnt vmcnt(16)
    s_barrier
    s_sub_u32 s46, s46, 2
    s_cmp_lg_u32 s46, 0
    s_cbranch_scc1 L_outp_kernel_main_6
    s_mov_b32 s46, 4
L_outp_kernel_tail_7:
    v_add_u32 v232, s45, v31
    v_add_u32 v233, s45, v32
    v_add_u32 v234, s45, v33
    v_add_u32 v235, s45, v34
    v_add_u32 v236, s45, v35
    v_add_u32 v237, s45, v36
    s_waitcnt lgkmcnt(0)
    v_mfma_f32_32x32x16_bf16 v[40:55], v[168:171], v[104:107], v[40:55]
    ds_read_b128 v[136:139], v232 offset:0
    ds_read_b128 v[140:143], v232 offset:4096
    v_mfma_f32_32x32x16_bf16 v[56:71], v[172:175], v[104:107], v[56:71]
    ds_read_b64_tr_b16 v[200:201], v236 offset:0
    ds_read_b64_tr_b16 v[202:203], v236 offset:1024
    v_mfma_f32_32x32x16_bf16 v[72:87], v[168:171], v[108:111], v[72:87]
    ds_read_b64_tr_b16 v[204:205], v237 offset:0
    ds_read_b64_tr_b16 v[206:207], v237 offset:1024
    v_mfma_f32_32x32x16_bf16 v[88:103], v[172:175], v[108:111], v[88:103]
    ds_read_b128 v[144:147], v233 offset:0
    ds_read_b128 v[148:151], v233 offset:4096
    v_mfma_f32_32x32x16_bf16 v[40:55], v[176:179], v[112:115], v[40:55]
    ds_read_b64_tr_b16 v[208:209], v236 offset:4096
    ds_read_b64_tr_b16 v[210:211], v236 offset:5120
    v_mfma_f32_32x32x16_bf16 v[56:71], v[180:183], v[112:115], v[56:71]
    ds_read_b64_tr_b16 v[212:213], v237 offset:4096
    ds_read_b64_tr_b16 v[214:215], v237 offset:5120
    v_mfma_f32_32x32x16_bf16 v[72:87], v[176:179], v[116:119], v[72:87]
    ds_read_b128 v[152:155], v234 offset:0
    ds_read_b128 v[156:159], v234 offset:4096
    v_mfma_f32_32x32x16_bf16 v[88:103], v[180:183], v[116:119], v[88:103]
    ds_read_b64_tr_b16 v[216:217], v236 offset:8192
    ds_read_b64_tr_b16 v[218:219], v236 offset:9216
    v_mfma_f32_32x32x16_bf16 v[40:55], v[184:187], v[120:123], v[40:55]
    ds_read_b64_tr_b16 v[220:221], v237 offset:8192
    ds_read_b64_tr_b16 v[222:223], v237 offset:9216
    v_mfma_f32_32x32x16_bf16 v[56:71], v[188:191], v[120:123], v[56:71]
    ds_read_b128 v[160:163], v235 offset:0
    ds_read_b128 v[164:167], v235 offset:4096
    v_mfma_f32_32x32x16_bf16 v[72:87], v[184:187], v[124:127], v[72:87]
    ds_read_b64_tr_b16 v[224:225], v236 offset:12288
    ds_read_b64_tr_b16 v[226:227], v236 offset:13312
    v_mfma_f32_32x32x16_bf16 v[88:103], v[188:191], v[124:127], v[88:103]
    ds_read_b64_tr_b16 v[228:229], v237 offset:12288
    ds_read_b64_tr_b16 v[230:231], v237 offset:13312
    v_mfma_f32_32x32x16_bf16 v[40:55], v[192:195], v[128:131], v[40:55]
    v_mfma_f32_32x32x16_bf16 v[56:71], v[196:199], v[128:131], v[56:71]
    v_mfma_f32_32x32x16_bf16 v[72:87], v[192:195], v[132:135], v[72:87]
    v_mfma_f32_32x32x16_bf16 v[88:103], v[196:199], v[132:135], v[88:103]
    s_add_u32 s45, s45, 32768
    s_cmp_eq_u32 s45, 163840
    s_cselect_b32 s45, 0, s45
    s_waitcnt vmcnt(0)
    s_barrier
    v_add_u32 v232, s45, v31
    v_add_u32 v233, s45, v32
    v_add_u32 v234, s45, v33
    v_add_u32 v235, s45, v34
    v_add_u32 v236, s45, v35
    v_add_u32 v237, s45, v36
    s_waitcnt lgkmcnt(0)
    v_mfma_f32_32x32x16_bf16 v[40:55], v[200:203], v[136:139], v[40:55]
    ds_read_b128 v[104:107], v232 offset:0
    ds_read_b128 v[108:111], v232 offset:4096
    v_mfma_f32_32x32x16_bf16 v[56:71], v[204:207], v[136:139], v[56:71]
    ds_read_b64_tr_b16 v[168:169], v236 offset:0
    ds_read_b64_tr_b16 v[170:171], v236 offset:1024
    v_mfma_f32_32x32x16_bf16 v[72:87], v[200:203], v[140:143], v[72:87]
    ds_read_b64_tr_b16 v[172:173], v237 offset:0
    ds_read_b64_tr_b16 v[174:175], v237 offset:1024
    v_mfma_f32_32x32x16_bf16 v[88:103], v[204:207], v[140:143], v[88:103]
    ds_read_b128 v[112:115], v233 offset:0
    ds_read_b128 v[116:119], v233 offset:4096
    v_mfma_f32_32x32x16_bf16 v[40:55], v[208:211], v[144:147], v[40:55]
    ds_read_b64_tr_b16 v[176:177], v236 offset:4096
    ds_read_b64_tr_b16 v[178:179], v236 offset:5120
    v_mfma_f32_32x32x16_bf16 v[56:71], v[212:215], v[144:147], v[56:71]
    ds_read_b64_tr_b16 v[180:181], v237 offset:4096
    ds_read_b64_tr_b16 v[182:183], v237 offset:5120
    v_mfma_f32_32x32x16_bf16 v[72:87], v[208:211], v[148:151], v[72:87]
    ds_read_b128 v[120:123], v234 offset:0
    ds_read_b128 v[124:127], v234 offset:4096
    v_mfma_f32_32x32x16_bf16 v[88:103], v[212:215], v[148:151], v[88:103]
    ds_read_b64_tr_b16 v[184:185], v236 offset:8192
    ds_read_b64_tr_b16 v[186:187], v236 offset:9216
    v_mfma_f32_32x32x16_bf16 v[40:55], v[216:219], v[152:155], v[40:55]
    ds_read_b64_tr_b16 v[188:189], v237 offset:8192
    ds_read_b64_tr_b16 v[190:191], v237 offset:9216
    v_mfma_f32_32x32x16_bf16 v[56:71], v[220:223], v[152:155], v[56:71]
    ds_read_b128 v[128:131], v235 offset:0
    ds_read_b128 v[132:135], v235 offset:4096
    v_mfma_f32_32x32x16_bf16 v[72:87], v[216:219], v[156:159], v[72:87]
    ds_read_b64_tr_b16 v[192:193], v236 offset:12288
    ds_read_b64_tr_b16 v[194:195], v236 offset:13312
    v_mfma_f32_32x32x16_bf16 v[88:103], v[220:223], v[156:159], v[88:103]
    ds_read_b64_tr_b16 v[196:197], v237 offset:12288
    ds_read_b64_tr_b16 v[198:199], v237 offset:13312
    v_mfma_f32_32x32x16_bf16 v[40:55], v[224:227], v[160:163], v[40:55]
    v_mfma_f32_32x32x16_bf16 v[56:71], v[228:231], v[160:163], v[56:71]
    v_mfma_f32_32x32x16_bf16 v[72:87], v[224:227], v[164:167], v[72:87]
    v_mfma_f32_32x32x16_bf16 v[88:103], v[228:231], v[164:167], v[88:103]
    s_add_u32 s45, s45, 32768
    s_cmp_eq_u32 s45, 163840
    s_cselect_b32 s45, 0, s45
    s_waitcnt vmcnt(0)
    s_barrier
    s_sub_u32 s46, s46, 2
    s_cmp_lg_u32 s46, 0
    s_cbranch_scc1 L_outp_kernel_tail_7
    s_waitcnt lgkmcnt(0)
    s_nop 15
    s_lshl_b32 s25, s24, 12
    s_add_u32 s25, s25, 0
    v_and_b32 v243, 31, v1
    v_lshlrev_b32 v240, 7, v243
    v_add_u32 v240, s25, v240
    v_and_b32 v243, 7, v243
    v_lshrrev_b32 v241, 5, v1
    v_xor_b32 v243, v243, v241
    v_lshl_add_u32 v240, v243, 4, v240
    v_lshrrev_b32 v243, 3, v1
    v_xor_b32 v241, v243, v1
    v_and_b32 v241, 7, v241
    v_lshlrev_b32 v241, 4, v241
    v_lshl_add_u32 v241, v243, 7, v241
    v_add_u32 v241, s25, v241
    v_mul_lo_u32 v242, v243, s22
    v_and_b32 v243, 7, v1
    v_lshl_add_u32 v242, v243, 4, v242
    s_mul_i32 s25, s53, 64
    s_mul_i32 s25, s25, s22
    s_add_u32 s25, s25, s21
    s_mul_i32 s26, s54, 128
    s_add_u32 s25, s25, s26
    s_mul_i32 s26, s22, 8
    v_cvt_pk_bf16_f32 v40, v40, v41
    v_cvt_pk_bf16_f32 v41, v42, v43
    v_cvt_pk_bf16_f32 v42, v44, v45
    v_cvt_pk_bf16_f32 v43, v46, v47
    v_cvt_pk_bf16_f32 v44, v48, v49
    v_cvt_pk_bf16_f32 v45, v50, v51
    v_cvt_pk_bf16_f32 v46, v52, v53
    v_cvt_pk_bf16_f32 v47, v54, v55
    s_nop 1
    v_permlane32_swap_b32 v40, v42
    v_permlane32_swap_b32 v41, v43
    v_permlane32_swap_b32 v44, v46
    v_permlane32_swap_b32 v45, v47
    s_nop 0
    ds_write_b128 v240, v[40:43]
    v_xor_b32 v243, 32, v240
    ds_write_b128 v243, v[44:47]
    v_cvt_pk_bf16_f32 v56, v56, v57
    v_cvt_pk_bf16_f32 v57, v58, v59
    v_cvt_pk_bf16_f32 v58, v60, v61
    v_cvt_pk_bf16_f32 v59, v62, v63
    v_cvt_pk_bf16_f32 v60, v64, v65
    v_cvt_pk_bf16_f32 v61, v66, v67
    v_cvt_pk_bf16_f32 v62, v68, v69
    v_cvt_pk_bf16_f32 v63, v70, v71
    s_nop 1
    v_permlane32_swap_b32 v56, v58
    v_permlane32_swap_b32 v57, v59
    v_permlane32_swap_b32 v60, v62
    v_permlane32_swap_b32 v61, v63
    v_xor_b32 v243, 64, v240
    ds_write_b128 v243, v[56:59]
    v_xor_b32 v243, 96, v240
    ds_write_b128 v243, v[60:63]
    s_waitcnt lgkmcnt(0)
    ds_read_b128 v[48:51], v241 offset:0
    ds_read_b128 v[52:55], v241 offset:1024
    ds_read_b128 v[64:67], v241 offset:2048
    ds_read_b128 v[68:71], v241 offset:3072
    s_waitcnt lgkmcnt(3)
    buffer_store_dwordx4 v[48:51], v242, s[12:15], s25 offen
    s_add_u32 s25, s25, s26
    s_waitcnt lgkmcnt(2)
    buffer_store_dwordx4 v[52:55], v242, s[12:15], s25 offen
    s_add_u32 s25, s25, s26
    s_waitcnt lgkmcnt(1)
    buffer_store_dwordx4 v[64:67], v242, s[12:15], s25 offen
    s_add_u32 s25, s25, s26
    s_waitcnt lgkmcnt(0)
    buffer_store_dwordx4 v[68:71], v242, s[12:15], s25 offen
    s_add_u32 s25, s25, s26
    v_cvt_pk_bf16_f32 v72, v72, v73
    v_cvt_pk_bf16_f32 v73, v74, v75
    v_cvt_pk_bf16_f32 v74, v76, v77
    v_cvt_pk_bf16_f32 v75, v78, v79
    v_cvt_pk_bf16_f32 v76, v80, v81
    v_cvt_pk_bf16_f32 v77, v82, v83
    v_cvt_pk_bf16_f32 v78, v84, v85
    v_cvt_pk_bf16_f32 v79, v86, v87
    s_nop 1
    v_permlane32_swap_b32 v72, v74
    v_permlane32_swap_b32 v73, v75
    v_permlane32_swap_b32 v76, v78
    v_permlane32_swap_b32 v77, v79
    s_nop 0
    ds_write_b128 v240, v[72:75]
    v_xor_b32 v243, 32, v240
    ds_write_b128 v243, v[76:79]
    v_cvt_pk_bf16_f32 v88, v88, v89
    v_cvt_pk_bf16_f32 v89, v90, v91
    v_cvt_pk_bf16_f32 v90, v92, v93
    v_cvt_pk_bf16_f32 v91, v94, v95
    v_cvt_pk_bf16_f32 v92, v96, v97
    v_cvt_pk_bf16_f32 v93, v98, v99
    v_cvt_pk_bf16_f32 v94, v100, v101
    v_cvt_pk_bf16_f32 v95, v102, v103
    s_nop 1
    v_permlane32_swap_b32 v88, v90
    v_permlane32_swap_b32 v89, v91
    v_permlane32_swap_b32 v92, v94
    v_permlane32_swap_b32 v93, v95
    v_xor_b32 v243, 64, v240
    ds_write_b128 v243, v[88:91]
    v_xor_b32 v243, 96, v240
    ds_write_b128 v243, v[92:95]
    s_waitcnt lgkmcnt(0)
    ds_read_b128 v[80:83], v241 offset:0
    ds_read_b128 v[84:87], v241 offset:1024
    ds_read_b128 v[96:99], v241 offset:2048
    ds_read_b128 v[100:103], v241 offset:3072
    s_waitcnt lgkmcnt(3)
    buffer_store_dwordx4 v[80:83], v242, s[12:15], s25 offen
    s_add_u32 s25, s25, s26
    s_waitcnt lgkmcnt(2)
    buffer_store_dwordx4 v[84:87], v242, s[12:15], s25 offen
    s_add_u32 s25, s25, s26
    s_waitcnt lgkmcnt(1)
    buffer_store_dwordx4 v[96:99], v242, s[12:15], s25 offen
    s_add_u32 s25, s25, s26
    s_waitcnt lgkmcnt(0)
    buffer_store_dwordx4 v[100:103], v242, s[12:15], s25 offen
    s_add_u32 s25, s25, s26
    s_nop 1
    s_branch L_outp_kernel_end_1
L_outp_kernel_cons_2:
    s_add_u32 s4, s56, 0x3000000
    s_addc_u32 s5, s57, 0
    s_and_b32 s5, s5, 0xffff
    s_mov_b32 s6, 0x1000000
    s_mov_b32 s7, 0x20000
    s_mov_b32 s8, s60
    s_and_b32 s9, s61, 0xffff
    s_mov_b32 s10, 0x800000
    s_mov_b32 s11, 0x20000
    s_mov_b32 s16, 128
    s_mov_b32 s17, 2048
    s_mov_b32 s18, 44
    s_lshl_b32 s19, s66, 20
    s_lshl_b32 s20, s67, 8
    s_mul_i32 s25, s24, 32
    s_add_u32 s25, s25, 0
    v_lshrrev_b32 v2, 3, v1
    v_add_u32 v2, s25, v2
    v_lshrrev_b32 v3, 1, v2
    v_and_b32 v3, 7, v3
    v_and_b32 v4, 7, v1
    v_xor_b32 v3, v3, v4
    v_mul_lo_u32 v2, v2, s16
    v_lshl_add_u32 v2, v3, 4, v2
    v_add_u32 v6, s19, v2
    s_mul_i32 s25, s24, 32
    s_add_u32 s25, s25, 8
    v_lshrrev_b32 v2, 3, v1
    v_add_u32 v2, s25, v2
    v_lshrrev_b32 v3, 1, v2
    v_and_b32 v3, 7, v3
    v_and_b32 v4, 7, v1
    v_xor_b32 v3, v3, v4
    v_mul_lo_u32 v2, v2, s16
    v_lshl_add_u32 v2, v3, 4, v2
    v_add_u32 v7, s19, v2
    s_mul_i32 s25, s24, 32
    s_add_u32 s25, s25, 16
    v_lshrrev_b32 v2, 3, v1
    v_add_u32 v2, s25, v2
    v_lshrrev_b32 v3, 1, v2
    v_and_b32 v3, 7, v3
    v_and_b32 v4, 7, v1
    v_xor_b32 v3, v3, v4
    v_mul_lo_u32 v2, v2, s16
    v_lshl_add_u32 v2, v3, 4, v2
    v_add_u32 v8, s19, v2
    s_mul_i32 s25, s24, 32
    s_add_u32 s25, s25, 24
    v_lshrrev_b32 v2, 3, v1
    v_add_u32 v2, s25, v2
    v_lshrrev_b32 v3, 1, v2
    v_and_b32 v3, 7, v3
    v_and_b32 v4, 7, v1
    v_xor_b32 v3, v3, v4
    v_mul_lo_u32 v2, v2, s16
    v_lshl_add_u32 v2, v3, 4, v2
    v_add_u32 v9, s19, v2
    s_mul_i32 s25, s24, 16
    s_add_u32 s25, s25, 0
    v_lshrrev_b32 v2, 4, v1
    v_add_u32 v2, s25, v2
    v_and_b32 v3, 3, v2
    v_lshlrev_b32 v3, 2, v3
    v_and_b32 v4, 15, v1
    v_xor_b32 v3, v3, v4
    v_mul_lo_u32 v2, v2, s17
    v_lshl_add_u32 v2, v3, 4, v2
    v_add_u32 v10, s20, v2
    s_mul_i32 s25, s24, 16
    s_add_u32 s25, s25, 4
    v_lshrrev_b32 v2, 4, v1
    v_add_u32 v2, s25, v2
    v_and_b32 v3, 3, v2
    v_lshlrev_b32 v3, 2, v3
    v_and_b32 v4, 15, v1
    v_xor_b32 v3, v3, v4
    v_mul_lo_u32 v2, v2, s17
    v_lshl_add_u32 v2, v3, 4, v2
    v_add_u32 v11, s20, v2
    s_mul_i32 s25, s24, 16
    s_add_u32 s25, s25, 8
    v_lshrrev_b32 v2, 4, v1
    v_add_u32 v2, s25, v2
    v_and_b32 v3, 3, v2
    v_lshlrev_b32 v3, 2, v3
    v_and_b32 v4, 15, v1
    v_xor_b32 v3, v3, v4
    v_mul_lo_u32 v2, v2, s17
    v_lshl_add_u32 v2, v3, 4, v2
    v_add_u32 v12, s20, v2
    s_mul_i32 s25, s24, 16
    s_add_u32 s25, s25, 12
    v_lshrrev_b32 v2, 4, v1
    v_add_u32 v2, s25, v2
    v_and_b32 v3, 3, v2
    v_lshlrev_b32 v3, 2, v3
    v_and_b32 v4, 15, v1
    v_xor_b32 v3, v3, v4
    v_mul_lo_u32 v2, v2, s17
    v_lshl_add_u32 v2, v3, 4, v2
    v_add_u32 v13, s20, v2
    s_mov_b32 s27, 0
    s_mov_b32 s28, 0
    s_mov_b32 s29, 0
    s_mov_b32 s30, 0
    s_mov_b32 s31, 32768
    s_mul_i32 s33, s24, 4096
    s_mul_i32 s34, s24, 4096
    s_add_u32 s34, s34, 16384
    s_mul_i32 s35, s17, 64
    s_mov_b32 s38, s18
    s_add_u32 s36, s29, s33
    s_add_u32 m0, s36, 0
    s_nop 0
    buffer_load_dwordx4 v6, s[4:7], s27 offen lds
    s_add_u32 m0, s36, 1024
    s_nop 0
    buffer_load_dwordx4 v7, s[4:7], s27 offen lds
    s_add_u32 m0, s36, 2048
    s_nop 0
    buffer_load_dwordx4 v8, s[4:7], s27 offen lds
    s_add_u32 m0, s36, 3072
    s_nop 0
    buffer_load_dwordx4 v9, s[4:7], s27 offen lds
    s_add_u32 s37, s29, s34
    s_add_u32 m0, s37, 0
    s_nop 0
    buffer_load_dwordx4 v10, s[8:11], s28 offen lds
    s_add_u32 m0, s37, 1024
    s_nop 0
    buffer_load_dwordx4 v11, s[8:11], s28 offen lds
    s_add_u32 m0, s37, 2048
    s_nop 0
    buffer_load_dwordx4 v12, s[8:11], s28 offen lds
    s_add_u32 m0, s37, 3072
    s_nop 0
    buffer_load_dwordx4 v13, s[8:11], s28 offen lds
    s_add_u32 s27, s27, 16384
    s_add_u32 s28, s28, s35
    s_add_u32 s29, s29, 32768
    s_cmp_eq_u32 s29, 163840
    s_cselect_b32 s29, 0, s29
    s_add_u32 s36, s29, s33
    s_add_u32 m0, s36, 0
    s_nop 0
    buffer_load_dwordx4 v6, s[4:7], s27 offen lds
    s_add_u32 m0, s36, 1024
    s_nop 0
    buffer_load_dwordx4 v7, s[4:7], s27 offen lds
    s_add_u32 m0, s36, 2048
    s_nop 0
    buffer_load_dwordx4 v8, s[4:7], s27 offen lds
    s_add_u32 m0, s36, 3072
    s_nop 0
    buffer_load_dwordx4 v9, s[4:7], s27 offen lds
    s_add_u32 s37, s29, s34
    s_add_u32 m0, s37, 0
    s_nop 0
    buffer_load_dwordx4 v10, s[8:11], s28 offen lds
    s_add_u32 m0, s37, 1024
    s_nop 0
    buffer_load_dwordx4 v11, s[8:11], s28 offen lds
    s_add_u32 m0, s37, 2048
    s_nop 0
    buffer_load_dwordx4 v12, s[8:11], s28 offen lds
    s_add_u32 m0, s37, 3072
    s_nop 0
    buffer_load_dwordx4 v13, s[8:11], s28 offen lds
    s_add_u32 s27, s27, 16384
    s_add_u32 s28, s28, s35
    s_add_u32 s29, s29, 32768
    s_cmp_eq_u32 s29, 163840
    s_cselect_b32 s29, 0, s29
    s_add_u32 s36, s29, s33
    s_add_u32 m0, s36, 0
    s_nop 0
    buffer_load_dwordx4 v6, s[4:7], s27 offen lds
    s_add_u32 m0, s36, 1024
    s_nop 0
    buffer_load_dwordx4 v7, s[4:7], s27 offen lds
    s_add_u32 m0, s36, 2048
    s_nop 0
    buffer_load_dwordx4 v8, s[4:7], s27 offen lds
    s_add_u32 m0, s36, 3072
    s_nop 0
    buffer_load_dwordx4 v9, s[4:7], s27 offen lds
    s_add_u32 s37, s29, s34
    s_add_u32 m0, s37, 0
    s_nop 0
    buffer_load_dwordx4 v10, s[8:11], s28 offen lds
    s_add_u32 m0, s37, 1024
    s_nop 0
    buffer_load_dwordx4 v11, s[8:11], s28 offen lds
    s_add_u32 m0, s37, 2048
    s_nop 0
    buffer_load_dwordx4 v12, s[8:11], s28 offen lds
    s_add_u32 m0, s37, 3072
    s_nop 0
    buffer_load_dwordx4 v13, s[8:11], s28 offen lds
    s_add_u32 s27, s27, 16384
    s_add_u32 s28, s28, s35
    s_add_u32 s29, s29, 32768
    s_cmp_eq_u32 s29, 163840
    s_cselect_b32 s29, 0, s29
    s_add_u32 s36, s29, s33
    s_add_u32 m0, s36, 0
    s_nop 0
    buffer_load_dwordx4 v6, s[4:7], s27 offen lds
    s_add_u32 m0, s36, 1024
    s_nop 0
    buffer_load_dwordx4 v7, s[4:7], s27 offen lds
    s_add_u32 m0, s36, 2048
    s_nop 0
    buffer_load_dwordx4 v8, s[4:7], s27 offen lds
    s_add_u32 m0, s36, 3072
    s_nop 0
    buffer_load_dwordx4 v9, s[4:7], s27 offen lds
    s_add_u32 s37, s29, s34
    s_add_u32 m0, s37, 0
    s_nop 0
    buffer_load_dwordx4 v10, s[8:11], s28 offen lds
    s_add_u32 m0, s37, 1024
    s_nop 0
    buffer_load_dwordx4 v11, s[8:11], s28 offen lds
    s_add_u32 m0, s37, 2048
    s_nop 0
    buffer_load_dwordx4 v12, s[8:11], s28 offen lds
    s_add_u32 m0, s37, 3072
    s_nop 0
    buffer_load_dwordx4 v13, s[8:11], s28 offen lds
    s_add_u32 s27, s27, 16384
    s_add_u32 s28, s28, s35
    s_add_u32 s29, s29, 32768
    s_cmp_eq_u32 s29, 163840
    s_cselect_b32 s29, 0, s29
    s_mov_b32 s12, s58
    s_and_b32 s13, s59, 0xffff
    s_mov_b32 s14, 0x800000
    s_mov_b32 s15, 0x20000
    s_mov_b32 s23, 1.0
    s_mov_b32 s22, 4096
    s_lshl_b32 s21, s66, 19
    s_lshl_b32 s68, s67, 8
    s_add_u32 s21, s21, s68
    s_add_u32 s21, s21, 2048
    s_and_b32 s39, s24, 1
    s_lshr_b32 s40, s24, 1
    s_mul_i32 s25, s39, 64
    v_and_b32 v2, 31, v1
    v_add_u32 v2, s25, v2
    v_lshrrev_b32 v3, 1, v2
    v_and_b32 v3, 7, v3
    v_lshrrev_b32 v4, 5, v1
    v_xor_b32 v3, v3, v4
    v_lshlrev_b32 v2, 7, v2
    v_xor_b32 v4, 0, v3
    v_lshl_add_u32 v31, v4, 4, v2
    v_xor_b32 v4, 2, v3
    v_lshl_add_u32 v32, v4, 4, v2
    v_xor_b32 v4, 4, v3
    v_lshl_add_u32 v33, v4, 4, v2
    v_xor_b32 v4, 6, v3
    v_lshl_add_u32 v34, v4, 4, v2
    v_lshrrev_b32 v2, 5, v1
    v_lshlrev_b32 v2, 3, v2
    v_bfe_u32 v3, v1, 2, 2
    v_add_u32 v2, v2, v3
    v_and_b32 v3, 3, v2
    v_lshlrev_b32 v3, 2, v3
    v_lshlrev_b32 v2, 8, v2
    s_mul_i32 s25, s40, 8
    s_add_u32 s25, s25, 0
    v_bfe_u32 v4, v1, 4, 1
    v_lshlrev_b32 v4, 1, v4
    v_bfe_u32 v5, v1, 1, 1
    v_add3_u32 v4, v4, v5, s25
    v_xor_b32 v4, v4, v3
    v_lshl_add_u32 v4, v4, 4, v2
    v_and_b32 v5, 1, v1
    v_lshl_add_u32 v4, v5, 3, v4
    v_add_u32 v35, 16384, v4
    s_mul_i32 s25, s40, 8
    s_add_u32 s25, s25, 4
    v_bfe_u32 v4, v1, 4, 1
    v_lshlrev_b32 v4, 1, v4
    v_bfe_u32 v5, v1, 1, 1
    v_add3_u32 v4, v4, v5, s25
    v_xor_b32 v4, v4, v3
    v_lshl_add_u32 v4, v4, 4, v2
    v_and_b32 v5, 1, v1
    v_lshl_add_u32 v4, v5, 3, v4
    v_add_u32 v36, 16384, v4
    v_mov_b32 v40, 0
    v_mov_b32 v41, 0
    v_mov_b32 v42, 0
    v_mov_b32 v43, 0
    v_mov_b32 v44, 0
    v_mov_b32 v45, 0
    v_mov_b32 v46, 0
    v_mov_b32 v47, 0
    v_mov_b32 v48, 0
    v_mov_b32 v49, 0
    v_mov_b32 v50, 0
    v_mov_b32 v51, 0
    v_mov_b32 v52, 0
    v_mov_b32 v53, 0
    v_mov_b32 v54, 0
    v_mov_b32 v55, 0
    v_mov_b32 v56, 0
    v_mov_b32 v57, 0
    v_mov_b32 v58, 0
    v_mov_b32 v59, 0
    v_mov_b32 v60, 0
    v_mov_b32 v61, 0
    v_mov_b32 v62, 0
    v_mov_b32 v63, 0
    v_mov_b32 v64, 0
    v_mov_b32 v65, 0
    v_mov_b32 v66, 0
    v_mov_b32 v67, 0
    v_mov_b32 v68, 0
    v_mov_b32 v69, 0
    v_mov_b32 v70, 0
    v_mov_b32 v71, 0
    v_mov_b32 v72, 0
    v_mov_b32 v73, 0
    v_mov_b32 v74, 0
    v_mov_b32 v75, 0
    v_mov_b32 v76, 0
    v_mov_b32 v77, 0
    v_mov_b32 v78, 0
    v_mov_b32 v79, 0
    v_mov_b32 v80, 0
    v_mov_b32 v81, 0
    v_mov_b32 v82, 0
    v_mov_b32 v83, 0
    v_mov_b32 v84, 0
    v_mov_b32 v85, 0
    v_mov_b32 v86, 0
    v_mov_b32 v87, 0
    v_mov_b32 v88, 0
    v_mov_b32 v89, 0
    v_mov_b32 v90, 0
    v_mov_b32 v91, 0
    v_mov_b32 v92, 0
    v_mov_b32 v93, 0
    v_mov_b32 v94, 0
    v_mov_b32 v95, 0
    v_mov_b32 v96, 0
    v_mov_b32 v97, 0
    v_mov_b32 v98, 0
    v_mov_b32 v99, 0
    v_mov_b32 v100, 0
    v_mov_b32 v101, 0
    v_mov_b32 v102, 0
    v_mov_b32 v103, 0
    s_waitcnt vmcnt(16)
    s_barrier
    ds_read_b128 v[104:107], v31 offset:0
    ds_read_b128 v[108:111], v31 offset:4096
    ds_read_b64_tr_b16 v[168:169], v35 offset:0
    ds_read_b64_tr_b16 v[170:171], v35 offset:1024
    ds_read_b64_tr_b16 v[172:173], v36 offset:0
    ds_read_b64_tr_b16 v[174:175], v36 offset:1024
    ds_read_b128 v[112:115], v32 offset:0
    ds_read_b128 v[116:119], v32 offset:4096
    ds_read_b64_tr_b16 v[176:177], v35 offset:4096
    ds_read_b64_tr_b16 v[178:179], v35 offset:5120
    ds_read_b64_tr_b16 v[180:181], v36 offset:4096
    ds_read_b64_tr_b16 v[182:183], v36 offset:5120
    ds_read_b128 v[120:123], v33 offset:0
    ds_read_b128 v[124:127], v33 offset:4096
    ds_read_b64_tr_b16 v[184:185], v35 offset:8192
    ds_read_b64_tr_b16 v[186:187], v35 offset:9216
    ds_read_b64_tr_b16 v[188:189], v36 offset:8192
    ds_read_b64_tr_b16 v[190:191], v36 offset:9216
    ds_read_b128 v[128:131], v34 offset:0
    ds_read_b128 v[132:135], v34 offset:4096
    ds_read_b64_tr_b16 v[192:193], v35 offset:12288
    ds_read_b64_tr_b16 v[194:195], v35 offset:13312
    ds_read_b64_tr_b16 v[196:197], v36 offset:12288
    ds_read_b64_tr_b16 v[198:199], v36 offset:13312
    s_sub_u32 s32, s38, 4
L_outp_kernel_main_8:
    v_add_u32 v232, s31, v31
    v_add_u32 v233, s31, v32
    v_add_u32 v234, s31, v33
    v_add_u32 v235, s31, v34
    v_add_u32 v236, s31, v35
    v_add_u32 v237, s31, v36
    s_waitcnt lgkmcnt(0)
    v_mfma_f32_32x32x16_bf16 v[40:55], v[168:171], v[104:107], v[40:55]
    ds_read_b128 v[136:139], v232 offset:0
    ds_read_b128 v[140:143], v232 offset:4096
    ds_read_b64_tr_b16 v[200:201], v236 offset:0
    v_mfma_f32_32x32x16_bf16 v[56:71], v[172:175], v[104:107], v[56:71]
    s_add_u32 s36, s29, s33
    s_add_u32 m0, s36, 0
    s_nop 0
    buffer_load_dwordx4 v6, s[4:7], s27 offen lds
    ds_read_b64_tr_b16 v[202:203], v236 offset:1024
    ds_read_b64_tr_b16 v[204:205], v237 offset:0
    v_mfma_f32_32x32x16_bf16 v[72:87], v[168:171], v[108:111], v[72:87]
    ds_read_b64_tr_b16 v[206:207], v237 offset:1024
    s_add_u32 m0, s36, 1024
    s_nop 0
    buffer_load_dwordx4 v7, s[4:7], s27 offen lds
    ds_read_b128 v[144:147], v233 offset:0
    v_mfma_f32_32x32x16_bf16 v[88:103], v[172:175], v[108:111], v[88:103]
    ds_read_b128 v[148:151], v233 offset:4096
    s_add_u32 m0, s36, 2048
    s_nop 0
    buffer_load_dwordx4 v8, s[4:7], s27 offen lds
    ds_read_b64_tr_b16 v[208:209], v236 offset:4096
    v_mfma_f32_32x32x16_bf16 v[40:55], v[176:179], v[112:115], v[40:55]
    ds_read_b64_tr_b16 v[210:211], v236 offset:5120
    ds_read_b64_tr_b16 v[212:213], v237 offset:4096
    s_add_u32 m0, s36, 3072
    s_nop 0
    buffer_load_dwordx4 v9, s[4:7], s27 offen lds
    v_mfma_f32_32x32x16_bf16 v[56:71], v[180:183], v[112:115], v[56:71]
    ds_read_b64_tr_b16 v[214:215], v237 offset:5120
    ds_read_b128 v[152:155], v234 offset:0
    ds_read_b128 v[156:159], v234 offset:4096
    v_mfma_f32_32x32x16_bf16 v[72:87], v[176:179], v[116:119], v[72:87]
    s_add_u32 s37, s29, s34
    s_add_u32 m0, s37, 0
    s_nop 0
    buffer_load_dwordx4 v10, s[8:11], s28 offen lds
    ds_read_b64_tr_b16 v[216:217], v236 offset:8192
    ds_read_b64_tr_b16 v[218:219], v236 offset:9216
    v_mfma_f32_32x32x16_bf16 v[88:103], v[180:183], v[116:119], v[88:103]
    s_add_u32 m0, s37, 1024
    s_nop 0
    buffer_load_dwordx4 v11, s[8:11], s28 offen lds
    ds_read_b64_tr_b16 v[220:221], v237 offset:8192
    ds_read_b64_tr_b16 v[222:223], v237 offset:9216
    v_mfma_f32_32x32x16_bf16 v[40:55], v[184:187], v[120:123], v[40:55]
    ds_read_b128 v[160:163], v235 offset:0
    s_add_u32 m0, s37, 2048
    s_nop 0
    buffer_load_dwordx4 v12, s[8:11], s28 offen lds
    ds_read_b128 v[164:167], v235 offset:4096
    v_mfma_f32_32x32x16_bf16 v[56:71], v[188:191], v[120:123], v[56:71]
    ds_read_b64_tr_b16 v[224:225], v236 offset:12288
    ds_read_b64_tr_b16 v[226:227], v236 offset:13312
    s_add_u32 m0, s37, 3072
    s_nop 0
    buffer_load_dwordx4 v13, s[8:11], s28 offen lds
    v_mfma_f32_32x32x16_bf16 v[72:87], v[184:187], v[124:127], v[72:87]
    ds_read_b64_tr_b16 v[228:229], v237 offset:12288
    ds_read_b64_tr_b16 v[230:231], v237 offset:13312
    s_add_u32 s27, s27, 16384
    s_add_u32 s28, s28, s35
    s_add_u32 s29, s29, 32768
    s_cmp_eq_u32 s29, 163840
    s_cselect_b32 s29, 0, s29
    v_mfma_f32_32x32x16_bf16 v[88:103], v[188:191], v[124:127], v[88:103]
    v_mfma_f32_32x32x16_bf16 v[40:55], v[192:195], v[128:131], v[40:55]
    v_mfma_f32_32x32x16_bf16 v[56:71], v[196:199], v[128:131], v[56:71]
    v_mfma_f32_32x32x16_bf16 v[72:87], v[192:195], v[132:135], v[72:87]
    v_mfma_f32_32x32x16_bf16 v[88:103], v[196:199], v[132:135], v[88:103]
    s_add_u32 s31, s31, 32768
    s_cmp_eq_u32 s31, 163840
    s_cselect_b32 s31, 0, s31
    s_waitcnt vmcnt(16)
    s_barrier
    v_add_u32 v232, s31, v31
    v_add_u32 v233, s31, v32
    v_add_u32 v234, s31, v33
    v_add_u32 v235, s31, v34
    v_add_u32 v236, s31, v35
    v_add_u32 v237, s31, v36
    s_waitcnt lgkmcnt(0)
    v_mfma_f32_32x32x16_bf16 v[40:55], v[200:203], v[136:139], v[40:55]
    ds_read_b128 v[104:107], v232 offset:0
    ds_read_b128 v[108:111], v232 offset:4096
    ds_read_b64_tr_b16 v[168:169], v236 offset:0
    v_mfma_f32_32x32x16_bf16 v[56:71], v[204:207], v[136:139], v[56:71]
    s_add_u32 s36, s29, s33
    s_add_u32 m0, s36, 0
    s_nop 0
    buffer_load_dwordx4 v6, s[4:7], s27 offen lds
    ds_read_b64_tr_b16 v[170:171], v236 offset:1024
    ds_read_b64_tr_b16 v[172:173], v237 offset:0
    v_mfma_f32_32x32x16_bf16 v[72:87], v[200:203], v[140:143], v[72:87]
    ds_read_b64_tr_b16 v[174:175], v237 offset:1024
    s_add_u32 m0, s36, 1024
    s_nop 0
    buffer_load_dwordx4 v7, s[4:7], s27 offen lds
    ds_read_b128 v[112:115], v233 offset:0
    v_mfma_f32_32x32x16_bf16 v[88:103], v[204:207], v[140:143], v[88:103]
    ds_read_b128 v[116:119], v233 offset:4096
    s_add_u32 m0, s36, 2048
    s_nop 0
    buffer_load_dwordx4 v8, s[4:7], s27 offen lds
    ds_read_b64_tr_b16 v[176:177], v236 offset:4096
    v_mfma_f32_32x32x16_bf16 v[40:55], v[208:211], v[144:147], v[40:55]
    ds_read_b64_tr_b16 v[178:179], v236 offset:5120
    ds_read_b64_tr_b16 v[180:181], v237 offset:4096
    s_add_u32 m0, s36, 3072
    s_nop 0
    buffer_load_dwordx4 v9, s[4:7], s27 offen lds
    v_mfma_f32_32x32x16_bf16 v[56:71], v[212:215], v[144:147], v[56:71]
    ds_read_b64_tr_b16 v[182:183], v237 offset:5120
    ds_read_b128 v[120:123], v234 offset:0
    ds_read_b128 v[124:127], v234 offset:4096
    v_mfma_f32_32x32x16_bf16 v[72:87], v[208:211], v[148:151], v[72:87]
    s_add_u32 s37, s29, s34
    s_add_u32 m0, s37, 0
    s_nop 0
    buffer_load_dwordx4 v10, s[8:11], s28 offen lds
    ds_read_b64_tr_b16 v[184:185], v236 offset:8192
    ds_read_b64_tr_b16 v[186:187], v236 offset:9216
    v_mfma_f32_32x32x16_bf16 v[88:103], v[212:215], v[148:151], v[88:103]
    s_add_u32 m0, s37, 1024
    s_nop 0
    buffer_load_dwordx4 v11, s[8:11], s28 offen lds
    ds_read_b64_tr_b16 v[188:189], v237 offset:8192
    ds_read_b64_tr_b16 v[190:191], v237 offset:9216
    v_mfma_f32_32x32x16_bf16 v[40:55], v[216:219], v[152:155], v[40:55]
    ds_read_b128 v[128:131], v235 offset:0
    s_add_u32 m0, s37, 2048
    s_nop 0
    buffer_load_dwordx4 v12, s[8:11], s28 offen lds
    ds_read_b128 v[132:135], v235 offset:4096
    v_mfma_f32_32x32x16_bf16 v[56:71], v[220:223], v[152:155], v[56:71]
    ds_read_b64_tr_b16 v[192:193], v236 offset:12288
    ds_read_b64_tr_b16 v[194:195], v236 offset:13312
    s_add_u32 m0, s37, 3072
    s_nop 0
    buffer_load_dwordx4 v13, s[8:11], s28 offen lds
    v_mfma_f32_32x32x16_bf16 v[72:87], v[216:219], v[156:159], v[72:87]
    ds_read_b64_tr_b16 v[196:197], v237 offset:12288
    ds_read_b64_tr_b16 v[198:199], v237 offset:13312
    s_add_u32 s27, s27, 16384
    s_add_u32 s28, s28, s35
    s_add_u32 s29, s29, 32768
    s_cmp_eq_u32 s29, 163840
    s_cselect_b32 s29, 0, s29
    v_mfma_f32_32x32x16_bf16 v[88:103], v[220:223], v[156:159], v[88:103]
    v_mfma_f32_32x32x16_bf16 v[40:55], v[224:227], v[160:163], v[40:55]
    v_mfma_f32_32x32x16_bf16 v[56:71], v[228:231], v[160:163], v[56:71]
    v_mfma_f32_32x32x16_bf16 v[72:87], v[224:227], v[164:167], v[72:87]
    v_mfma_f32_32x32x16_bf16 v[88:103], v[228:231], v[164:167], v[88:103]
    s_add_u32 s31, s31, 32768
    s_cmp_eq_u32 s31, 163840
    s_cselect_b32 s31, 0, s31
    s_waitcnt vmcnt(16)
    s_barrier
    s_sub_u32 s32, s32, 2
    s_cmp_lg_u32 s32, 0
    s_cbranch_scc1 L_outp_kernel_main_8
    s_mov_b32 s32, 4
L_outp_kernel_tail_9:
    v_add_u32 v232, s31, v31
    v_add_u32 v233, s31, v32
    v_add_u32 v234, s31, v33
    v_add_u32 v235, s31, v34
    v_add_u32 v236, s31, v35
    v_add_u32 v237, s31, v36
    s_waitcnt lgkmcnt(0)
    v_mfma_f32_32x32x16_bf16 v[40:55], v[168:171], v[104:107], v[40:55]
    ds_read_b128 v[136:139], v232 offset:0
    ds_read_b128 v[140:143], v232 offset:4096
    v_mfma_f32_32x32x16_bf16 v[56:71], v[172:175], v[104:107], v[56:71]
    ds_read_b64_tr_b16 v[200:201], v236 offset:0
    ds_read_b64_tr_b16 v[202:203], v236 offset:1024
    v_mfma_f32_32x32x16_bf16 v[72:87], v[168:171], v[108:111], v[72:87]
    ds_read_b64_tr_b16 v[204:205], v237 offset:0
    ds_read_b64_tr_b16 v[206:207], v237 offset:1024
    v_mfma_f32_32x32x16_bf16 v[88:103], v[172:175], v[108:111], v[88:103]
    ds_read_b128 v[144:147], v233 offset:0
    ds_read_b128 v[148:151], v233 offset:4096
    v_mfma_f32_32x32x16_bf16 v[40:55], v[176:179], v[112:115], v[40:55]
    ds_read_b64_tr_b16 v[208:209], v236 offset:4096
    ds_read_b64_tr_b16 v[210:211], v236 offset:5120
    v_mfma_f32_32x32x16_bf16 v[56:71], v[180:183], v[112:115], v[56:71]
    ds_read_b64_tr_b16 v[212:213], v237 offset:4096
    ds_read_b64_tr_b16 v[214:215], v237 offset:5120
    v_mfma_f32_32x32x16_bf16 v[72:87], v[176:179], v[116:119], v[72:87]
    ds_read_b128 v[152:155], v234 offset:0
    ds_read_b128 v[156:159], v234 offset:4096
    v_mfma_f32_32x32x16_bf16 v[88:103], v[180:183], v[116:119], v[88:103]
    ds_read_b64_tr_b16 v[216:217], v236 offset:8192
    ds_read_b64_tr_b16 v[218:219], v236 offset:9216
    v_mfma_f32_32x32x16_bf16 v[40:55], v[184:187], v[120:123], v[40:55]
    ds_read_b64_tr_b16 v[220:221], v237 offset:8192
    ds_read_b64_tr_b16 v[222:223], v237 offset:9216
    v_mfma_f32_32x32x16_bf16 v[56:71], v[188:191], v[120:123], v[56:71]
    ds_read_b128 v[160:163], v235 offset:0
    ds_read_b128 v[164:167], v235 offset:4096
    v_mfma_f32_32x32x16_bf16 v[72:87], v[184:187], v[124:127], v[72:87]
    ds_read_b64_tr_b16 v[224:225], v236 offset:12288
    ds_read_b64_tr_b16 v[226:227], v236 offset:13312
    v_mfma_f32_32x32x16_bf16 v[88:103], v[188:191], v[124:127], v[88:103]
    ds_read_b64_tr_b16 v[228:229], v237 offset:12288
    ds_read_b64_tr_b16 v[230:231], v237 offset:13312
    v_mfma_f32_32x32x16_bf16 v[40:55], v[192:195], v[128:131], v[40:55]
    v_mfma_f32_32x32x16_bf16 v[56:71], v[196:199], v[128:131], v[56:71]
    v_mfma_f32_32x32x16_bf16 v[72:87], v[192:195], v[132:135], v[72:87]
    v_mfma_f32_32x32x16_bf16 v[88:103], v[196:199], v[132:135], v[88:103]
    s_add_u32 s31, s31, 32768
    s_cmp_eq_u32 s31, 163840
    s_cselect_b32 s31, 0, s31
    s_waitcnt vmcnt(0)
    s_barrier
    v_add_u32 v232, s31, v31
    v_add_u32 v233, s31, v32
    v_add_u32 v234, s31, v33
    v_add_u32 v235, s31, v34
    v_add_u32 v236, s31, v35
    v_add_u32 v237, s31, v36
    s_waitcnt lgkmcnt(0)
    v_mfma_f32_32x32x16_bf16 v[40:55], v[200:203], v[136:139], v[40:55]
    ds_read_b128 v[104:107], v232 offset:0
    ds_read_b128 v[108:111], v232 offset:4096
    v_mfma_f32_32x32x16_bf16 v[56:71], v[204:207], v[136:139], v[56:71]
    ds_read_b64_tr_b16 v[168:169], v236 offset:0
    ds_read_b64_tr_b16 v[170:171], v236 offset:1024
    v_mfma_f32_32x32x16_bf16 v[72:87], v[200:203], v[140:143], v[72:87]
    ds_read_b64_tr_b16 v[172:173], v237 offset:0
    ds_read_b64_tr_b16 v[174:175], v237 offset:1024
    v_mfma_f32_32x32x16_bf16 v[88:103], v[204:207], v[140:143], v[88:103]
    ds_read_b128 v[112:115], v233 offset:0
    ds_read_b128 v[116:119], v233 offset:4096
    v_mfma_f32_32x32x16_bf16 v[40:55], v[208:211], v[144:147], v[40:55]
    ds_read_b64_tr_b16 v[176:177], v236 offset:4096
    ds_read_b64_tr_b16 v[178:179], v236 offset:5120
    v_mfma_f32_32x32x16_bf16 v[56:71], v[212:215], v[144:147], v[56:71]
    ds_read_b64_tr_b16 v[180:181], v237 offset:4096
    ds_read_b64_tr_b16 v[182:183], v237 offset:5120
    v_mfma_f32_32x32x16_bf16 v[72:87], v[208:211], v[148:151], v[72:87]
    ds_read_b128 v[120:123], v234 offset:0
    ds_read_b128 v[124:127], v234 offset:4096
    v_mfma_f32_32x32x16_bf16 v[88:103], v[212:215], v[148:151], v[88:103]
    ds_read_b64_tr_b16 v[184:185], v236 offset:8192
    ds_read_b64_tr_b16 v[186:187], v236 offset:9216
    v_mfma_f32_32x32x16_bf16 v[40:55], v[216:219], v[152:155], v[40:55]
    ds_read_b64_tr_b16 v[188:189], v237 offset:8192
    ds_read_b64_tr_b16 v[190:191], v237 offset:9216
    v_mfma_f32_32x32x16_bf16 v[56:71], v[220:223], v[152:155], v[56:71]
    ds_read_b128 v[128:131], v235 offset:0
    ds_read_b128 v[132:135], v235 offset:4096
    v_mfma_f32_32x32x16_bf16 v[72:87], v[216:219], v[156:159], v[72:87]
    ds_read_b64_tr_b16 v[192:193], v236 offset:12288
    ds_read_b64_tr_b16 v[194:195], v236 offset:13312
    v_mfma_f32_32x32x16_bf16 v[88:103], v[220:223], v[156:159], v[88:103]
    ds_read_b64_tr_b16 v[196:197], v237 offset:12288
    ds_read_b64_tr_b16 v[198:199], v237 offset:13312
    v_mfma_f32_32x32x16_bf16 v[40:55], v[224:227], v[160:163], v[40:55]
    v_mfma_f32_32x32x16_bf16 v[56:71], v[228:231], v[160:163], v[56:71]
    v_mfma_f32_32x32x16_bf16 v[72:87], v[224:227], v[164:167], v[72:87]
    v_mfma_f32_32x32x16_bf16 v[88:103], v[228:231], v[164:167], v[88:103]
    s_add_u32 s31, s31, 32768
    s_cmp_eq_u32 s31, 163840
    s_cselect_b32 s31, 0, s31
    s_waitcnt vmcnt(0)
    s_barrier
    s_sub_u32 s32, s32, 2
    s_cmp_lg_u32 s32, 0
    s_cbranch_scc1 L_outp_kernel_tail_9
    s_waitcnt lgkmcnt(0)
    s_nop 15
    s_lshr_b32 s26, s69, 1
    s_lshl_b32 s26, s26, 2
    v_mov_b32 v240, s26
    s_and_b32 s26, s69, 1
    s_lshl_b32 s26, s26, 4
    s_lshl_b32 s26, 1, s26
    v_mov_b32 v241, s26
    s_mov_b32 s25, 0x400000
L_outp_kernel_poll_10:
    buffer_load_dword v242, v240, s[76:79], 0 offen sc1
    s_waitcnt vmcnt(0)
    v_and_b32 v242, v242, v241
    v_cmp_ne_u32 vcc, 0, v242
    s_cbranch_vccnz L_outp_kernel_ok_11
    s_sleep 2
    s_sub_u32 s25, s25, 1
    s_cmp_lg_u32 s25, 0
    s_cbranch_scc1 L_outp_kernel_poll_10
L_outp_kernel_ok_11:
    s_barrier
    v_lshlrev_b32 v243, 4, v1
    s_lshl_b32 s25, s69, 16
    s_lshl_b32 s26, s24, 14
    s_add_u32 s25, s25, s26
    buffer_load_dwordx4 v[104:107], v243, s[72:75], s25 offen offset:0 sc1
    buffer_load_dwordx4 v[108:111], v243, s[72:75], s25 offen offset:1024 sc1
    buffer_load_dwordx4 v[112:115], v243, s[72:75], s25 offen offset:2048 sc1
    buffer_load_dwordx4 v[116:119], v243, s[72:75], s25 offen offset:3072 sc1
    s_add_u32 s25, s25, 4096
    buffer_load_dwordx4 v[120:123], v243, s[72:75], s25 offen offset:0 sc1
    buffer_load_dwordx4 v[124:127], v243, s[72:75], s25 offen offset:1024 sc1
    buffer_load_dwordx4 v[128:131], v243, s[72:75], s25 offen offset:2048 sc1
    buffer_load_dwordx4 v[132:135], v243, s[72:75], s25 offen offset:3072 sc1
    s_add_u32 s25, s25, 4096
    buffer_load_dwordx4 v[136:139], v243, s[72:75], s25 offen offset:0 sc1
    buffer_load_dwordx4 v[140:143], v243, s[72:75], s25 offen offset:1024 sc1
    buffer_load_dwordx4 v[144:147], v243, s[72:75], s25 offen offset:2048 sc1
    buffer_load_dwordx4 v[148:151], v243, s[72:75], s25 offen offset:3072 sc1
    s_add_u32 s25, s25, 4096
    buffer_load_dwordx4 v[152:155], v243, s[72:75], s25 offen offset:0 sc1
    buffer_load_dwordx4 v[156:159], v243, s[72:75], s25 offen offset:1024 sc1
    buffer_load_dwordx4 v[160:163], v243, s[72:75], s25 offen offset:2048 sc1
    buffer_load_dwordx4 v[164:167], v243, s[72:75], s25 offen offset:3072 sc1
    s_add_u32 s25, s25, 4096
    s_waitcnt vmcnt(15)
    v_add_f32 v40, v40, v104
    v_add_f32 v41, v41, v105
    v_add_f32 v42, v42, v106
    v_add_f32 v43, v43, v107
    s_waitcnt vmcnt(14)
    v_add_f32 v44, v44, v108
    v_add_f32 v45, v45, v109
    v_add_f32 v46, v46, v110
    v_add_f32 v47, v47, v111
    s_waitcnt vmcnt(13)
    v_add_f32 v48, v48, v112
    v_add_f32 v49, v49, v113
    v_add_f32 v50, v50, v114
    v_add_f32 v51, v51, v115
    s_waitcnt vmcnt(12)
    v_add_f32 v52, v52, v116
    v_add_f32 v53, v53, v117
    v_add_f32 v54, v54, v118
    v_add_f32 v55, v55, v119
    s_waitcnt vmcnt(11)
    v_add_f32 v56, v56, v120
    v_add_f32 v57, v57, v121
    v_add_f32 v58, v58, v122
    v_add_f32 v59, v59, v123
    s_waitcnt vmcnt(10)
    v_add_f32 v60, v60, v124
    v_add_f32 v61, v61, v125
    v_add_f32 v62, v62, v126
    v_add_f32 v63, v63, v127
    s_waitcnt vmcnt(9)
    v_add_f32 v64, v64, v128
    v_add_f32 v65, v65, v129
    v_add_f32 v66, v66, v130
    v_add_f32 v67, v67, v131
    s_waitcnt vmcnt(8)
    v_add_f32 v68, v68, v132
    v_add_f32 v69, v69, v133
    v_add_f32 v70, v70, v134
    v_add_f32 v71, v71, v135
    s_waitcnt vmcnt(7)
    v_add_f32 v72, v72, v136
    v_add_f32 v73, v73, v137
    v_add_f32 v74, v74, v138
    v_add_f32 v75, v75, v139
    s_waitcnt vmcnt(6)
    v_add_f32 v76, v76, v140
    v_add_f32 v77, v77, v141
    v_add_f32 v78, v78, v142
    v_add_f32 v79, v79, v143
    s_waitcnt vmcnt(5)
    v_add_f32 v80, v80, v144
    v_add_f32 v81, v81, v145
    v_add_f32 v82, v82, v146
    v_add_f32 v83, v83, v147
    s_waitcnt vmcnt(4)
    v_add_f32 v84, v84, v148
    v_add_f32 v85, v85, v149
    v_add_f32 v86, v86, v150
    v_add_f32 v87, v87, v151
    s_waitcnt vmcnt(3)
    v_add_f32 v88, v88, v152
    v_add_f32 v89, v89, v153
    v_add_f32 v90, v90, v154
    v_add_f32 v91, v91, v155
    s_waitcnt vmcnt(2)
    v_add_f32 v92, v92, v156
    v_add_f32 v93, v93, v157
    v_add_f32 v94, v94, v158
    v_add_f32 v95, v95, v159
    s_waitcnt vmcnt(1)
    v_add_f32 v96, v96, v160
    v_add_f32 v97, v97, v161
    v_add_f32 v98, v98, v162
    v_add_f32 v99, v99, v163
    s_waitcnt vmcnt(0)
    v_add_f32 v100, v100, v164
    v_add_f32 v101, v101, v165
    v_add_f32 v102, v102, v166
    v_add_f32 v103, v103, v167
    s_lshl_b32 s25, s24, 12
    s_add_u32 s25, s25, 0
    v_and_b32 v247, 31, v1
    v_lshlrev_b32 v244, 7, v247
    v_add_u32 v244, s25, v244
    v_and_b32 v247, 7, v247
    v_lshrrev_b32 v245, 5, v1
    v_xor_b32 v247, v247, v245
    v_lshl_add_u32 v244, v247, 4, v244
    v_lshrrev_b32 v247, 3, v1
    v_xor_b32 v245, v247, v1
    v_and_b32 v245, 7, v245
    v_lshlrev_b32 v245, 4, v245
    v_lshl_add_u32 v245, v247, 7, v245
    v_add_u32 v245, s25, v245
    v_mul_lo_u32 v246, v247, s22
    v_and_b32 v247, 7, v1
    v_lshl_add_u32 v246, v247, 4, v246
    s_mul_i32 s25, s39, 64
    s_mul_i32 s25, s25, s22
    s_add_u32 s25, s25, s21
    s_mul_i32 s26, s40, 128
    s_add_u32 s25, s25, s26
    s_mul_i32 s26, s22, 8
    v_cvt_pk_bf16_f32 v40, v40, v41
    v_cvt_pk_bf16_f32 v41, v42, v43
    v_cvt_pk_bf16_f32 v42, v44, v45
    v_cvt_pk_bf16_f32 v43, v46, v47
    v_cvt_pk_bf16_f32 v44, v48, v49
    v_cvt_pk_bf16_f32 v45, v50, v51
    v_cvt_pk_bf16_f32 v46, v52, v53
    v_cvt_pk_bf16_f32 v47, v54, v55
    s_nop 1
    v_permlane32_swap_b32 v40, v42
    v_permlane32_swap_b32 v41, v43
    v_permlane32_swap_b32 v44, v46
    v_permlane32_swap_b32 v45, v47
    s_nop 0
    ds_write_b128 v244, v[40:43]
    v_xor_b32 v247, 32, v244
    ds_write_b128 v247, v[44:47]
    v_cvt_pk_bf16_f32 v56, v56, v57
    v_cvt_pk_bf16_f32 v57, v58, v59
    v_cvt_pk_bf16_f32 v58, v60, v61
    v_cvt_pk_bf16_f32 v59, v62, v63
    v_cvt_pk_bf16_f32 v60, v64, v65
    v_cvt_pk_bf16_f32 v61, v66, v67
    v_cvt_pk_bf16_f32 v62, v68, v69
    v_cvt_pk_bf16_f32 v63, v70, v71
    s_nop 1
    v_permlane32_swap_b32 v56, v58
    v_permlane32_swap_b32 v57, v59
    v_permlane32_swap_b32 v60, v62
    v_permlane32_swap_b32 v61, v63
    v_xor_b32 v247, 64, v244
    ds_write_b128 v247, v[56:59]
    v_xor_b32 v247, 96, v244
    ds_write_b128 v247, v[60:63]
    s_waitcnt lgkmcnt(0)
    ds_read_b128 v[48:51], v245 offset:0
    ds_read_b128 v[52:55], v245 offset:1024
    ds_read_b128 v[64:67], v245 offset:2048
    ds_read_b128 v[68:71], v245 offset:3072
    s_waitcnt lgkmcnt(3)
    buffer_store_dwordx4 v[48:51], v246, s[12:15], s25 offen
    s_add_u32 s25, s25, s26
    s_waitcnt lgkmcnt(2)
    buffer_store_dwordx4 v[52:55], v246, s[12:15], s25 offen
    s_add_u32 s25, s25, s26
    s_waitcnt lgkmcnt(1)
    buffer_store_dwordx4 v[64:67], v246, s[12:15], s25 offen
    s_add_u32 s25, s25, s26
    s_waitcnt lgkmcnt(0)
    buffer_store_dwordx4 v[68:71], v246, s[12:15], s25 offen
    s_add_u32 s25, s25, s26
    v_cvt_pk_bf16_f32 v72, v72, v73
    v_cvt_pk_bf16_f32 v73, v74, v75
    v_cvt_pk_bf16_f32 v74, v76, v77
    v_cvt_pk_bf16_f32 v75, v78, v79
    v_cvt_pk_bf16_f32 v76, v80, v81
    v_cvt_pk_bf16_f32 v77, v82, v83
    v_cvt_pk_bf16_f32 v78, v84, v85
    v_cvt_pk_bf16_f32 v79, v86, v87
    s_nop 1
    v_permlane32_swap_b32 v72, v74
    v_permlane32_swap_b32 v73, v75
    v_permlane32_swap_b32 v76, v78
    v_permlane32_swap_b32 v77, v79
    s_nop 0
    ds_write_b128 v244, v[72:75]
    v_xor_b32 v247, 32, v244
    ds_write_b128 v247, v[76:79]
    v_cvt_pk_bf16_f32 v88, v88, v89
    v_cvt_pk_bf16_f32 v89, v90, v91
    v_cvt_pk_bf16_f32 v90, v92, v93
    v_cvt_pk_bf16_f32 v91, v94, v95
    v_cvt_pk_bf16_f32 v92, v96, v97
    v_cvt_pk_bf16_f32 v93, v98, v99
    v_cvt_pk_bf16_f32 v94, v100, v101
    v_cvt_pk_bf16_f32 v95, v102, v103
    s_nop 1
    v_permlane32_swap_b32 v88, v90
    v_permlane32_swap_b32 v89, v91
    v_permlane32_swap_b32 v92, v94
    v_permlane32_swap_b32 v93, v95
    v_xor_b32 v247, 64, v244
    ds_write_b128 v247, v[88:91]
    v_xor_b32 v247, 96, v244
    ds_write_b128 v247, v[92:95]
    s_waitcnt lgkmcnt(0)
    ds_read_b128 v[80:83], v245 offset:0
    ds_read_b128 v[84:87], v245 offset:1024
    ds_read_b128 v[96:99], v245 offset:2048
    ds_read_b128 v[100:103], v245 offset:3072
    s_waitcnt lgkmcnt(3)
    buffer_store_dwordx4 v[80:83], v246, s[12:15], s25 offen
    s_add_u32 s25, s25, s26
    s_waitcnt lgkmcnt(2)
    buffer_store_dwordx4 v[84:87], v246, s[12:15], s25 offen
    s_add_u32 s25, s25, s26
    s_waitcnt lgkmcnt(1)
    buffer_store_dwordx4 v[96:99], v246, s[12:15], s25 offen
    s_add_u32 s25, s25, s26
    s_waitcnt lgkmcnt(0)
    buffer_store_dwordx4 v[100:103], v246, s[12:15], s25 offen
    s_add_u32 s25, s25, s26
    s_nop 1
L_outp_kernel_end_1:
    s_endpgm
.section .rodata,"a"
.p2align 6
.amdhsa_kernel proj_kernel
  .amdhsa_next_free_vgpr 224
  .amdhsa_next_free_sgpr 102
  .amdhsa_accum_offset 224
  .amdhsa_group_segment_fixed_size 0
  .amdhsa_kernarg_size 112
  .amdhsa_user_sgpr_count 2
  .amdhsa_user_sgpr_kernarg_segment_ptr 1
  .amdhsa_system_sgpr_workgroup_id_x 1
.end_amdhsa_kernel
.p2align 6
.amdhsa_kernel attn_kernel
  .amdhsa_next_free_vgpr 248
  .amdhsa_next_free_sgpr 102
  .amdhsa_accum_offset 248
  .amdhsa_group_segment_fixed_size 0
  .amdhsa_kernarg_size 112
  .amdhsa_user_sgpr_count 2
  .amdhsa_user_sgpr_kernarg_segment_ptr 1
  .amdhsa_system_sgpr_workgroup_id_x 1
.end_amdhsa_kernel
.p2align 6
.amdhsa_kernel outp_kernel
  .amdhsa_next_free_vgpr 248
  .amdhsa_next_free_sgpr 102
  .amdhsa_accum_offset 248
  .amdhsa_group_segment_fixed_size 0
  .amdhsa_kernarg_size 112
  .amdhsa_user_sgpr_count 2
  .amdhsa_user_sgpr_kernarg_segment_ptr 1
  .amdhsa_system_sgpr_workgroup_id_x 1
.end_amdhsa_kernel
```
